```python
import torch

def _softmax(x, axis=-1):
    return torch.softmax(x, dim=axis)
def _gelu(x):
    return torch.nn.functional.gelu(x, approximate="tanh")
def _silu(x):
    return torch.nn.functional.silu(x)
def _sigmoid(x):
    return torch.sigmoid(x)
def _layernorm(x, axis=-1, eps=1e-5):
    m = x.mean(dim=axis, keepdim=True)
    v = x.var(dim=axis, keepdim=True, unbiased=False)
    return (x - m) / torch.sqrt(v + eps)
def _scatter_add(tgt, idx, src, axis=0):
    return tgt.clone().index_add_(axis, idx, src)
def _segment_sum(src, seg, n):
    out = torch.zeros((n,) + src.shape[1:], dtype=src.dtype)
    return out.index_add_(0, seg, src)
def _pad(x, pw):
    flat = tuple(v for pair in reversed(pw) for v in pair)
    return torch.nn.functional.pad(x, flat)

kernel_name = 'gated_mix__sliding_local_dilated__dense_activation_gelu__prompt'

def setup_inputs():

    _w = (lambda a: (lambda t: t.to(torch.bfloat16) if t.is_floating_point() else t)(torch.as_tensor(a)))
    def _A_setup():
        B, S, D = 1, 2048, 640
        return {
            "x": _w((lambda *s: torch.randn(*s, dtype=torch.bfloat16) * 0.05)(B, S, D)),
            "wqkv": _w((lambda *s: torch.randn(*s, dtype=torch.bfloat16) * 0.8)(D, 3 * D)),
            "wo": _w((lambda *s: torch.randn(*s, dtype=torch.bfloat16) * 0.05)(D, D)),
        }
    _A_in = _A_setup()

    def _B_setup():
        B, S, D, F = 1, 2048, 640, 1536
        return {
            "x": _w((lambda *s: torch.randn(*s, dtype=torch.bfloat16) * 0.05)(B, S, D)),
            "w1": _w((lambda *s: torch.randn(*s, dtype=torch.bfloat16) * 12.8)(D, F) * (D ** -0.5)),
            "b1": _w((lambda *s: torch.randn(*s, dtype=torch.bfloat16) * 12.8)(F) * 0.01),
            "w2": _w((lambda *s: torch.randn(*s, dtype=torch.bfloat16) * 1.6)(F, D) * (F ** -0.5)),
            "b2": _w((lambda *s: torch.randn(*s, dtype=torch.bfloat16) * 12.8)(D) * 0.01),
        }
    _B_in = _B_setup()

    return {
        "A_x": _A_in["x"],
        "A_wqkv": _A_in["wqkv"],
        "A_wo": _A_in["wo"],
        "B_x": _B_in["x"],
        "B_w1": _B_in["w1"],
        "B_b1": _B_in["b1"],
        "B_w2": _B_in["w2"],
        "B_b2": _B_in["b2"],
        "gate_w": _w((lambda *s: torch.randn(*s, dtype=torch.bfloat16) * 0.05)(640) * 16.0),
    }

def reference(A_x, A_wqkv, A_wo, B_x, B_w1, B_b1, B_w2, B_b2, gate_w):
    def _A_ref(x, wqkv, wo):
        B, S, D = x.shape
        H = 32; Dh = D // H
        W, dil = 8, 2
        qkv = (lambda x, *d: x.permute(*d))((x @ wqkv).reshape(B, S, 3, H, Dh), 2, 0, 3, 1, 4)
        q, k, v = qkv[0], qkv[1], qkv[2]
        scale = Dh ** -0.5
        pos = torch.arange(S)
        off = torch.arange(W) * dil
        idx = pos[:, None] - off[None, :]
        mask = idx >= 0
        idx_c = torch.where(mask, idx, 0).reshape(-1)
        kg = k[:, :, idx_c, :].reshape(B, H, S, W, Dh)
        vg = v[:, :, idx_c, :].reshape(B, H, S, W, Dh)
        logits = torch.einsum("bhsd,bhswd->bhsw", q, kg) * scale
        logits = torch.where(mask[None, None, :, :], logits, -1e9)
        attn = _softmax(logits, axis=-1)
        o = torch.einsum("bhsw,bhswd->bhsd", attn, vg)
        return (lambda x, *d: x.permute(*d))(o, 0, 2, 1, 3).reshape(B, S, D) @ wo

    def _B_ref(x, w1, b1, w2, b2):
        h = torch.einsum("bsd,df->bsf", x, w1) + b1
        h = _gelu(h)
        return torch.einsum("bsf,fd->bsd", h, w2) + b2

    x = A_x
    g = _sigmoid((x * gate_w).sum(-1, keepdims=True))
    a = _A_ref(x, A_wqkv, A_wo)
    b = _B_ref(x, B_w1, B_b1, B_w2, B_b2)
    return g * a + (1 - g) * b
```

```asm
; @launch kernel=k1_kernel grid=(256,1,1) block=(256,1,1) lds=154112
; @launch kernel=k2_kernel grid=(256,1,1) block=(256,1,1) lds=61440
.amdgcn_target "amdgcn-amd-amdhsa--gfx950"
.text
.globl k1_kernel
.p2align 8
.type k1_kernel,@function
k1_kernel:
    s_cmp_ge_u32 s2, 256
    s_cbranch_scc1 L_k1_end
    s_load_dwordx4 s[4:7], s[0:1], 0
    s_load_dwordx2 s[8:9], s[0:1], 16
    s_load_dwordx4 s[12:15], s[0:1], 32
    s_load_dwordx2 s[16:17], s[0:1], 48
    s_load_dwordx2 s[18:19], s[0:1], 64
    s_load_dwordx2 s[20:21], s[0:1], 88
    v_lshrrev_b32 v1, 6, v0
    v_and_b32 v0, 63, v0
    v_readfirstlane_b32 s47, v1
    s_lshr_b32 s94, s2, 3
    s_lshl2_add_u32 s94, s94, s47
    s_mul_i32 s92, s94, 320
    s_min_u32 s92, s92, L_k1_end-L_q0-320
    s_getpc_b64 s[90:91]
L_pf1:
    s_add_u32 s92, s92, L_q0-L_pf1
    s_add_u32 s90, s90, s92
    s_addc_u32 s91, s91, 0
    s_load_dword s93, s[90:91], 0
    s_load_dword s93, s[90:91], 64
    s_load_dword s93, s[90:91], 128
    s_load_dword s93, s[90:91], 192
    s_load_dword s93, s[90:91], 256
    s_and_b32 s44, s2, 1
    s_lshr_b32 s45, s2, 5
    s_bfe_u32 s46, s2, 0x20001
    s_lshl_b32 s46, s46, 1
    s_bfe_u32 s56, s2, 0x10003
    s_add_u32 s46, s46, s56
    s_bitcmp1_b32 s2, 4
    s_cbranch_scc1 L_h
    s_cmp_eq_u32 s47, 1
    s_cbranch_scc1 L_q1
    s_cmp_eq_u32 s47, 2
    s_cbranch_scc1 L_q2
    s_cmp_eq_u32 s47, 3
    s_cbranch_scc1 L_q3
L_q0:
    v_lshrrev_b32 v1, 3, v0
    v_mul_u32_u24 v1, 0xa00, v1
    v_lshrrev_b32 v2, 4, v0
    v_xor_b32 v2, v2, v0
    v_and_b32 v2, 7, v2
    v_lshl_add_u32 v3, v2, 4, v1
    v_xor_b32 v4, 64, v3
    s_lshl_b32 s56, s45, 8
    s_add_u32 s56, s56, s44
    s_mul_i32 s56, s56, 0x500
    s_sub_u32 s57, s56, 0xa000
    s_cmp_eq_u32 s45, 0
    s_cselect_b32 s58, s56, s57
    s_add_u32 s59, s58, 0x5000
    v_add_u32 v12, s59, v3
    s_add_u32 s59, s58, 0x5000
    v_add_u32 v13, s59, v4
    s_add_u32 s59, s57, 0xa000
    v_add_u32 v14, s59, v3
    s_add_u32 s59, s57, 0xf000
    v_add_u32 v15, s59, v4
    s_mul_i32 s60, s46, 160
    v_add_u32 v1, 0x0, v0
    v_mul_u32_u24 v2, 0x889, v1
    v_lshrrev_b32 v2, 16, v2
    v_mul_u32_u24 v5, 30, v2
    v_sub_u32 v1, v1, v5
    v_mul_u32_u24 v5, 0xcd, v1
    v_lshrrev_b32 v5, 11, v5
    v_mul_u32_u24 v5, 0x460, v5
    v_lshl_add_u32 v1, v1, 4, v5
    v_and_b32 v5, 0x13, v2
    v_and_b32 v6, 4, v2
    v_lshl_or_b32 v5, v6, 1, v5
    v_and_b32 v6, 8, v2
    v_lshrrev_b32 v6, 1, v6
    v_or_b32 v5, v5, v6
    v_mul_u32_u24 v5, 0xf00, v5
    v_add3_u32 v8, v1, v5, s60
    v_add_u32 v1, 0x40, v0
    v_mul_u32_u24 v2, 0x889, v1
    v_lshrrev_b32 v2, 16, v2
    v_mul_u32_u24 v5, 30, v2
    v_sub_u32 v1, v1, v5
    v_mul_u32_u24 v5, 0xcd, v1
    v_lshrrev_b32 v5, 11, v5
    v_mul_u32_u24 v5, 0x460, v5
    v_lshl_add_u32 v1, v1, 4, v5
    v_and_b32 v5, 0x13, v2
    v_and_b32 v6, 4, v2
    v_lshl_or_b32 v5, v6, 1, v5
    v_and_b32 v6, 8, v2
    v_lshrrev_b32 v6, 1, v6
    v_or_b32 v5, v5, v6
    v_mul_u32_u24 v5, 0xf00, v5
    v_add3_u32 v9, v1, v5, s60
    v_add_u32 v1, 0x80, v0
    v_mul_u32_u24 v2, 0x889, v1
    v_lshrrev_b32 v2, 16, v2
    v_mul_u32_u24 v5, 30, v2
    v_sub_u32 v1, v1, v5
    v_mul_u32_u24 v5, 0xcd, v1
    v_lshrrev_b32 v5, 11, v5
    v_mul_u32_u24 v5, 0x460, v5
    v_lshl_add_u32 v1, v1, 4, v5
    v_and_b32 v5, 0x13, v2
    v_and_b32 v6, 4, v2
    v_lshl_or_b32 v5, v6, 1, v5
    v_and_b32 v6, 8, v2
    v_lshrrev_b32 v6, 1, v6
    v_or_b32 v5, v5, v6
    v_mul_u32_u24 v5, 0xf00, v5
    v_add3_u32 v10, v1, v5, s60
    v_add_u32 v1, 0xc0, v0
    v_mul_u32_u24 v2, 0x889, v1
    v_lshrrev_b32 v2, 16, v2
    v_mul_u32_u24 v5, 30, v2
    v_sub_u32 v1, v1, v5
    v_mul_u32_u24 v5, 0xcd, v1
    v_lshrrev_b32 v5, 11, v5
    v_mul_u32_u24 v5, 0x460, v5
    v_lshl_add_u32 v1, v1, 4, v5
    v_and_b32 v5, 0x13, v2
    v_and_b32 v6, 4, v2
    v_lshl_or_b32 v5, v6, 1, v5
    v_and_b32 v6, 8, v2
    v_lshrrev_b32 v6, 1, v6
    v_or_b32 v5, v5, v6
    v_mul_u32_u24 v5, 0xf00, v5
    v_add3_u32 v11, v1, v5, s60
    s_and_b32 s50, s46, 1
    s_lshl_b32 s50, s50, 1
    s_add_u32 s50, s50, s45
    s_mul_i32 s48, s50, 52
    s_lshr_b32 s48, s48, 8
    s_mul_i32 s48, s48, 5
    s_sub_u32 s50, s50, s48
    s_mul_i32 s50, s50, 32
    s_lshr_b32 s50, s50, 4
    s_mul_i32 s48, s50, 0x3c000
    s_lshl_b32 s50, s50, 7
    s_add_u32 s49, s48, 0x1e000
    s_mov_b32 s51, 0
    s_mov_b32 s55, 0
    s_mov_b32 s52, 0
    s_waitcnt lgkmcnt(0)
    s_mov_b32 s24, s4
    s_mov_b32 s25, s5
    s_mov_b32 s26, 0x280000
    s_mov_b32 s27, 0x20000
    s_mov_b32 s28, s6
    s_mov_b32 s29, s7
    s_mov_b32 s30, 0x258000
    s_mov_b32 s31, 0x20000
    s_mov_b32 s32, s20
    s_mov_b32 s33, s21
    s_mov_b32 s34, 0xc02000
    s_mov_b32 s35, 0x20000
    s_add_u32 m0, s51, 0x0
    s_nop 0
    buffer_load_dwordx4 v12, s[24:27], s50 offen lds
    s_add_u32 m0, s51, 0x400
    s_nop 0
    buffer_load_dwordx4 v13, s[24:27], s50 offen lds
    s_add_u32 m0, s51, 0x800
    s_nop 0
    buffer_load_dwordx4 v14, s[24:27], s50 offen lds
    s_add_u32 m0, s51, 0xc00
    s_nop 0
    buffer_load_dwordx4 v15, s[24:27], s50 offen lds
    s_add_u32 m0, s51, 0x4800
    s_nop 0
    buffer_load_dwordx4 v8, s[28:31], s48 offen lds
    s_add_u32 m0, s51, 0x4c00
    s_nop 0
    buffer_load_dwordx4 v9, s[28:31], s48 offen lds
    s_add_u32 m0, s51, 0x5000
    s_nop 0
    buffer_load_dwordx4 v10, s[28:31], s48 offen lds
    s_add_u32 m0, s51, 0x5400
    s_nop 0
    buffer_load_dwordx4 v11, s[28:31], s48 offen lds
    s_add_u32 m0, s51, 0x8400
    s_nop 0
    buffer_load_dwordx4 v8, s[28:31], s49 offen lds
    s_add_u32 m0, s51, 0x8800
    s_nop 0
    buffer_load_dwordx4 v9, s[28:31], s49 offen lds
    s_add_u32 m0, s51, 0x8c00
    s_nop 0
    buffer_load_dwordx4 v10, s[28:31], s49 offen lds
    s_add_u32 m0, s51, 0x9000
    s_nop 0
    buffer_load_dwordx4 v11, s[28:31], s49 offen lds
    s_add_u32 s48, s48, 0x3c000
    s_add_u32 s55, s55, 1
    s_add_u32 s50, s50, 0x80
    s_cmp_eq_u32 s50, 0x500
    s_cselect_b32 s50, 0, s50
    s_cselect_b32 s48, 0, s48
    s_cmp_ge_u32 s55, 10
    s_cselect_b32 s50, 0x7f000000, s50
    s_cselect_b32 s48, 0x7f000000, s48
    s_add_u32 s51, s51, 0xc000
    s_cmp_eq_u32 s51, 0x24000
    s_cselect_b32 s51, 0, s51
    s_add_u32 s49, s48, 0x1e000
    s_and_b32 s94, s46, 1
    s_lshl1_add_u32 s94, s45, s94
    s_mul_i32 s92, s94, 256
    s_min_u32 s92, s92, L_q0_end-L_q0_tail-256
    s_getpc_b64 s[90:91]
L_pf2:
    s_add_u32 s92, s92, L_q0_tail-L_pf2
    s_add_u32 s90, s90, s92
    s_addc_u32 s91, s91, 0
    s_load_dword s93, s[90:91], 0
    s_load_dword s93, s[90:91], 64
    s_load_dword s93, s[90:91], 128
    s_load_dword s93, s[90:91], 192
    s_add_u32 m0, s51, 0x0
    s_nop 0
    buffer_load_dwordx4 v12, s[24:27], s50 offen lds
    v_and_b32 v1, 15, v0
    v_lshrrev_b32 v2, 1, v1
    v_lshrrev_b32 v3, 4, v0
    v_xor_b32 v2, v2, v3
    v_lshlrev_b32 v2, 4, v2
    v_lshl_add_u32 v18, v1, 7, v2
    v_xor_b32 v19, 64, v18
    v_lshrrev_b32 v1, 5, v0
    v_lshlrev_b32 v1, 4, v1
    v_bfe_u32 v2, v0, 4, 1
    v_lshl_add_u32 v1, v2, 2, v1
    v_bfe_u32 v2, v0, 2, 2
    v_add_u32 v1, v1, v2
    v_mul_u32_u24 v1, 0x1e0, v1
    s_add_u32 m0, s51, 0x400
    s_nop 0
    buffer_load_dwordx4 v13, s[24:27], s50 offen lds
    v_and_b32 v2, 3, v0
    v_lshl_add_u32 v20, v2, 3, v1
    v_mul_u32_u24 v2, 40, v2
    v_add3_u32 v21, v1, v2, 32
    v_mov_b64 v[24:25], 0
    v_mov_b64 v[26:27], 0
    v_mov_b64 v[28:29], 0
    v_mov_b64 v[30:31], 0
    v_mov_b64 v[32:33], 0
    v_mov_b64 v[34:35], 0
    v_mov_b64 v[36:37], 0
    v_mov_b64 v[38:39], 0
    v_mov_b64 v[40:41], 0
    v_mov_b64 v[42:43], 0
    s_add_u32 m0, s51, 0x800
    s_nop 0
    buffer_load_dwordx4 v14, s[24:27], s50 offen lds
    v_mov_b64 v[44:45], 0
    v_mov_b64 v[46:47], 0
    v_mov_b64 v[48:49], 0
    v_mov_b64 v[50:51], 0
    v_mov_b64 v[52:53], 0
    v_mov_b64 v[54:55], 0
    v_mov_b64 v[56:57], 0
    v_mov_b64 v[58:59], 0
    v_mov_b64 v[60:61], 0
    v_mov_b64 v[62:63], 0
    v_mov_b64 v[64:65], 0
    v_mov_b64 v[66:67], 0
    v_mov_b64 v[68:69], 0
    v_mov_b64 v[70:71], 0
    s_add_u32 m0, s51, 0xc00
    s_nop 0
    buffer_load_dwordx4 v15, s[24:27], s50 offen lds
    v_mov_b64 v[72:73], 0
    v_mov_b64 v[74:75], 0
    v_mov_b64 v[76:77], 0
    v_mov_b64 v[78:79], 0
    v_mov_b64 v[80:81], 0
    v_mov_b64 v[82:83], 0
    v_mov_b64 v[84:85], 0
    v_mov_b64 v[86:87], 0
    v_mov_b64 v[88:89], 0
    v_mov_b64 v[90:91], 0
    v_mov_b64 v[92:93], 0
    v_mov_b64 v[94:95], 0
    v_mov_b64 v[96:97], 0
    v_mov_b64 v[98:99], 0
    s_add_u32 m0, s51, 0x4800
    s_nop 0
    buffer_load_dwordx4 v8, s[28:31], s48 offen lds
    v_mov_b64 v[100:101], 0
    v_mov_b64 v[102:103], 0
    v_mov_b64 v[104:105], 0
    v_mov_b64 v[106:107], 0
    v_mov_b64 v[108:109], 0
    v_mov_b64 v[110:111], 0
    v_mov_b64 v[112:113], 0
    v_mov_b64 v[114:115], 0
    v_mov_b64 v[116:117], 0
    v_mov_b64 v[118:119], 0
    v_mov_b64 v[120:121], 0
    v_mov_b64 v[122:123], 0
    v_mov_b64 v[124:125], 0
    v_mov_b64 v[126:127], 0
    s_add_u32 m0, s51, 0x4c00
    s_nop 0
    buffer_load_dwordx4 v9, s[28:31], s48 offen lds
    v_mov_b64 v[128:129], 0
    v_mov_b64 v[130:131], 0
    v_mov_b64 v[132:133], 0
    v_mov_b64 v[134:135], 0
    v_mov_b64 v[136:137], 0
    v_mov_b64 v[138:139], 0
    v_mov_b64 v[140:141], 0
    v_mov_b64 v[142:143], 0
    v_mov_b64 v[144:145], 0
    v_mov_b64 v[146:147], 0
    v_mov_b64 v[148:149], 0
    v_mov_b64 v[150:151], 0
    v_mov_b64 v[152:153], 0
    v_mov_b64 v[154:155], 0
    s_add_u32 m0, s51, 0x5000
    s_nop 0
    buffer_load_dwordx4 v10, s[28:31], s48 offen lds
    v_and_b32 v1, 15, v0
    v_lshrrev_b32 v2, 4, v0
    v_lshlrev_b32 v3, 2, v2
    v_sub_u32 v3, v1, v3
    v_mov_b32 v4, 0xf149f2ca
    v_subrev_u32 v5, 0, v3
    v_cmp_gt_u32 vcc, 8, v5
    s_nop 1
    v_cndmask_b32 v196, v4, 0, vcc
    v_cmp_ge_i32 vcc, -9, v5
    s_nop 1
    v_cndmask_b32 v200, v4, 0, vcc
    v_subrev_u32 v5, 1, v3
    v_cmp_gt_u32 vcc, 8, v5
    s_nop 1
    v_cndmask_b32 v197, v4, 0, vcc
    v_cmp_ge_i32 vcc, -9, v5
    s_add_u32 m0, s51, 0x5400
    s_nop 0
    buffer_load_dwordx4 v11, s[28:31], s48 offen lds
    v_cndmask_b32 v201, v4, 0, vcc
    v_subrev_u32 v5, 2, v3
    v_cmp_gt_u32 vcc, 8, v5
    s_nop 1
    v_cndmask_b32 v198, v4, 0, vcc
    v_cmp_ge_i32 vcc, -9, v5
    s_nop 1
    v_cndmask_b32 v202, v4, 0, vcc
    v_subrev_u32 v5, 3, v3
    v_cmp_gt_u32 vcc, 8, v5
    s_nop 1
    v_cndmask_b32 v199, v4, 0, vcc
    v_cmp_ge_i32 vcc, -9, v5
    s_nop 1
    v_cndmask_b32 v203, v4, 0, vcc
    s_cmp_eq_u32 s45, 0
    s_cselect_b64 s[68:69], -1, 0
    v_cndmask_b32 v204, v200, v4, s[68:69]
    s_add_u32 m0, s51, 0x8400
    s_nop 0
    buffer_load_dwordx4 v8, s[28:31], s49 offen lds
    v_cndmask_b32 v205, v201, v4, s[68:69]
    v_cndmask_b32 v206, v202, v4, s[68:69]
    v_cndmask_b32 v207, v203, v4, s[68:69]
    v_mov_b32 v208, 0x3f803f80
    v_mov_b32 v209, 0x3f803f80
    v_mov_b32 v210, 0x3f803f80
    v_mov_b32 v211, 0x3f803f80
    v_cmp_eq_u32 vcc, 0, v2
    s_nop 1
    v_cndmask_b32 v212, 0, -1, vcc
    v_cmp_eq_u32 s[68:69], 1, v2
    s_nop 1
    v_cndmask_b32 v213, 0, -1, s[68:69]
    s_mov_b32 s62, 0x3ea52b5c
    s_mov_b32 s63, 0x3ea52b5c
    s_lshl_b32 s56, s44, 6
    s_add_u32 m0, s51, 0x8800
    s_nop 0
    buffer_load_dwordx4 v9, s[28:31], s49 offen lds
    s_lshl_b32 s57, s45, 3
    s_add_u32 s56, s56, s57
    s_add_u32 s56, s56, 0
    s_mul_i32 s56, s56, 0x11000
    s_lshl_b32 s57, s46, 11
    s_add_u32 s57, s57, s56
    s_add_u32 s57, s57, 0
    s_lshr_b32 s58, s46, 1
    s_lshl_b32 s58, s58, 10
    s_add_u32 s58, s58, s56
    s_and_b32 s59, s46, 1
    s_lshl_b32 s59, s59, 3
    s_add_u32 s58, s58, s59
    s_add_u32 s58, s58, 16384
    s_add_u32 m0, s51, 0x8c00
    s_nop 0
    buffer_load_dwordx4 v10, s[28:31], s49 offen lds
    v_lshlrev_b32 v157, 4, v0
    s_movk_i32 s59, 0x7fff
    s_lshl1_add_u32 s59, s59, 1
    v_ashrrev_i32 v1, 31, v200
    v_ashrrev_i32 v2, 31, v201
    v_bfi_b32 v1, s59, v1, v2
    v_not_b32 v222, v1
    v_ashrrev_i32 v1, 31, v202
    v_ashrrev_i32 v2, 31, v203
    v_bfi_b32 v1, s59, v1, v2
    v_not_b32 v223, v1
    v_ashrrev_i32 v1, 31, v196
    v_ashrrev_i32 v2, 31, v197
    v_bfi_b32 v1, s59, v1, v2
    s_add_u32 m0, s51, 0x9000
    s_nop 0
    buffer_load_dwordx4 v11, s[28:31], s49 offen lds
    v_not_b32 v6, v1
    v_ashrrev_i32 v1, 31, v198
    v_ashrrev_i32 v2, 31, v199
    v_bfi_b32 v1, s59, v1, v2
    v_not_b32 v7, v1
    v_lshlrev_b32 v156, 3, v0
    v_add_u32 v156, 0x20400, v156
    s_add_u32 s48, s48, 0x3c000
    s_add_u32 s55, s55, 1
    s_add_u32 s50, s50, 0x80
    s_cmp_eq_u32 s50, 0x500
    s_cselect_b32 s50, 0, s50
    s_cselect_b32 s48, 0, s48
    s_cmp_ge_u32 s55, 10
    s_cselect_b32 s50, 0x7f000000, s50
    s_cselect_b32 s48, 0x7f000000, s48
    s_add_u32 s51, s51, 0xc000
    s_cmp_eq_u32 s51, 0x24000
    s_cselect_b32 s51, 0, s51
    s_add_u32 s49, s48, 0x1e000
    s_waitcnt vmcnt(12)
    s_barrier
    ds_read_b128 a[0:3], v18 offset:2048
    ds_read_b128 a[4:7], v18 offset:4096
    ds_read_b128 a[8:11], v18 offset:6144
    ds_read_b128 a[12:15], v18 offset:8192
    ds_read_b128 a[16:19], v18 offset:0
    ds_read_b64_tr_b16 a[20:21], v20 offset:18432
    ds_read_b64_tr_b16 a[22:23], v20 offset:22272
    ds_read_b64_tr_b16 a[24:25], v20 offset:18472
    ds_read_b64_tr_b16 a[26:27], v20 offset:22312
    ds_read_b64_tr_b16 a[28:29], v20 offset:18592
    ds_read_b64_tr_b16 a[30:31], v20 offset:22432
    ds_read_b64_tr_b16 a[32:33], v20 offset:18632
    ds_read_b64_tr_b16 a[34:35], v20 offset:22472
    ds_read_b64_tr_b16 a[36:37], v20 offset:18752
    ds_read_b64_tr_b16 a[38:39], v20 offset:22592
    ds_read_b64_tr_b16 a[40:41], v20 offset:18792
    ds_read_b64_tr_b16 a[42:43], v20 offset:22632
    ds_read_b64_tr_b16 a[44:45], v21 offset:18432
    ds_read_b64_tr_b16 a[46:47], v21 offset:22272
    ds_read_b64_tr_b16 a[48:49], v21 offset:18592
    ds_read_b64_tr_b16 a[50:51], v21 offset:22432
    s_add_u32 m0, s51, 0x0
    s_nop 0
    buffer_load_dwordx4 v12, s[24:27], s50 offen lds
    s_add_u32 m0, s51, 0x400
    s_nop 0
    buffer_load_dwordx4 v13, s[24:27], s50 offen lds
    s_add_u32 m0, s51, 0x800
    s_nop 0
    buffer_load_dwordx4 v14, s[24:27], s50 offen lds
    s_add_u32 m0, s51, 0xc00
    s_nop 0
    buffer_load_dwordx4 v15, s[24:27], s50 offen lds
    s_add_u32 m0, s51, 0x4800
    s_nop 0
    buffer_load_dwordx4 v8, s[28:31], s48 offen lds
    s_add_u32 m0, s51, 0x4c00
    s_nop 0
    buffer_load_dwordx4 v9, s[28:31], s48 offen lds
    s_mov_b32 s54, 9
L_q0_loop:
    s_waitcnt lgkmcnt(0)
    v_mfma_f32_16x16x32_bf16 v[24:27], a[20:23], a[0:3], v[24:27]
    ds_read_b128 a[52:55], v19 offset:2048
    s_add_u32 m0, s51, 0x5000
    v_mfma_f32_16x16x32_bf16 v[28:31], a[24:27], a[0:3], v[28:31]
    buffer_load_dwordx4 v10, s[28:31], s48 offen lds
    ds_read_b128 a[56:59], v19 offset:4096
    v_mfma_f32_16x16x32_bf16 v[32:35], a[28:31], a[0:3], v[32:35]
    ds_read_b128 a[60:63], v19 offset:6144
    v_mfma_f32_16x16x32_bf16 v[36:39], a[32:35], a[0:3], v[36:39]
    ds_read_b128 a[64:67], v19 offset:8192
    v_mfma_f32_16x16x32_bf16 v[40:43], a[0:3], a[36:39], v[40:43]
    ds_read_b128 a[68:71], v19 offset:0
    s_add_u32 m0, s51, 0x5400
    v_mfma_f32_16x16x32_bf16 v[44:47], a[0:3], a[40:43], v[44:47]
    buffer_load_dwordx4 v11, s[28:31], s48 offen lds
    ds_read_b64_tr_b16 a[72:73], v20 offset:33792
    v_mfma_f32_16x16x32_bf16 v[120:123], a[44:47], a[0:3], v[120:123]
    ds_read_b64_tr_b16 a[74:75], v20 offset:37632
    v_mfma_f32_16x16x32_bf16 v[48:51], a[20:23], a[4:7], v[48:51]
    ds_read_b64_tr_b16 a[76:77], v20 offset:33832
    v_mfma_f32_16x16x32_bf16 v[52:55], a[24:27], a[4:7], v[52:55]
    ds_read_b64_tr_b16 a[78:79], v20 offset:37672
    s_add_u32 m0, s51, 0x8400
    v_mfma_f32_16x16x32_bf16 v[56:59], a[28:31], a[4:7], v[56:59]
    buffer_load_dwordx4 v8, s[28:31], s49 offen lds
    ds_read_b64_tr_b16 a[80:81], v20 offset:33952
    v_mfma_f32_16x16x32_bf16 v[60:63], a[32:35], a[4:7], v[60:63]
    ds_read_b64_tr_b16 a[82:83], v20 offset:37792
    v_mfma_f32_16x16x32_bf16 v[64:67], a[4:7], a[36:39], v[64:67]
    ds_read_b64_tr_b16 a[84:85], v20 offset:33992
    v_mfma_f32_16x16x32_bf16 v[68:71], a[4:7], a[40:43], v[68:71]
    ds_read_b64_tr_b16 a[86:87], v20 offset:37832
    s_add_u32 m0, s51, 0x8800
    v_mfma_f32_16x16x32_bf16 v[124:127], a[44:47], a[4:7], v[124:127]
    buffer_load_dwordx4 v9, s[28:31], s49 offen lds
    ds_read_b64_tr_b16 a[88:89], v20 offset:34112
    v_mfma_f32_16x16x32_bf16 v[72:75], a[20:23], a[8:11], v[72:75]
    ds_read_b64_tr_b16 a[90:91], v20 offset:37952
    v_mfma_f32_16x16x32_bf16 v[76:79], a[24:27], a[8:11], v[76:79]
    ds_read_b64_tr_b16 a[92:93], v20 offset:34152
    v_mfma_f32_16x16x32_bf16 v[80:83], a[28:31], a[8:11], v[80:83]
    ds_read_b64_tr_b16 a[94:95], v20 offset:37992
    s_add_u32 m0, s51, 0x8c00
    v_mfma_f32_16x16x32_bf16 v[84:87], a[32:35], a[8:11], v[84:87]
    buffer_load_dwordx4 v10, s[28:31], s49 offen lds
    ds_read_b64_tr_b16 a[96:97], v21 offset:33792
    v_mfma_f32_16x16x32_bf16 v[88:91], a[8:11], a[36:39], v[88:91]
    ds_read_b64_tr_b16 a[98:99], v21 offset:37632
    v_mfma_f32_16x16x32_bf16 v[92:95], a[8:11], a[40:43], v[92:95]
    ds_read_b64_tr_b16 a[100:101], v21 offset:33952
    v_mfma_f32_16x16x32_bf16 v[128:131], a[44:47], a[8:11], v[128:131]
    ds_read_b64_tr_b16 a[102:103], v21 offset:37792
    s_add_u32 m0, s51, 0x9000
    v_mfma_f32_16x16x32_bf16 v[96:99], a[20:23], a[12:15], v[96:99]
    buffer_load_dwordx4 v11, s[28:31], s49 offen lds
    v_mfma_f32_16x16x32_bf16 v[100:103], a[24:27], a[12:15], v[100:103]
    s_add_u32 s70, s52, 0xc000
    s_cmp_eq_u32 s70, 0x24000
    s_cselect_b32 s70, 0, s70
    s_sub_u32 s53, s70, s52
    s_mov_b32 s52, s70
    v_mfma_f32_16x16x32_bf16 v[104:107], a[28:31], a[12:15], v[104:107]
    v_add_u32 v18, s53, v18
    v_mfma_f32_16x16x32_bf16 v[108:111], a[32:35], a[12:15], v[108:111]
    s_add_u32 s48, s48, 0x3c000
    s_add_u32 s55, s55, 1
    s_add_u32 s50, s50, 0x80
    v_mfma_f32_16x16x32_bf16 v[112:115], a[12:15], a[36:39], v[112:115]
    s_cmp_eq_u32 s50, 0x500
    s_cselect_b32 s50, 0, s50
    s_cselect_b32 s48, 0, s48
    v_mfma_f32_16x16x32_bf16 v[116:119], a[12:15], a[40:43], v[116:119]
    s_cmp_ge_u32 s55, 10
    s_cselect_b32 s50, 0x7f000000, s50
    s_cselect_b32 s48, 0x7f000000, s48
    v_mfma_f32_16x16x32_bf16 v[132:135], a[44:47], a[12:15], v[132:135]
    s_add_u32 s51, s51, 0xc000
    s_cmp_eq_u32 s51, 0x24000
    s_cselect_b32 s51, 0, s51
    v_mfma_f32_16x16x32_bf16 v[136:139], a[48:51], a[0:3], v[136:139]
    s_add_u32 s49, s48, 0x1e000
    v_mfma_f32_16x16x32_bf16 v[140:143], a[48:51], a[4:7], v[140:143]
    v_add_u32 v19, s53, v19
    v_mfma_f32_16x16x32_bf16 v[144:147], a[28:31], a[16:19], v[144:147]
    v_add_u32 v20, s53, v20
    v_add_u32 v21, s53, v21
    v_mfma_f32_16x16x32_bf16 v[148:151], a[32:35], a[16:19], v[148:151]
    v_mfma_f32_16x16x32_bf16 v[152:155], a[48:51], a[16:19], v[152:155]
    s_waitcnt vmcnt(12) lgkmcnt(0)
    s_barrier
    v_mfma_f32_16x16x32_bf16 v[24:27], a[72:75], a[52:55], v[24:27]
    ds_read_b128 a[0:3], v18 offset:2048
    s_add_u32 m0, s51, 0x0
    v_mfma_f32_16x16x32_bf16 v[28:31], a[76:79], a[52:55], v[28:31]
    buffer_load_dwordx4 v12, s[24:27], s50 offen lds
    ds_read_b128 a[4:7], v18 offset:4096
    v_mfma_f32_16x16x32_bf16 v[32:35], a[80:83], a[52:55], v[32:35]
    ds_read_b128 a[8:11], v18 offset:6144
    v_mfma_f32_16x16x32_bf16 v[36:39], a[84:87], a[52:55], v[36:39]
    ds_read_b128 a[12:15], v18 offset:8192
    v_mfma_f32_16x16x32_bf16 v[40:43], a[52:55], a[88:91], v[40:43]
    ds_read_b128 a[16:19], v18 offset:0
    s_add_u32 m0, s51, 0x400
    v_mfma_f32_16x16x32_bf16 v[44:47], a[52:55], a[92:95], v[44:47]
    buffer_load_dwordx4 v13, s[24:27], s50 offen lds
    ds_read_b64_tr_b16 a[20:21], v20 offset:18432
    v_mfma_f32_16x16x32_bf16 v[120:123], a[96:99], a[52:55], v[120:123]
    ds_read_b64_tr_b16 a[22:23], v20 offset:22272
    v_mfma_f32_16x16x32_bf16 v[48:51], a[72:75], a[56:59], v[48:51]
    ds_read_b64_tr_b16 a[24:25], v20 offset:18472
    v_mfma_f32_16x16x32_bf16 v[52:55], a[76:79], a[56:59], v[52:55]
    ds_read_b64_tr_b16 a[26:27], v20 offset:22312
    s_add_u32 m0, s51, 0x800
    v_mfma_f32_16x16x32_bf16 v[56:59], a[80:83], a[56:59], v[56:59]
    buffer_load_dwordx4 v14, s[24:27], s50 offen lds
    ds_read_b64_tr_b16 a[28:29], v20 offset:18592
    v_mfma_f32_16x16x32_bf16 v[60:63], a[84:87], a[56:59], v[60:63]
    ds_read_b64_tr_b16 a[30:31], v20 offset:22432
    v_mfma_f32_16x16x32_bf16 v[64:67], a[56:59], a[88:91], v[64:67]
    ds_read_b64_tr_b16 a[32:33], v20 offset:18632
    v_mfma_f32_16x16x32_bf16 v[68:71], a[56:59], a[92:95], v[68:71]
    ds_read_b64_tr_b16 a[34:35], v20 offset:22472
    s_add_u32 m0, s51, 0xc00
    v_mfma_f32_16x16x32_bf16 v[124:127], a[96:99], a[56:59], v[124:127]
    buffer_load_dwordx4 v15, s[24:27], s50 offen lds
    ds_read_b64_tr_b16 a[36:37], v20 offset:18752
    v_mfma_f32_16x16x32_bf16 v[72:75], a[72:75], a[60:63], v[72:75]
    ds_read_b64_tr_b16 a[38:39], v20 offset:22592
    v_mfma_f32_16x16x32_bf16 v[76:79], a[76:79], a[60:63], v[76:79]
    ds_read_b64_tr_b16 a[40:41], v20 offset:18792
    v_mfma_f32_16x16x32_bf16 v[80:83], a[80:83], a[60:63], v[80:83]
    ds_read_b64_tr_b16 a[42:43], v20 offset:22632
    s_add_u32 m0, s51, 0x4800
    v_mfma_f32_16x16x32_bf16 v[84:87], a[84:87], a[60:63], v[84:87]
    buffer_load_dwordx4 v8, s[28:31], s48 offen lds
    ds_read_b64_tr_b16 a[44:45], v21 offset:18432
    v_mfma_f32_16x16x32_bf16 v[88:91], a[60:63], a[88:91], v[88:91]
    ds_read_b64_tr_b16 a[46:47], v21 offset:22272
    v_mfma_f32_16x16x32_bf16 v[92:95], a[60:63], a[92:95], v[92:95]
    ds_read_b64_tr_b16 a[48:49], v21 offset:18592
    v_mfma_f32_16x16x32_bf16 v[128:131], a[96:99], a[60:63], v[128:131]
    ds_read_b64_tr_b16 a[50:51], v21 offset:22432
    s_add_u32 m0, s51, 0x4c00
    v_mfma_f32_16x16x32_bf16 v[96:99], a[72:75], a[64:67], v[96:99]
    buffer_load_dwordx4 v9, s[28:31], s48 offen lds
    v_mfma_f32_16x16x32_bf16 v[100:103], a[76:79], a[64:67], v[100:103]
    v_mfma_f32_16x16x32_bf16 v[104:107], a[80:83], a[64:67], v[104:107]
    v_mfma_f32_16x16x32_bf16 v[108:111], a[84:87], a[64:67], v[108:111]
    v_mfma_f32_16x16x32_bf16 v[112:115], a[64:67], a[88:91], v[112:115]
    v_mfma_f32_16x16x32_bf16 v[116:119], a[64:67], a[92:95], v[116:119]
    s_sub_u32 s54, s54, 1
    v_mfma_f32_16x16x32_bf16 v[132:135], a[96:99], a[64:67], v[132:135]
    s_cmp_lg_u32 s54, 0
    v_mfma_f32_16x16x32_bf16 v[136:139], a[100:103], a[52:55], v[136:139]
    v_mfma_f32_16x16x32_bf16 v[140:143], a[100:103], a[56:59], v[140:143]
    v_mfma_f32_16x16x32_bf16 v[144:147], a[80:83], a[68:71], v[144:147]
    v_mfma_f32_16x16x32_bf16 v[148:151], a[84:87], a[68:71], v[148:151]
    v_mfma_f32_16x16x32_bf16 v[152:155], a[100:103], a[68:71], v[152:155]
    s_cbranch_scc1 L_q0_loop
L_q0_tail:
    s_waitcnt lgkmcnt(0)
    v_mfma_f32_16x16x32_bf16 v[24:27], a[20:23], a[0:3], v[24:27]
    ds_read_b128 a[52:55], v19 offset:2048
    v_mfma_f32_16x16x32_bf16 v[28:31], a[24:27], a[0:3], v[28:31]
    ds_read_b128 a[56:59], v19 offset:4096
    v_mfma_f32_16x16x32_bf16 v[32:35], a[28:31], a[0:3], v[32:35]
    ds_read_b128 a[60:63], v19 offset:6144
    v_mfma_f32_16x16x32_bf16 v[36:39], a[32:35], a[0:3], v[36:39]
    ds_read_b128 a[64:67], v19 offset:8192
    v_mfma_f32_16x16x32_bf16 v[40:43], a[0:3], a[36:39], v[40:43]
    ds_read_b128 a[68:71], v19 offset:0
    v_mfma_f32_16x16x32_bf16 v[44:47], a[0:3], a[40:43], v[44:47]
    ds_read_b64_tr_b16 a[72:73], v20 offset:33792
    v_mfma_f32_16x16x32_bf16 v[120:123], a[44:47], a[0:3], v[120:123]
    ds_read_b64_tr_b16 a[74:75], v20 offset:37632
    v_mfma_f32_16x16x32_bf16 v[48:51], a[20:23], a[4:7], v[48:51]
    ds_read_b64_tr_b16 a[76:77], v20 offset:33832
    v_mfma_f32_16x16x32_bf16 v[52:55], a[24:27], a[4:7], v[52:55]
    ds_read_b64_tr_b16 a[78:79], v20 offset:37672
    v_mfma_f32_16x16x32_bf16 v[56:59], a[28:31], a[4:7], v[56:59]
    ds_read_b64_tr_b16 a[80:81], v20 offset:33952
    v_mfma_f32_16x16x32_bf16 v[60:63], a[32:35], a[4:7], v[60:63]
    ds_read_b64_tr_b16 a[82:83], v20 offset:37792
    v_mfma_f32_16x16x32_bf16 v[64:67], a[4:7], a[36:39], v[64:67]
    ds_read_b64_tr_b16 a[84:85], v20 offset:33992
    v_mfma_f32_16x16x32_bf16 v[68:71], a[4:7], a[40:43], v[68:71]
    ds_read_b64_tr_b16 a[86:87], v20 offset:37832
    v_mfma_f32_16x16x32_bf16 v[124:127], a[44:47], a[4:7], v[124:127]
    ds_read_b64_tr_b16 a[88:89], v20 offset:34112
    v_mfma_f32_16x16x32_bf16 v[72:75], a[20:23], a[8:11], v[72:75]
    ds_read_b64_tr_b16 a[90:91], v20 offset:37952
    v_mfma_f32_16x16x32_bf16 v[76:79], a[24:27], a[8:11], v[76:79]
    ds_read_b64_tr_b16 a[92:93], v20 offset:34152
    v_mfma_f32_16x16x32_bf16 v[80:83], a[28:31], a[8:11], v[80:83]
    ds_read_b64_tr_b16 a[94:95], v20 offset:37992
    v_mfma_f32_16x16x32_bf16 v[84:87], a[32:35], a[8:11], v[84:87]
    ds_read_b64_tr_b16 a[96:97], v21 offset:33792
    v_mfma_f32_16x16x32_bf16 v[88:91], a[8:11], a[36:39], v[88:91]
    ds_read_b64_tr_b16 a[98:99], v21 offset:37632
    v_mfma_f32_16x16x32_bf16 v[92:95], a[8:11], a[40:43], v[92:95]
    ds_read_b64_tr_b16 a[100:101], v21 offset:33952
    v_mfma_f32_16x16x32_bf16 v[128:131], a[44:47], a[8:11], v[128:131]
    ds_read_b64_tr_b16 a[102:103], v21 offset:37792
    v_mfma_f32_16x16x32_bf16 v[96:99], a[20:23], a[12:15], v[96:99]
    v_mfma_f32_16x16x32_bf16 v[100:103], a[24:27], a[12:15], v[100:103]
    v_mfma_f32_16x16x32_bf16 v[104:107], a[28:31], a[12:15], v[104:107]
    v_mfma_f32_16x16x32_bf16 v[108:111], a[32:35], a[12:15], v[108:111]
    v_mfma_f32_16x16x32_bf16 v[112:115], a[12:15], a[36:39], v[112:115]
    v_mfma_f32_16x16x32_bf16 v[116:119], a[12:15], a[40:43], v[116:119]
    v_mfma_f32_16x16x32_bf16 v[132:135], a[44:47], a[12:15], v[132:135]
    v_mfma_f32_16x16x32_bf16 v[136:139], a[48:51], a[0:3], v[136:139]
    v_mfma_f32_16x16x32_bf16 v[140:143], a[48:51], a[4:7], v[140:143]
    v_mfma_f32_16x16x32_bf16 v[144:147], a[28:31], a[16:19], v[144:147]
    v_mfma_f32_16x16x32_bf16 v[148:151], a[32:35], a[16:19], v[148:151]
    v_mfma_f32_16x16x32_bf16 v[152:155], a[48:51], a[16:19], v[152:155]
    s_waitcnt lgkmcnt(0)
    v_mfma_f32_16x16x32_bf16 v[120:123], a[96:99], a[52:55], v[120:123]
    v_mfma_f32_16x16x32_bf16 v[124:127], a[96:99], a[56:59], v[124:127]
    v_mfma_f32_16x16x32_bf16 v[128:131], a[96:99], a[60:63], v[128:131]
    v_mfma_f32_16x16x32_bf16 v[132:135], a[96:99], a[64:67], v[132:135]
    s_nop 4
    v_cvt_pk_bf16_f32 v120, v120, v121
    v_cvt_pk_bf16_f32 v121, v122, v123
    ds_write_b64 v156, v[120:121] offset:512
    v_mfma_f32_16x16x32_bf16 v[136:139], a[100:103], a[52:55], v[136:139]
    v_cvt_pk_bf16_f32 v124, v124, v125
    v_cvt_pk_bf16_f32 v125, v126, v127
    ds_write_b64 v156, v[124:125] offset:1024
    v_mfma_f32_16x16x32_bf16 v[140:143], a[100:103], a[56:59], v[140:143]
    v_cvt_pk_bf16_f32 v128, v128, v129
    v_cvt_pk_bf16_f32 v129, v130, v131
    ds_write_b64 v156, v[128:129] offset:1536
    v_mfma_f32_16x16x32_bf16 v[144:147], a[80:83], a[68:71], v[144:147]
    v_cvt_pk_bf16_f32 v132, v132, v133
    v_cvt_pk_bf16_f32 v133, v134, v135
    ds_write_b64 v156, v[132:133] offset:2048
    v_mfma_f32_16x16x32_bf16 v[148:151], a[84:87], a[68:71], v[148:151]
    v_cvt_pk_bf16_f32 v136, v136, v137
    v_cvt_pk_bf16_f32 v137, v138, v139
    ds_write_b64 v156, v[136:137] offset:5120
    v_mfma_f32_16x16x32_bf16 v[152:155], a[100:103], a[68:71], v[152:155]
    v_cvt_pk_bf16_f32 v140, v140, v141
    v_cvt_pk_bf16_f32 v141, v142, v143
    ds_write_b64 v156, v[140:141] offset:5632
    v_mfma_f32_16x16x32_bf16 v[104:107], a[80:83], a[64:67], v[104:107]
    v_cvt_pk_bf16_f32 v144, v144, v145
    v_cvt_pk_bf16_f32 v145, v146, v147
    ds_write_b64 v156, v[144:145] offset:13824
    v_mfma_f32_16x16x32_bf16 v[108:111], a[84:87], a[64:67], v[108:111]
    v_cvt_pk_bf16_f32 v148, v148, v149
    v_cvt_pk_bf16_f32 v149, v150, v151
    ds_write_b64 v156, v[148:149] offset:14336
    v_mfma_f32_16x16x32_bf16 v[112:115], a[64:67], a[88:91], v[112:115]
    v_cvt_pk_bf16_f32 v152, v152, v153
    v_cvt_pk_bf16_f32 v153, v154, v155
    ds_write_b64 v156, v[152:153] offset:4608
    v_mfma_f32_16x16x32_bf16 v[116:119], a[64:67], a[92:95], v[116:119]
    v_cvt_pk_bf16_f32 v104, v104, v105
    v_cvt_pk_bf16_f32 v105, v106, v107
    ds_write_b64 v156, v[104:105] offset:17920
    v_mfma_f32_16x16x32_bf16 v[32:35], a[80:83], a[52:55], v[32:35]
    v_cvt_pk_bf16_f32 v108, v108, v109
    v_cvt_pk_bf16_f32 v109, v110, v111
    ds_write_b64 v156, v[108:109] offset:18432
    v_mfma_f32_16x16x32_bf16 v[36:39], a[84:87], a[52:55], v[36:39]
    v_cvt_pk_bf16_f32 v166, v112, v113
    v_cvt_pk_bf16_f32 v167, v114, v115
    ds_write_b64 v156, v[166:167] offset:19968
    v_mfma_f32_16x16x32_bf16 v[40:43], a[52:55], a[88:91], v[40:43]
    v_cvt_pk_bf16_f32 v176, v116, v117
    v_cvt_pk_bf16_f32 v177, v118, v119
    ds_write_b64 v156, v[176:177] offset:20480
    v_mfma_f32_16x16x32_bf16 v[44:47], a[52:55], a[92:95], v[44:47]
    v_cvt_pk_bf16_f32 v32, v32, v33
    v_cvt_pk_bf16_f32 v33, v34, v35
    v_mfma_f32_16x16x32_bf16 v[56:59], a[80:83], a[56:59], v[56:59]
    v_cvt_pk_bf16_f32 v36, v36, v37
    v_cvt_pk_bf16_f32 v37, v38, v39
    v_mfma_f32_16x16x32_bf16 v[60:63], a[84:87], a[56:59], v[60:63]
    v_cvt_pk_bf16_f32 v160, v40, v41
    v_cvt_pk_bf16_f32 v161, v42, v43
    v_mfma_f32_16x16x32_bf16 v[64:67], a[56:59], a[88:91], v[64:67]
    v_cvt_pk_bf16_f32 v170, v44, v45
    v_cvt_pk_bf16_f32 v171, v46, v47
    v_mfma_f32_16x16x32_bf16 v[68:71], a[56:59], a[92:95], v[68:71]
    v_cvt_pk_bf16_f32 v56, v56, v57
    v_cvt_pk_bf16_f32 v57, v58, v59
    v_mfma_f32_16x16x32_bf16 v[80:83], a[80:83], a[60:63], v[80:83]
    v_cvt_pk_bf16_f32 v60, v60, v61
    v_cvt_pk_bf16_f32 v61, v62, v63
    v_mfma_f32_16x16x32_bf16 v[84:87], a[84:87], a[60:63], v[84:87]
    v_cvt_pk_bf16_f32 v162, v64, v65
    v_cvt_pk_bf16_f32 v163, v66, v67
    v_mfma_f32_16x16x32_bf16 v[88:91], a[60:63], a[88:91], v[88:91]
    v_cvt_pk_bf16_f32 v172, v68, v69
    v_cvt_pk_bf16_f32 v173, v70, v71
    v_mfma_f32_16x16x32_bf16 v[92:95], a[60:63], a[92:95], v[92:95]
    v_cvt_pk_bf16_f32 v80, v80, v81
    v_cvt_pk_bf16_f32 v81, v82, v83
    s_waitcnt lgkmcnt(0)
    s_barrier
    v_mfma_f32_16x16x32_bf16 v[24:27], a[72:75], a[52:55], v[24:27]
    ds_read_b64 v[214:215], v156 offset:512
    ds_read_b64 v[216:217], v156 offset:1024
    ds_read_b64 v[218:219], v156 offset:1536
    v_mfma_f32_16x16x32_bf16 v[28:31], a[76:79], a[52:55], v[28:31]
    ds_read_b64 v[220:221], v156 offset:2048
    ds_read_b64 v[188:189], v156 offset:13824
    ds_read_b64 v[190:191], v156 offset:4608
    v_mfma_f32_16x16x32_bf16 v[48:51], a[72:75], a[56:59], v[48:51]
    ds_read_b64 v[158:159], v156 offset:15872
    ds_read_b64 v[192:193], v156 offset:14336
    ds_read_b64 v[194:195], v156 offset:4608
    v_mfma_f32_16x16x32_bf16 v[52:55], a[76:79], a[56:59], v[52:55]
    ds_read_b64 v[168:169], v156 offset:16384
    ds_read_b64 v[178:179], v156 offset:9216
    ds_read_b64 v[180:181], v156 offset:9728
    v_mfma_f32_16x16x32_bf16 v[72:75], a[72:75], a[60:63], v[72:75]
    ds_read_b64 v[182:183], v156 offset:10240
    ds_read_b64 v[184:185], v156 offset:10752
    ds_read_b64 v[186:187], v156 offset:11264
    v_mfma_f32_16x16x32_bf16 v[76:79], a[76:79], a[60:63], v[76:79]
    s_waitcnt lgkmcnt(7)
    ds_read_b64 v[106:107], v156 offset:6656
    ds_read_b64 v[110:111], v156 offset:6656
    ds_read_b64 v[34:35], v156 offset:5120
    v_mfma_f32_16x16x32_bf16 v[96:99], a[72:75], a[64:67], v[96:99]
    ds_read_b64 v[38:39], v156 offset:5120
    ds_read_b64 v[58:59], v156 offset:5632
    ds_read_b64 v[62:63], v156 offset:5632
    v_mfma_f32_16x16x32_bf16 v[100:103], a[76:79], a[64:67], v[100:103]
    ds_read_b64 v[82:83], v156 offset:6144
    v_cvt_pk_bf16_f32 v84, v84, v85
    v_cvt_pk_bf16_f32 v85, v86, v87
    ds_read_b64 v[86:87], v156 offset:6144
    v_cvt_pk_bf16_f32 v164, v88, v89
    v_cvt_pk_bf16_f32 v165, v90, v91
    v_cvt_pk_bf16_f32 v174, v92, v93
    v_cvt_pk_bf16_f32 v175, v94, v95
    v_cvt_pk_bf16_f32 v24, v24, v25
    v_cvt_pk_bf16_f32 v25, v26, v27
    v_cvt_pk_bf16_f32 v28, v28, v29
    v_cvt_pk_bf16_f32 v29, v30, v31
    v_cvt_pk_bf16_f32 v48, v48, v49
    v_cvt_pk_bf16_f32 v49, v50, v51
    v_cvt_pk_bf16_f32 v52, v52, v53
    v_cvt_pk_bf16_f32 v53, v54, v55
    v_cvt_pk_bf16_f32 v72, v72, v73
    v_cvt_pk_bf16_f32 v73, v74, v75
    v_cvt_pk_bf16_f32 v76, v76, v77
    v_cvt_pk_bf16_f32 v77, v78, v79
    v_cvt_pk_bf16_f32 v96, v96, v97
    v_cvt_pk_bf16_f32 v97, v98, v99
    v_cvt_pk_bf16_f32 v100, v100, v101
    v_cvt_pk_bf16_f32 v101, v102, v103
    s_waitcnt lgkmcnt(0)
    v_and_b32 v26, v212, v214
    v_and_b32 v27, v212, v215
    v_and_b32 v30, v213, v214
    v_and_b32 v31, v213, v215
    v_and_b32 v50, v212, v216
    v_and_b32 v51, v212, v217
    v_and_b32 v54, v213, v216
    v_and_b32 v55, v213, v217
    v_and_b32 v74, v212, v218
    v_and_b32 v75, v212, v219
    v_and_b32 v78, v213, v218
    v_and_b32 v79, v213, v219
    v_and_b32 v98, v212, v220
    v_and_b32 v99, v212, v221
    v_and_b32 v102, v213, v220
    v_and_b32 v103, v213, v221
    v_mfma_f32_16x16x32_bf16 v[40:43], v[188:191], v[24:27], v[204:207]
    v_mfma_f32_16x16x32_bf16 v[64:67], v[192:195], v[28:31], v[204:207]
    v_mfma_f32_16x16x32_bf16 v[88:91], v[32:35], v[48:51], v[200:203]
    v_mfma_f32_16x16x32_bf16 v[112:115], v[36:39], v[52:55], v[200:203]
    v_mfma_f32_16x16x32_bf16 v[44:47], v[32:35], v[24:27], v[196:199]
    v_mfma_f32_16x16x32_bf16 v[68:71], v[36:39], v[28:31], v[196:199]
    v_mfma_f32_16x16x32_bf16 v[92:95], v[56:59], v[48:51], v[196:199]
    v_mfma_f32_16x16x32_bf16 v[116:119], v[60:63], v[52:55], v[196:199]
    s_nop 4
    v_max_f32 v40, v40, v44
    v_max_f32 v64, v64, v68
    v_max_f32 v88, v88, v92
    v_max_f32 v112, v112, v116
    v_max_f32 v41, v41, v45
    v_max_f32 v65, v65, v69
    v_max_f32 v89, v89, v93
    v_max_f32 v113, v113, v117
    v_max_f32 v42, v42, v46
    v_max_f32 v66, v66, v70
    v_max_f32 v90, v90, v94
    v_max_f32 v114, v114, v118
    v_max_f32 v43, v43, v47
    v_max_f32 v67, v67, v71
    v_max_f32 v91, v91, v95
    v_max_f32 v115, v115, v119
    v_max3_f32 v120, v40, v41, v42
    v_max3_f32 v128, v64, v65, v66
    v_max3_f32 v136, v88, v89, v90
    v_max3_f32 v144, v112, v113, v114
    v_max_f32 v120, v120, v43
    v_max_f32 v128, v128, v67
    v_max_f32 v136, v136, v91
    v_max_f32 v144, v144, v115
    v_mov_b32 v122, v120
    v_mov_b32 v130, v128
    v_mov_b32 v138, v136
    v_mov_b32 v146, v144
    v_permlane16_swap_b32 v120, v122
    v_permlane16_swap_b32 v128, v130
    v_permlane16_swap_b32 v136, v138
    v_permlane16_swap_b32 v144, v146
    v_max_f32 v120, v120, v122
    v_max_f32 v128, v128, v130
    v_max_f32 v136, v136, v138
    v_max_f32 v144, v144, v146
    v_mov_b32 v122, v120
    v_mov_b32 v130, v128
    v_mov_b32 v138, v136
    v_mov_b32 v146, v144
    v_permlane32_swap_b32 v120, v122
    v_permlane32_swap_b32 v128, v130
    v_permlane32_swap_b32 v136, v138
    v_permlane32_swap_b32 v144, v146
    v_max_f32 v120, v120, v122
    v_max_f32 v128, v128, v130
    v_max_f32 v136, v136, v138
    v_max_f32 v144, v144, v146
    v_mul_f32 v120, s62, v120
    v_mul_f32 v128, s62, v128
    v_mul_f32 v136, s62, v136
    v_mul_f32 v144, s62, v144
    v_pk_fma_f32 v[40:41], v[40:41], s[62:63], v[120:121] op_sel_hi:[1,0,0] neg_lo:[0,0,1] neg_hi:[0,0,1]
    v_pk_fma_f32 v[64:65], v[64:65], s[62:63], v[128:129] op_sel_hi:[1,0,0] neg_lo:[0,0,1] neg_hi:[0,0,1]
    v_pk_fma_f32 v[88:89], v[88:89], s[62:63], v[136:137] op_sel_hi:[1,0,0] neg_lo:[0,0,1] neg_hi:[0,0,1]
    v_pk_fma_f32 v[112:113], v[112:113], s[62:63], v[144:145] op_sel_hi:[1,0,0] neg_lo:[0,0,1] neg_hi:[0,0,1]
    v_pk_fma_f32 v[42:43], v[42:43], s[62:63], v[120:121] op_sel_hi:[1,0,0] neg_lo:[0,0,1] neg_hi:[0,0,1]
    v_pk_fma_f32 v[66:67], v[66:67], s[62:63], v[128:129] op_sel_hi:[1,0,0] neg_lo:[0,0,1] neg_hi:[0,0,1]
    v_pk_fma_f32 v[90:91], v[90:91], s[62:63], v[136:137] op_sel_hi:[1,0,0] neg_lo:[0,0,1] neg_hi:[0,0,1]
    v_pk_fma_f32 v[114:115], v[114:115], s[62:63], v[144:145] op_sel_hi:[1,0,0] neg_lo:[0,0,1] neg_hi:[0,0,1]
    v_exp_f32 v40, v40
    v_exp_f32 v64, v64
    v_exp_f32 v88, v88
    v_exp_f32 v112, v112
    v_exp_f32 v41, v41
    v_exp_f32 v65, v65
    v_exp_f32 v89, v89
    v_exp_f32 v113, v113
    v_exp_f32 v42, v42
    v_exp_f32 v66, v66
    v_exp_f32 v90, v90
    v_exp_f32 v114, v114
    v_exp_f32 v43, v43
    v_exp_f32 v67, v67
    v_exp_f32 v91, v91
    v_exp_f32 v115, v115
    v_cvt_pk_bf16_f32 v44, v40, v41
    v_cvt_pk_bf16_f32 v68, v64, v65
    v_cvt_pk_bf16_f32 v92, v88, v89
    v_cvt_pk_bf16_f32 v116, v112, v113
    v_cvt_pk_bf16_f32 v45, v42, v43
    v_cvt_pk_bf16_f32 v69, v66, v67
    v_cvt_pk_bf16_f32 v93, v90, v91
    v_cvt_pk_bf16_f32 v117, v114, v115
    v_and_b32 v40, v222, v44
    v_and_b32 v64, v222, v68
    v_and_b32 v88, v222, v92
    v_and_b32 v112, v222, v116
    v_and_b32 v41, v223, v45
    v_and_b32 v65, v223, v69
    v_and_b32 v89, v223, v93
    v_and_b32 v113, v223, v117
    v_and_b32 v42, v6, v44
    v_and_b32 v66, v6, v68
    v_and_b32 v90, v6, v92
    v_and_b32 v114, v6, v116
    v_and_b32 v43, v7, v45
    v_and_b32 v67, v7, v69
    v_and_b32 v91, v7, v93
    v_and_b32 v115, v7, v117
    v_mfma_f32_16x16x32_bf16 v[124:127], v[208:211], v[40:43], 0
    v_mfma_f32_16x16x32_bf16 v[132:135], v[208:211], v[64:67], 0
    v_mfma_f32_16x16x32_bf16 v[140:143], v[208:211], v[88:91], 0
    v_mfma_f32_16x16x32_bf16 v[148:151], v[208:211], v[112:115], 0
    v_mfma_f32_16x16x32_bf16 v[224:227], v[158:161], v[40:43], 0
    v_mfma_f32_16x16x32_bf16 v[232:235], v[168:171], v[64:67], 0
    v_mfma_f32_16x16x32_bf16 v[240:243], v[160:163], v[88:91], 0
    v_mfma_f32_16x16x32_bf16 v[248:251], v[170:173], v[112:115], 0
    v_mfma_f32_16x16x32_bf16 v[228:231], v[178:181], v[40:43], 0
    v_mfma_f32_16x16x32_bf16 v[236:239], v[178:181], v[64:67], 0
    v_mfma_f32_16x16x32_bf16 v[244:247], v[180:183], v[88:91], 0
    v_mfma_f32_16x16x32_bf16 v[252:255], v[180:183], v[112:115], 0
    v_rcp_f32 v120, v124
    v_rcp_f32 v128, v132
    v_rcp_f32 v136, v140
    v_rcp_f32 v144, v148
    v_pk_mul_f32 v[224:225], v[224:225], v[120:121] op_sel_hi:[1,0]
    v_pk_mul_f32 v[232:233], v[232:233], v[128:129] op_sel_hi:[1,0]
    v_pk_mul_f32 v[240:241], v[240:241], v[136:137] op_sel_hi:[1,0]
    v_pk_mul_f32 v[248:249], v[248:249], v[144:145] op_sel_hi:[1,0]
    v_pk_mul_f32 v[226:227], v[226:227], v[120:121] op_sel_hi:[1,0]
    v_pk_mul_f32 v[234:235], v[234:235], v[128:129] op_sel_hi:[1,0]
    v_pk_mul_f32 v[242:243], v[242:243], v[136:137] op_sel_hi:[1,0]
    v_pk_mul_f32 v[250:251], v[250:251], v[144:145] op_sel_hi:[1,0]
    v_pk_mul_f32 v[228:229], v[228:229], v[120:121] op_sel_hi:[1,0]
    v_pk_mul_f32 v[236:237], v[236:237], v[128:129] op_sel_hi:[1,0]
    v_pk_mul_f32 v[244:245], v[244:245], v[136:137] op_sel_hi:[1,0]
    v_pk_mul_f32 v[252:253], v[252:253], v[144:145] op_sel_hi:[1,0]
    v_pk_mul_f32 v[230:231], v[230:231], v[120:121] op_sel_hi:[1,0]
    v_pk_mul_f32 v[238:239], v[238:239], v[128:129] op_sel_hi:[1,0]
    v_pk_mul_f32 v[246:247], v[246:247], v[136:137] op_sel_hi:[1,0]
    v_pk_mul_f32 v[254:255], v[254:255], v[144:145] op_sel_hi:[1,0]
    v_cvt_pk_bf16_f32 v24, v224, v225
    v_cvt_pk_bf16_f32 v26, v232, v233
    v_cvt_pk_bf16_f32 v48, v240, v241
    v_cvt_pk_bf16_f32 v50, v248, v249
    v_cvt_pk_bf16_f32 v25, v226, v227
    v_cvt_pk_bf16_f32 v27, v234, v235
    v_cvt_pk_bf16_f32 v49, v242, v243
    v_cvt_pk_bf16_f32 v51, v250, v251
    v_cvt_pk_bf16_f32 v228, v228, v229
    v_cvt_pk_bf16_f32 v236, v236, v237
    v_cvt_pk_bf16_f32 v244, v244, v245
    v_cvt_pk_bf16_f32 v252, v252, v253
    v_cvt_pk_bf16_f32 v229, v230, v231
    v_cvt_pk_bf16_f32 v237, v238, v239
    v_cvt_pk_bf16_f32 v245, v246, v247
    v_cvt_pk_bf16_f32 v253, v254, v255
    v_cndmask_b32 v228, v228, v236, s[68:69]
    v_cndmask_b32 v229, v229, v237, s[68:69]
    s_add_u32 s59, s57, 0x0
    buffer_store_dwordx4 v[24:27], v157, s[32:35], s59 offen sc1
    s_add_u32 s60, s58, 0x0
    s_mov_b32 exec_hi, 0
    buffer_store_dwordx2 v[228:229], v157, s[32:35], s60 offen
    s_mov_b64 exec, -1
    v_cndmask_b32 v244, v244, v252, s[68:69]
    v_cndmask_b32 v245, v245, v253, s[68:69]
    s_add_u32 s59, s57, 0x11000
    buffer_store_dwordx4 v[48:51], v157, s[32:35], s59 offen sc1
    s_add_u32 s60, s58, 0x11000
    s_mov_b32 exec_hi, 0
    buffer_store_dwordx2 v[244:245], v157, s[32:35], s60 offen
    s_mov_b64 exec, -1
    v_mfma_f32_16x16x32_bf16 v[40:43], v[56:59], v[72:75], v[200:203]
    v_mfma_f32_16x16x32_bf16 v[64:67], v[60:63], v[76:79], v[200:203]
    v_mfma_f32_16x16x32_bf16 v[88:91], v[80:83], v[96:99], v[200:203]
    v_mfma_f32_16x16x32_bf16 v[112:115], v[84:87], v[100:103], v[200:203]
    v_mfma_f32_16x16x32_bf16 v[44:47], v[80:83], v[72:75], v[196:199]
    v_mfma_f32_16x16x32_bf16 v[68:71], v[84:87], v[76:79], v[196:199]
    v_mfma_f32_16x16x32_bf16 v[92:95], v[104:107], v[96:99], v[196:199]
    v_mfma_f32_16x16x32_bf16 v[116:119], v[108:111], v[100:103], v[196:199]
    s_nop 4
    v_max_f32 v40, v40, v44
    v_max_f32 v64, v64, v68
    v_max_f32 v88, v88, v92
    v_max_f32 v112, v112, v116
    v_max_f32 v41, v41, v45
    v_max_f32 v65, v65, v69
    v_max_f32 v89, v89, v93
    v_max_f32 v113, v113, v117
    v_max_f32 v42, v42, v46
    v_max_f32 v66, v66, v70
    v_max_f32 v90, v90, v94
    v_max_f32 v114, v114, v118
    v_max_f32 v43, v43, v47
    v_max_f32 v67, v67, v71
    v_max_f32 v91, v91, v95
    v_max_f32 v115, v115, v119
    v_max3_f32 v120, v40, v41, v42
    v_max3_f32 v128, v64, v65, v66
    v_max3_f32 v136, v88, v89, v90
    v_max3_f32 v144, v112, v113, v114
    v_max_f32 v120, v120, v43
    v_max_f32 v128, v128, v67
    v_max_f32 v136, v136, v91
    v_max_f32 v144, v144, v115
    v_mov_b32 v122, v120
    v_mov_b32 v130, v128
    v_mov_b32 v138, v136
    v_mov_b32 v146, v144
    v_permlane16_swap_b32 v120, v122
    v_permlane16_swap_b32 v128, v130
    v_permlane16_swap_b32 v136, v138
    v_permlane16_swap_b32 v144, v146
    v_max_f32 v120, v120, v122
    v_max_f32 v128, v128, v130
    v_max_f32 v136, v136, v138
    v_max_f32 v144, v144, v146
    v_mov_b32 v122, v120
    v_mov_b32 v130, v128
    v_mov_b32 v138, v136
    v_mov_b32 v146, v144
    v_permlane32_swap_b32 v120, v122
    v_permlane32_swap_b32 v128, v130
    v_permlane32_swap_b32 v136, v138
    v_permlane32_swap_b32 v144, v146
    v_max_f32 v120, v120, v122
    v_max_f32 v128, v128, v130
    v_max_f32 v136, v136, v138
    v_max_f32 v144, v144, v146
    v_mul_f32 v120, s62, v120
    v_mul_f32 v128, s62, v128
    v_mul_f32 v136, s62, v136
    v_mul_f32 v144, s62, v144
    v_pk_fma_f32 v[40:41], v[40:41], s[62:63], v[120:121] op_sel_hi:[1,0,0] neg_lo:[0,0,1] neg_hi:[0,0,1]
    v_pk_fma_f32 v[64:65], v[64:65], s[62:63], v[128:129] op_sel_hi:[1,0,0] neg_lo:[0,0,1] neg_hi:[0,0,1]
    v_pk_fma_f32 v[88:89], v[88:89], s[62:63], v[136:137] op_sel_hi:[1,0,0] neg_lo:[0,0,1] neg_hi:[0,0,1]
    v_pk_fma_f32 v[112:113], v[112:113], s[62:63], v[144:145] op_sel_hi:[1,0,0] neg_lo:[0,0,1] neg_hi:[0,0,1]
    v_pk_fma_f32 v[42:43], v[42:43], s[62:63], v[120:121] op_sel_hi:[1,0,0] neg_lo:[0,0,1] neg_hi:[0,0,1]
    v_pk_fma_f32 v[66:67], v[66:67], s[62:63], v[128:129] op_sel_hi:[1,0,0] neg_lo:[0,0,1] neg_hi:[0,0,1]
    v_pk_fma_f32 v[90:91], v[90:91], s[62:63], v[136:137] op_sel_hi:[1,0,0] neg_lo:[0,0,1] neg_hi:[0,0,1]
    v_pk_fma_f32 v[114:115], v[114:115], s[62:63], v[144:145] op_sel_hi:[1,0,0] neg_lo:[0,0,1] neg_hi:[0,0,1]
    v_exp_f32 v40, v40
    v_exp_f32 v64, v64
    v_exp_f32 v88, v88
    v_exp_f32 v112, v112
    v_exp_f32 v41, v41
    v_exp_f32 v65, v65
    v_exp_f32 v89, v89
    v_exp_f32 v113, v113
    v_exp_f32 v42, v42
    v_exp_f32 v66, v66
    v_exp_f32 v90, v90
    v_exp_f32 v114, v114
    v_exp_f32 v43, v43
    v_exp_f32 v67, v67
    v_exp_f32 v91, v91
    v_exp_f32 v115, v115
    v_cvt_pk_bf16_f32 v44, v40, v41
    v_cvt_pk_bf16_f32 v68, v64, v65
    v_cvt_pk_bf16_f32 v92, v88, v89
    v_cvt_pk_bf16_f32 v116, v112, v113
    v_cvt_pk_bf16_f32 v45, v42, v43
    v_cvt_pk_bf16_f32 v69, v66, v67
    v_cvt_pk_bf16_f32 v93, v90, v91
    v_cvt_pk_bf16_f32 v117, v114, v115
    v_and_b32 v40, v222, v44
    v_and_b32 v64, v222, v68
    v_and_b32 v88, v222, v92
    v_and_b32 v112, v222, v116
    v_and_b32 v41, v223, v45
    v_and_b32 v65, v223, v69
    v_and_b32 v89, v223, v93
    v_and_b32 v113, v223, v117
    v_and_b32 v42, v6, v44
    v_and_b32 v66, v6, v68
    v_and_b32 v90, v6, v92
    v_and_b32 v114, v6, v116
    v_and_b32 v43, v7, v45
    v_and_b32 v67, v7, v69
    v_and_b32 v91, v7, v93
    v_and_b32 v115, v7, v117
    v_mfma_f32_16x16x32_bf16 v[124:127], v[208:211], v[40:43], 0
    v_mfma_f32_16x16x32_bf16 v[132:135], v[208:211], v[64:67], 0
    v_mfma_f32_16x16x32_bf16 v[140:143], v[208:211], v[88:91], 0
    v_mfma_f32_16x16x32_bf16 v[148:151], v[208:211], v[112:115], 0
    v_mfma_f32_16x16x32_bf16 v[224:227], v[162:165], v[40:43], 0
    v_mfma_f32_16x16x32_bf16 v[232:235], v[172:175], v[64:67], 0
    v_mfma_f32_16x16x32_bf16 v[240:243], v[164:167], v[88:91], 0
    v_mfma_f32_16x16x32_bf16 v[248:251], v[174:177], v[112:115], 0
    v_mfma_f32_16x16x32_bf16 v[228:231], v[182:185], v[40:43], 0
    v_mfma_f32_16x16x32_bf16 v[236:239], v[182:185], v[64:67], 0
    v_mfma_f32_16x16x32_bf16 v[244:247], v[184:187], v[88:91], 0
    v_mfma_f32_16x16x32_bf16 v[252:255], v[184:187], v[112:115], 0
    v_rcp_f32 v120, v124
    v_rcp_f32 v128, v132
    v_rcp_f32 v136, v140
    v_rcp_f32 v144, v148
    v_pk_mul_f32 v[224:225], v[224:225], v[120:121] op_sel_hi:[1,0]
    v_pk_mul_f32 v[232:233], v[232:233], v[128:129] op_sel_hi:[1,0]
    v_pk_mul_f32 v[240:241], v[240:241], v[136:137] op_sel_hi:[1,0]
    v_pk_mul_f32 v[248:249], v[248:249], v[144:145] op_sel_hi:[1,0]
    v_pk_mul_f32 v[226:227], v[226:227], v[120:121] op_sel_hi:[1,0]
    v_pk_mul_f32 v[234:235], v[234:235], v[128:129] op_sel_hi:[1,0]
    v_pk_mul_f32 v[242:243], v[242:243], v[136:137] op_sel_hi:[1,0]
    v_pk_mul_f32 v[250:251], v[250:251], v[144:145] op_sel_hi:[1,0]
    v_pk_mul_f32 v[228:229], v[228:229], v[120:121] op_sel_hi:[1,0]
    v_pk_mul_f32 v[236:237], v[236:237], v[128:129] op_sel_hi:[1,0]
    v_pk_mul_f32 v[244:245], v[244:245], v[136:137] op_sel_hi:[1,0]
    v_pk_mul_f32 v[252:253], v[252:253], v[144:145] op_sel_hi:[1,0]
    v_pk_mul_f32 v[230:231], v[230:231], v[120:121] op_sel_hi:[1,0]
    v_pk_mul_f32 v[238:239], v[238:239], v[128:129] op_sel_hi:[1,0]
    v_pk_mul_f32 v[246:247], v[246:247], v[136:137] op_sel_hi:[1,0]
    v_pk_mul_f32 v[254:255], v[254:255], v[144:145] op_sel_hi:[1,0]
    v_cvt_pk_bf16_f32 v72, v224, v225
    v_cvt_pk_bf16_f32 v74, v232, v233
    v_cvt_pk_bf16_f32 v96, v240, v241
    v_cvt_pk_bf16_f32 v98, v248, v249
    v_cvt_pk_bf16_f32 v73, v226, v227
    v_cvt_pk_bf16_f32 v75, v234, v235
    v_cvt_pk_bf16_f32 v97, v242, v243
    v_cvt_pk_bf16_f32 v99, v250, v251
    v_cvt_pk_bf16_f32 v228, v228, v229
    v_cvt_pk_bf16_f32 v236, v236, v237
    v_cvt_pk_bf16_f32 v244, v244, v245
    v_cvt_pk_bf16_f32 v252, v252, v253
    v_cvt_pk_bf16_f32 v229, v230, v231
    v_cvt_pk_bf16_f32 v237, v238, v239
    v_cvt_pk_bf16_f32 v245, v246, v247
    v_cvt_pk_bf16_f32 v253, v254, v255
    v_cndmask_b32 v228, v228, v236, s[68:69]
    v_cndmask_b32 v229, v229, v237, s[68:69]
    s_add_u32 s59, s57, 0x22000
    buffer_store_dwordx4 v[72:75], v157, s[32:35], s59 offen sc1
    s_add_u32 s60, s58, 0x22000
    s_mov_b32 exec_hi, 0
    buffer_store_dwordx2 v[228:229], v157, s[32:35], s60 offen
    s_mov_b64 exec, -1
    v_cndmask_b32 v244, v244, v252, s[68:69]
    v_cndmask_b32 v245, v245, v253, s[68:69]
    s_add_u32 s59, s57, 0x33000
    buffer_store_dwordx4 v[96:99], v157, s[32:35], s59 offen sc1
    s_add_u32 s60, s58, 0x33000
    s_mov_b32 exec_hi, 0
    buffer_store_dwordx2 v[244:245], v157, s[32:35], s60 offen
    s_mov_b64 exec, -1
    s_endpgm
L_q0_end:
L_q1:
    v_lshrrev_b32 v1, 3, v0
    v_mul_u32_u24 v1, 0xa00, v1
    v_lshrrev_b32 v2, 4, v0
    v_xor_b32 v2, v2, v0
    v_and_b32 v2, 7, v2
    v_lshl_add_u32 v3, v2, 4, v1
    v_xor_b32 v4, 64, v3
    s_lshl_b32 s56, s45, 8
    s_add_u32 s56, s56, s44
    s_mul_i32 s56, s56, 0x500
    s_sub_u32 s57, s56, 0xa000
    s_cmp_eq_u32 s45, 0
    s_cselect_b32 s58, s56, s57
    s_add_u32 s59, s57, 0x14000
    v_add_u32 v12, s59, v3
    s_add_u32 s59, s57, 0x19000
    v_add_u32 v13, s59, v4
    s_add_u32 s59, s57, 0x1e000
    v_add_u32 v14, s59, v3
    s_add_u32 s59, s57, 0x23000
    v_add_u32 v15, s59, v4
    s_mul_i32 s60, s46, 160
    v_add_u32 v1, 0x100, v0
    v_mul_u32_u24 v2, 0x889, v1
    v_lshrrev_b32 v2, 16, v2
    v_mul_u32_u24 v5, 30, v2
    v_sub_u32 v1, v1, v5
    v_mul_u32_u24 v5, 0xcd, v1
    v_lshrrev_b32 v5, 11, v5
    v_mul_u32_u24 v5, 0x460, v5
    v_lshl_add_u32 v1, v1, 4, v5
    v_and_b32 v5, 0x13, v2
    v_and_b32 v6, 4, v2
    v_lshl_or_b32 v5, v6, 1, v5
    v_and_b32 v6, 8, v2
    v_lshrrev_b32 v6, 1, v6
    v_or_b32 v5, v5, v6
    v_mul_u32_u24 v5, 0xf00, v5
    v_add3_u32 v8, v1, v5, s60
    v_add_u32 v1, 0x140, v0
    v_mul_u32_u24 v2, 0x889, v1
    v_lshrrev_b32 v2, 16, v2
    v_mul_u32_u24 v5, 30, v2
    v_sub_u32 v1, v1, v5
    v_mul_u32_u24 v5, 0xcd, v1
    v_lshrrev_b32 v5, 11, v5
    v_mul_u32_u24 v5, 0x460, v5
    v_lshl_add_u32 v1, v1, 4, v5
    v_and_b32 v5, 0x13, v2
    v_and_b32 v6, 4, v2
    v_lshl_or_b32 v5, v6, 1, v5
    v_and_b32 v6, 8, v2
    v_lshrrev_b32 v6, 1, v6
    v_or_b32 v5, v5, v6
    v_mul_u32_u24 v5, 0xf00, v5
    v_add3_u32 v9, v1, v5, s60
    v_add_u32 v1, 0x180, v0
    v_mul_u32_u24 v2, 0x889, v1
    v_lshrrev_b32 v2, 16, v2
    v_mul_u32_u24 v5, 30, v2
    v_sub_u32 v1, v1, v5
    v_mul_u32_u24 v5, 0xcd, v1
    v_lshrrev_b32 v5, 11, v5
    v_mul_u32_u24 v5, 0x460, v5
    v_lshl_add_u32 v1, v1, 4, v5
    v_and_b32 v5, 0x13, v2
    v_and_b32 v6, 4, v2
    v_lshl_or_b32 v5, v6, 1, v5
    v_and_b32 v6, 8, v2
    v_lshrrev_b32 v6, 1, v6
    v_or_b32 v5, v5, v6
    v_mul_u32_u24 v5, 0xf00, v5
    v_add3_u32 v10, v1, v5, s60
    v_add_u32 v1, 0x1c0, v0
    v_mul_u32_u24 v2, 0x889, v1
    v_lshrrev_b32 v2, 16, v2
    v_mul_u32_u24 v5, 30, v2
    v_sub_u32 v1, v1, v5
    v_mul_u32_u24 v5, 0xcd, v1
    v_lshrrev_b32 v5, 11, v5
    v_mul_u32_u24 v5, 0x460, v5
    v_lshl_add_u32 v1, v1, 4, v5
    v_and_b32 v5, 0x13, v2
    v_and_b32 v6, 4, v2
    v_lshl_or_b32 v5, v6, 1, v5
    v_and_b32 v6, 8, v2
    v_lshrrev_b32 v6, 1, v6
    v_or_b32 v5, v5, v6
    v_mul_u32_u24 v5, 0xf00, v5
    v_add3_u32 v11, v1, v5, s60
    s_and_b32 s50, s46, 1
    s_lshl_b32 s50, s50, 1
    s_add_u32 s50, s50, s45
    s_mul_i32 s48, s50, 52
    s_lshr_b32 s48, s48, 8
    s_mul_i32 s48, s48, 5
    s_sub_u32 s50, s50, s48
    s_mul_i32 s50, s50, 32
    s_lshr_b32 s50, s50, 4
    s_mul_i32 s48, s50, 0x3c000
    s_lshl_b32 s50, s50, 7
    s_add_u32 s49, s48, 0x1e000
    s_mov_b32 s51, 0
    s_mov_b32 s55, 0
    s_mov_b32 s52, 0
    s_waitcnt lgkmcnt(0)
    s_mov_b32 s24, s4
    s_mov_b32 s25, s5
    s_mov_b32 s26, 0x280000
    s_mov_b32 s27, 0x20000
    s_mov_b32 s28, s6
    s_mov_b32 s29, s7
    s_mov_b32 s30, 0x258000
    s_mov_b32 s31, 0x20000
    s_mov_b32 s32, s20
    s_mov_b32 s33, s21
    s_mov_b32 s34, 0xc02000
    s_mov_b32 s35, 0x20000
    s_add_u32 m0, s51, 0x1000
    s_nop 0
    buffer_load_dwordx4 v12, s[24:27], s50 offen lds
    s_add_u32 m0, s51, 0x1400
    s_nop 0
    buffer_load_dwordx4 v13, s[24:27], s50 offen lds
    s_add_u32 m0, s51, 0x1800
    s_nop 0
    buffer_load_dwordx4 v14, s[24:27], s50 offen lds
    s_add_u32 m0, s51, 0x1c00
    s_nop 0
    buffer_load_dwordx4 v15, s[24:27], s50 offen lds
    s_add_u32 m0, s51, 0x5800
    s_nop 0
    buffer_load_dwordx4 v8, s[28:31], s48 offen lds
    s_add_u32 m0, s51, 0x5c00
    s_nop 0
    buffer_load_dwordx4 v9, s[28:31], s48 offen lds
    s_add_u32 m0, s51, 0x6000
    s_nop 0
    buffer_load_dwordx4 v10, s[28:31], s48 offen lds
    s_add_u32 m0, s51, 0x6400
    s_nop 0
    buffer_load_dwordx4 v11, s[28:31], s48 offen lds
    s_add_u32 m0, s51, 0x9400
    s_nop 0
    buffer_load_dwordx4 v8, s[28:31], s49 offen lds
    s_add_u32 m0, s51, 0x9800
    s_nop 0
    buffer_load_dwordx4 v9, s[28:31], s49 offen lds
    s_add_u32 m0, s51, 0x9c00
    s_nop 0
    buffer_load_dwordx4 v10, s[28:31], s49 offen lds
    s_add_u32 m0, s51, 0xa000
    s_nop 0
    buffer_load_dwordx4 v11, s[28:31], s49 offen lds
    s_add_u32 s48, s48, 0x3c000
    s_add_u32 s55, s55, 1
    s_add_u32 s50, s50, 0x80
    s_cmp_eq_u32 s50, 0x500
    s_cselect_b32 s50, 0, s50
    s_cselect_b32 s48, 0, s48
    s_cmp_ge_u32 s55, 10
    s_cselect_b32 s50, 0x7f000000, s50
    s_cselect_b32 s48, 0x7f000000, s48
    s_add_u32 s51, s51, 0xc000
    s_cmp_eq_u32 s51, 0x24000
    s_cselect_b32 s51, 0, s51
    s_add_u32 s49, s48, 0x1e000
    s_and_b32 s94, s46, 1
    s_lshl1_add_u32 s94, s45, s94
    s_mul_i32 s92, s94, 256
    s_min_u32 s92, s92, L_q1_end-L_q1_tail-256
    s_getpc_b64 s[90:91]
L_pf3:
    s_add_u32 s92, s92, L_q1_tail-L_pf3
    s_add_u32 s90, s90, s92
    s_addc_u32 s91, s91, 0
    s_load_dword s93, s[90:91], 0
    s_load_dword s93, s[90:91], 64
    s_load_dword s93, s[90:91], 128
    s_load_dword s93, s[90:91], 192
    s_add_u32 m0, s51, 0x1000
    s_nop 0
    buffer_load_dwordx4 v12, s[24:27], s50 offen lds
    v_and_b32 v1, 15, v0
    v_lshrrev_b32 v2, 1, v1
    v_lshrrev_b32 v3, 4, v0
    v_xor_b32 v2, v2, v3
    v_lshlrev_b32 v2, 4, v2
    v_lshl_add_u32 v18, v1, 7, v2
    v_xor_b32 v19, 64, v18
    v_lshrrev_b32 v1, 5, v0
    v_lshlrev_b32 v1, 4, v1
    v_bfe_u32 v2, v0, 4, 1
    v_lshl_add_u32 v1, v2, 2, v1
    v_bfe_u32 v2, v0, 2, 2
    v_add_u32 v1, v1, v2
    v_mul_u32_u24 v1, 0x1e0, v1
    s_add_u32 m0, s51, 0x1400
    s_nop 0
    buffer_load_dwordx4 v13, s[24:27], s50 offen lds
    v_and_b32 v2, 3, v0
    v_lshl_add_u32 v20, v2, 3, v1
    v_mul_u32_u24 v2, 40, v2
    v_add3_u32 v21, v1, v2, 32
    v_mov_b64 v[24:25], 0
    v_mov_b64 v[26:27], 0
    v_mov_b64 v[28:29], 0
    v_mov_b64 v[30:31], 0
    v_mov_b64 v[32:33], 0
    v_mov_b64 v[34:35], 0
    v_mov_b64 v[36:37], 0
    v_mov_b64 v[38:39], 0
    v_mov_b64 v[40:41], 0
    v_mov_b64 v[42:43], 0
    s_add_u32 m0, s51, 0x1800
    s_nop 0
    buffer_load_dwordx4 v14, s[24:27], s50 offen lds
    v_mov_b64 v[44:45], 0
    v_mov_b64 v[46:47], 0
    v_mov_b64 v[48:49], 0
    v_mov_b64 v[50:51], 0
    v_mov_b64 v[52:53], 0
    v_mov_b64 v[54:55], 0
    v_mov_b64 v[56:57], 0
    v_mov_b64 v[58:59], 0
    v_mov_b64 v[60:61], 0
    v_mov_b64 v[62:63], 0
    v_mov_b64 v[64:65], 0
    v_mov_b64 v[66:67], 0
    v_mov_b64 v[68:69], 0
    v_mov_b64 v[70:71], 0
    s_add_u32 m0, s51, 0x1c00
    s_nop 0
    buffer_load_dwordx4 v15, s[24:27], s50 offen lds
    v_mov_b64 v[72:73], 0
    v_mov_b64 v[74:75], 0
    v_mov_b64 v[76:77], 0
    v_mov_b64 v[78:79], 0
    v_mov_b64 v[80:81], 0
    v_mov_b64 v[82:83], 0
    v_mov_b64 v[84:85], 0
    v_mov_b64 v[86:87], 0
    v_mov_b64 v[88:89], 0
    v_mov_b64 v[90:91], 0
    v_mov_b64 v[92:93], 0
    v_mov_b64 v[94:95], 0
    v_mov_b64 v[96:97], 0
    v_mov_b64 v[98:99], 0
    s_add_u32 m0, s51, 0x5800
    s_nop 0
    buffer_load_dwordx4 v8, s[28:31], s48 offen lds
    v_mov_b64 v[100:101], 0
    v_mov_b64 v[102:103], 0
    v_mov_b64 v[104:105], 0
    v_mov_b64 v[106:107], 0
    v_mov_b64 v[108:109], 0
    v_mov_b64 v[110:111], 0
    v_mov_b64 v[112:113], 0
    v_mov_b64 v[114:115], 0
    v_mov_b64 v[116:117], 0
    v_mov_b64 v[118:119], 0
    v_mov_b64 v[120:121], 0
    v_mov_b64 v[122:123], 0
    v_mov_b64 v[124:125], 0
    v_mov_b64 v[126:127], 0
    s_add_u32 m0, s51, 0x5c00
    s_nop 0
    buffer_load_dwordx4 v9, s[28:31], s48 offen lds
    v_mov_b64 v[128:129], 0
    v_mov_b64 v[130:131], 0
    v_mov_b64 v[132:133], 0
    v_mov_b64 v[134:135], 0
    v_mov_b64 v[136:137], 0
    v_mov_b64 v[138:139], 0
    v_mov_b64 v[140:141], 0
    v_mov_b64 v[142:143], 0
    v_mov_b64 v[144:145], 0
    v_mov_b64 v[146:147], 0
    v_mov_b64 v[148:149], 0
    v_mov_b64 v[150:151], 0
    v_mov_b64 v[152:153], 0
    v_mov_b64 v[154:155], 0
    s_add_u32 m0, s51, 0x6000
    s_nop 0
    buffer_load_dwordx4 v10, s[28:31], s48 offen lds
    v_and_b32 v1, 15, v0
    v_lshrrev_b32 v2, 4, v0
    v_lshlrev_b32 v3, 2, v2
    v_sub_u32 v3, v1, v3
    v_mov_b32 v4, 0xf149f2ca
    v_subrev_u32 v5, 0, v3
    v_cmp_gt_u32 vcc, 8, v5
    s_nop 1
    v_cndmask_b32 v196, v4, 0, vcc
    v_cmp_ge_i32 vcc, -9, v5
    s_nop 1
    v_cndmask_b32 v200, v4, 0, vcc
    v_subrev_u32 v5, 1, v3
    v_cmp_gt_u32 vcc, 8, v5
    s_nop 1
    v_cndmask_b32 v197, v4, 0, vcc
    v_cmp_ge_i32 vcc, -9, v5
    s_add_u32 m0, s51, 0x6400
    s_nop 0
    buffer_load_dwordx4 v11, s[28:31], s48 offen lds
    v_cndmask_b32 v201, v4, 0, vcc
    v_subrev_u32 v5, 2, v3
    v_cmp_gt_u32 vcc, 8, v5
    s_nop 1
    v_cndmask_b32 v198, v4, 0, vcc
    v_cmp_ge_i32 vcc, -9, v5
    s_nop 1
    v_cndmask_b32 v202, v4, 0, vcc
    v_subrev_u32 v5, 3, v3
    v_cmp_gt_u32 vcc, 8, v5
    s_nop 1
    v_cndmask_b32 v199, v4, 0, vcc
    v_cmp_ge_i32 vcc, -9, v5
    s_nop 1
    v_cndmask_b32 v203, v4, 0, vcc
    s_cmp_eq_u32 s45, 0
    s_cselect_b64 s[68:69], -1, 0
    v_cndmask_b32 v204, v200, v4, s[68:69]
    s_add_u32 m0, s51, 0x9400
    s_nop 0
    buffer_load_dwordx4 v8, s[28:31], s49 offen lds
    v_cndmask_b32 v205, v201, v4, s[68:69]
    v_cndmask_b32 v206, v202, v4, s[68:69]
    v_cndmask_b32 v207, v203, v4, s[68:69]
    v_mov_b32 v208, 0x3f803f80
    v_mov_b32 v209, 0x3f803f80
    v_mov_b32 v210, 0x3f803f80
    v_mov_b32 v211, 0x3f803f80
    v_cmp_eq_u32 vcc, 2, v2
    s_nop 1
    v_cndmask_b32 v212, 0, -1, vcc
    v_cmp_eq_u32 s[68:69], 3, v2
    s_nop 1
    v_cndmask_b32 v213, 0, -1, s[68:69]
    s_mov_b32 s62, 0x3ea52b5c
    s_mov_b32 s63, 0x3ea52b5c
    s_lshl_b32 s56, s44, 6
    s_add_u32 m0, s51, 0x9800
    s_nop 0
    buffer_load_dwordx4 v9, s[28:31], s49 offen lds
    s_lshl_b32 s57, s45, 3
    s_add_u32 s56, s56, s57
    s_add_u32 s56, s56, 0
    s_mul_i32 s56, s56, 0x11000
    s_lshl_b32 s57, s46, 11
    s_add_u32 s57, s57, s56
    s_add_u32 s57, s57, 1024
    s_lshr_b32 s58, s46, 1
    s_lshl_b32 s58, s58, 10
    s_add_u32 s58, s58, s56
    s_and_b32 s59, s46, 1
    s_lshl_b32 s59, s59, 3
    s_add_u32 s58, s58, s59
    s_add_u32 s58, s58, 16384
    s_add_u32 m0, s51, 0x9c00
    s_nop 0
    buffer_load_dwordx4 v10, s[28:31], s49 offen lds
    v_lshlrev_b32 v157, 4, v0
    s_movk_i32 s59, 0x7fff
    s_lshl1_add_u32 s59, s59, 1
    v_ashrrev_i32 v1, 31, v200
    v_ashrrev_i32 v2, 31, v201
    v_bfi_b32 v1, s59, v1, v2
    v_not_b32 v222, v1
    v_ashrrev_i32 v1, 31, v202
    v_ashrrev_i32 v2, 31, v203
    v_bfi_b32 v1, s59, v1, v2
    v_not_b32 v223, v1
    v_ashrrev_i32 v1, 31, v196
    v_ashrrev_i32 v2, 31, v197
    v_bfi_b32 v1, s59, v1, v2
    s_add_u32 m0, s51, 0xa000
    s_nop 0
    buffer_load_dwordx4 v11, s[28:31], s49 offen lds
    v_not_b32 v6, v1
    v_ashrrev_i32 v1, 31, v198
    v_ashrrev_i32 v2, 31, v199
    v_bfi_b32 v1, s59, v1, v2
    v_not_b32 v7, v1
    v_lshlrev_b32 v156, 3, v0
    v_add_u32 v156, 0x20400, v156
    s_add_u32 s48, s48, 0x3c000
    s_add_u32 s55, s55, 1
    s_add_u32 s50, s50, 0x80
    s_cmp_eq_u32 s50, 0x500
    s_cselect_b32 s50, 0, s50
    s_cselect_b32 s48, 0, s48
    s_cmp_ge_u32 s55, 10
    s_cselect_b32 s50, 0x7f000000, s50
    s_cselect_b32 s48, 0x7f000000, s48
    s_add_u32 s51, s51, 0xc000
    s_cmp_eq_u32 s51, 0x24000
    s_cselect_b32 s51, 0, s51
    s_add_u32 s49, s48, 0x1e000
    s_waitcnt vmcnt(12)
    s_barrier
    ds_read_b128 a[0:3], v18 offset:2048
    ds_read_b128 a[4:7], v18 offset:4096
    ds_read_b128 a[8:11], v18 offset:6144
    ds_read_b128 a[12:15], v18 offset:8192
    ds_read_b128 a[16:19], v18 offset:0
    ds_read_b64_tr_b16 a[20:21], v20 offset:18512
    ds_read_b64_tr_b16 a[22:23], v20 offset:22352
    ds_read_b64_tr_b16 a[24:25], v20 offset:18552
    ds_read_b64_tr_b16 a[26:27], v20 offset:22392
    ds_read_b64_tr_b16 a[28:29], v20 offset:18672
    ds_read_b64_tr_b16 a[30:31], v20 offset:22512
    ds_read_b64_tr_b16 a[32:33], v20 offset:18712
    ds_read_b64_tr_b16 a[34:35], v20 offset:22552
    ds_read_b64_tr_b16 a[36:37], v20 offset:18832
    ds_read_b64_tr_b16 a[38:39], v20 offset:22672
    ds_read_b64_tr_b16 a[40:41], v20 offset:18872
    ds_read_b64_tr_b16 a[42:43], v20 offset:22712
    ds_read_b64_tr_b16 a[44:45], v21 offset:18752
    ds_read_b64_tr_b16 a[46:47], v21 offset:22592
    ds_read_b64_tr_b16 a[48:49], v21 offset:18592
    ds_read_b64_tr_b16 a[50:51], v21 offset:22432
    s_add_u32 m0, s51, 0x1000
    s_nop 0
    buffer_load_dwordx4 v12, s[24:27], s50 offen lds
    s_add_u32 m0, s51, 0x1400
    s_nop 0
    buffer_load_dwordx4 v13, s[24:27], s50 offen lds
    s_add_u32 m0, s51, 0x1800
    s_nop 0
    buffer_load_dwordx4 v14, s[24:27], s50 offen lds
    s_add_u32 m0, s51, 0x1c00
    s_nop 0
    buffer_load_dwordx4 v15, s[24:27], s50 offen lds
    s_add_u32 m0, s51, 0x5800
    s_nop 0
    buffer_load_dwordx4 v8, s[28:31], s48 offen lds
    s_add_u32 m0, s51, 0x5c00
    s_nop 0
    buffer_load_dwordx4 v9, s[28:31], s48 offen lds
    s_mov_b32 s54, 9
L_q1_loop:
    s_waitcnt lgkmcnt(0)
    v_mfma_f32_16x16x32_bf16 v[24:27], a[20:23], a[0:3], v[24:27]
    ds_read_b128 a[52:55], v19 offset:2048
    s_add_u32 m0, s51, 0x6000
    v_mfma_f32_16x16x32_bf16 v[28:31], a[24:27], a[0:3], v[28:31]
    buffer_load_dwordx4 v10, s[28:31], s48 offen lds
    ds_read_b128 a[56:59], v19 offset:4096
    v_mfma_f32_16x16x32_bf16 v[32:35], a[28:31], a[0:3], v[32:35]
    ds_read_b128 a[60:63], v19 offset:6144
    v_mfma_f32_16x16x32_bf16 v[36:39], a[32:35], a[0:3], v[36:39]
    ds_read_b128 a[64:67], v19 offset:8192
    v_mfma_f32_16x16x32_bf16 v[40:43], a[0:3], a[36:39], v[40:43]
    ds_read_b128 a[68:71], v19 offset:0
    s_add_u32 m0, s51, 0x6400
    v_mfma_f32_16x16x32_bf16 v[44:47], a[0:3], a[40:43], v[44:47]
    buffer_load_dwordx4 v11, s[28:31], s48 offen lds
    ds_read_b64_tr_b16 a[72:73], v20 offset:33872
    v_mfma_f32_16x16x32_bf16 v[120:123], a[0:3], a[44:47], v[120:123]
    ds_read_b64_tr_b16 a[74:75], v20 offset:37712
    v_mfma_f32_16x16x32_bf16 v[48:51], a[20:23], a[4:7], v[48:51]
    ds_read_b64_tr_b16 a[76:77], v20 offset:33912
    v_mfma_f32_16x16x32_bf16 v[52:55], a[24:27], a[4:7], v[52:55]
    ds_read_b64_tr_b16 a[78:79], v20 offset:37752
    s_add_u32 m0, s51, 0x9400
    v_mfma_f32_16x16x32_bf16 v[56:59], a[28:31], a[4:7], v[56:59]
    buffer_load_dwordx4 v8, s[28:31], s49 offen lds
    ds_read_b64_tr_b16 a[80:81], v20 offset:34032
    v_mfma_f32_16x16x32_bf16 v[60:63], a[32:35], a[4:7], v[60:63]
    ds_read_b64_tr_b16 a[82:83], v20 offset:37872
    v_mfma_f32_16x16x32_bf16 v[64:67], a[4:7], a[36:39], v[64:67]
    ds_read_b64_tr_b16 a[84:85], v20 offset:34072
    v_mfma_f32_16x16x32_bf16 v[68:71], a[4:7], a[40:43], v[68:71]
    ds_read_b64_tr_b16 a[86:87], v20 offset:37912
    s_add_u32 m0, s51, 0x9800
    v_mfma_f32_16x16x32_bf16 v[124:127], a[4:7], a[44:47], v[124:127]
    buffer_load_dwordx4 v9, s[28:31], s49 offen lds
    ds_read_b64_tr_b16 a[88:89], v20 offset:34192
    v_mfma_f32_16x16x32_bf16 v[72:75], a[20:23], a[8:11], v[72:75]
    ds_read_b64_tr_b16 a[90:91], v20 offset:38032
    v_mfma_f32_16x16x32_bf16 v[76:79], a[24:27], a[8:11], v[76:79]
    ds_read_b64_tr_b16 a[92:93], v20 offset:34232
    v_mfma_f32_16x16x32_bf16 v[80:83], a[28:31], a[8:11], v[80:83]
    ds_read_b64_tr_b16 a[94:95], v20 offset:38072
    s_add_u32 m0, s51, 0x9c00
    v_mfma_f32_16x16x32_bf16 v[84:87], a[32:35], a[8:11], v[84:87]
    buffer_load_dwordx4 v10, s[28:31], s49 offen lds
    ds_read_b64_tr_b16 a[96:97], v21 offset:34112
    v_mfma_f32_16x16x32_bf16 v[88:91], a[8:11], a[36:39], v[88:91]
    ds_read_b64_tr_b16 a[98:99], v21 offset:37952
    v_mfma_f32_16x16x32_bf16 v[92:95], a[8:11], a[40:43], v[92:95]
    ds_read_b64_tr_b16 a[100:101], v21 offset:33952
    v_mfma_f32_16x16x32_bf16 v[128:131], a[8:11], a[44:47], v[128:131]
    ds_read_b64_tr_b16 a[102:103], v21 offset:37792
    s_add_u32 m0, s51, 0xa000
    v_mfma_f32_16x16x32_bf16 v[96:99], a[20:23], a[12:15], v[96:99]
    buffer_load_dwordx4 v11, s[28:31], s49 offen lds
    v_mfma_f32_16x16x32_bf16 v[100:103], a[24:27], a[12:15], v[100:103]
    s_add_u32 s70, s52, 0xc000
    s_cmp_eq_u32 s70, 0x24000
    s_cselect_b32 s70, 0, s70
    s_sub_u32 s53, s70, s52
    s_mov_b32 s52, s70
    v_mfma_f32_16x16x32_bf16 v[104:107], a[28:31], a[12:15], v[104:107]
    v_add_u32 v18, s53, v18
    v_mfma_f32_16x16x32_bf16 v[108:111], a[32:35], a[12:15], v[108:111]
    s_add_u32 s48, s48, 0x3c000
    s_add_u32 s55, s55, 1
    s_add_u32 s50, s50, 0x80
    v_mfma_f32_16x16x32_bf16 v[112:115], a[12:15], a[36:39], v[112:115]
    s_cmp_eq_u32 s50, 0x500
    s_cselect_b32 s50, 0, s50
    s_cselect_b32 s48, 0, s48
    v_mfma_f32_16x16x32_bf16 v[116:119], a[12:15], a[40:43], v[116:119]
    s_cmp_ge_u32 s55, 10
    s_cselect_b32 s50, 0x7f000000, s50
    s_cselect_b32 s48, 0x7f000000, s48
    v_mfma_f32_16x16x32_bf16 v[132:135], a[12:15], a[44:47], v[132:135]
    s_add_u32 s51, s51, 0xc000
    s_cmp_eq_u32 s51, 0x24000
    s_cselect_b32 s51, 0, s51
    v_mfma_f32_16x16x32_bf16 v[136:139], a[48:51], a[8:11], v[136:139]
    s_add_u32 s49, s48, 0x1e000
    v_mfma_f32_16x16x32_bf16 v[140:143], a[48:51], a[12:15], v[140:143]
    v_add_u32 v19, s53, v19
    v_mfma_f32_16x16x32_bf16 v[144:147], a[28:31], a[16:19], v[144:147]
    v_add_u32 v20, s53, v20
    v_add_u32 v21, s53, v21
    v_mfma_f32_16x16x32_bf16 v[148:151], a[32:35], a[16:19], v[148:151]
    v_mfma_f32_16x16x32_bf16 v[152:155], a[16:19], a[44:47], v[152:155]
    s_waitcnt vmcnt(12) lgkmcnt(0)
    s_barrier
    v_mfma_f32_16x16x32_bf16 v[24:27], a[72:75], a[52:55], v[24:27]
    ds_read_b128 a[0:3], v18 offset:2048
    s_add_u32 m0, s51, 0x1000
    v_mfma_f32_16x16x32_bf16 v[28:31], a[76:79], a[52:55], v[28:31]
    buffer_load_dwordx4 v12, s[24:27], s50 offen lds
    ds_read_b128 a[4:7], v18 offset:4096
    v_mfma_f32_16x16x32_bf16 v[32:35], a[80:83], a[52:55], v[32:35]
    ds_read_b128 a[8:11], v18 offset:6144
    v_mfma_f32_16x16x32_bf16 v[36:39], a[84:87], a[52:55], v[36:39]
    ds_read_b128 a[12:15], v18 offset:8192
    v_mfma_f32_16x16x32_bf16 v[40:43], a[52:55], a[88:91], v[40:43]
    ds_read_b128 a[16:19], v18 offset:0
    s_add_u32 m0, s51, 0x1400
    v_mfma_f32_16x16x32_bf16 v[44:47], a[52:55], a[92:95], v[44:47]
    buffer_load_dwordx4 v13, s[24:27], s50 offen lds
    ds_read_b64_tr_b16 a[20:21], v20 offset:18512
    v_mfma_f32_16x16x32_bf16 v[120:123], a[52:55], a[96:99], v[120:123]
    ds_read_b64_tr_b16 a[22:23], v20 offset:22352
    v_mfma_f32_16x16x32_bf16 v[48:51], a[72:75], a[56:59], v[48:51]
    ds_read_b64_tr_b16 a[24:25], v20 offset:18552
    v_mfma_f32_16x16x32_bf16 v[52:55], a[76:79], a[56:59], v[52:55]
    ds_read_b64_tr_b16 a[26:27], v20 offset:22392
    s_add_u32 m0, s51, 0x1800
    v_mfma_f32_16x16x32_bf16 v[56:59], a[80:83], a[56:59], v[56:59]
    buffer_load_dwordx4 v14, s[24:27], s50 offen lds
    ds_read_b64_tr_b16 a[28:29], v20 offset:18672
    v_mfma_f32_16x16x32_bf16 v[60:63], a[84:87], a[56:59], v[60:63]
    ds_read_b64_tr_b16 a[30:31], v20 offset:22512
    v_mfma_f32_16x16x32_bf16 v[64:67], a[56:59], a[88:91], v[64:67]
    ds_read_b64_tr_b16 a[32:33], v20 offset:18712
    v_mfma_f32_16x16x32_bf16 v[68:71], a[56:59], a[92:95], v[68:71]
    ds_read_b64_tr_b16 a[34:35], v20 offset:22552
    s_add_u32 m0, s51, 0x1c00
    v_mfma_f32_16x16x32_bf16 v[124:127], a[56:59], a[96:99], v[124:127]
    buffer_load_dwordx4 v15, s[24:27], s50 offen lds
    ds_read_b64_tr_b16 a[36:37], v20 offset:18832
    v_mfma_f32_16x16x32_bf16 v[72:75], a[72:75], a[60:63], v[72:75]
    ds_read_b64_tr_b16 a[38:39], v20 offset:22672
    v_mfma_f32_16x16x32_bf16 v[76:79], a[76:79], a[60:63], v[76:79]
    ds_read_b64_tr_b16 a[40:41], v20 offset:18872
    v_mfma_f32_16x16x32_bf16 v[80:83], a[80:83], a[60:63], v[80:83]
    ds_read_b64_tr_b16 a[42:43], v20 offset:22712
    s_add_u32 m0, s51, 0x5800
    v_mfma_f32_16x16x32_bf16 v[84:87], a[84:87], a[60:63], v[84:87]
    buffer_load_dwordx4 v8, s[28:31], s48 offen lds
    ds_read_b64_tr_b16 a[44:45], v21 offset:18752
    v_mfma_f32_16x16x32_bf16 v[88:91], a[60:63], a[88:91], v[88:91]
    ds_read_b64_tr_b16 a[46:47], v21 offset:22592
    v_mfma_f32_16x16x32_bf16 v[92:95], a[60:63], a[92:95], v[92:95]
    ds_read_b64_tr_b16 a[48:49], v21 offset:18592
    v_mfma_f32_16x16x32_bf16 v[128:131], a[60:63], a[96:99], v[128:131]
    ds_read_b64_tr_b16 a[50:51], v21 offset:22432
    s_add_u32 m0, s51, 0x5c00
    v_mfma_f32_16x16x32_bf16 v[96:99], a[72:75], a[64:67], v[96:99]
    buffer_load_dwordx4 v9, s[28:31], s48 offen lds
    v_mfma_f32_16x16x32_bf16 v[100:103], a[76:79], a[64:67], v[100:103]
    v_mfma_f32_16x16x32_bf16 v[104:107], a[80:83], a[64:67], v[104:107]
    v_mfma_f32_16x16x32_bf16 v[108:111], a[84:87], a[64:67], v[108:111]
    v_mfma_f32_16x16x32_bf16 v[112:115], a[64:67], a[88:91], v[112:115]
    v_mfma_f32_16x16x32_bf16 v[116:119], a[64:67], a[92:95], v[116:119]
    s_sub_u32 s54, s54, 1
    v_mfma_f32_16x16x32_bf16 v[132:135], a[64:67], a[96:99], v[132:135]
    s_cmp_lg_u32 s54, 0
    v_mfma_f32_16x16x32_bf16 v[136:139], a[100:103], a[60:63], v[136:139]
    v_mfma_f32_16x16x32_bf16 v[140:143], a[100:103], a[64:67], v[140:143]
    v_mfma_f32_16x16x32_bf16 v[144:147], a[80:83], a[68:71], v[144:147]
    v_mfma_f32_16x16x32_bf16 v[148:151], a[84:87], a[68:71], v[148:151]
    v_mfma_f32_16x16x32_bf16 v[152:155], a[68:71], a[96:99], v[152:155]
    s_cbranch_scc1 L_q1_loop
L_q1_tail:
    s_waitcnt lgkmcnt(0)
    v_mfma_f32_16x16x32_bf16 v[24:27], a[20:23], a[0:3], v[24:27]
    ds_read_b128 a[52:55], v19 offset:2048
    v_mfma_f32_16x16x32_bf16 v[28:31], a[24:27], a[0:3], v[28:31]
    ds_read_b128 a[56:59], v19 offset:4096
    v_mfma_f32_16x16x32_bf16 v[32:35], a[28:31], a[0:3], v[32:35]
    ds_read_b128 a[60:63], v19 offset:6144
    v_mfma_f32_16x16x32_bf16 v[36:39], a[32:35], a[0:3], v[36:39]
    ds_read_b128 a[64:67], v19 offset:8192
    v_mfma_f32_16x16x32_bf16 v[40:43], a[0:3], a[36:39], v[40:43]
    ds_read_b128 a[68:71], v19 offset:0
    v_mfma_f32_16x16x32_bf16 v[44:47], a[0:3], a[40:43], v[44:47]
    ds_read_b64_tr_b16 a[72:73], v20 offset:33872
    v_mfma_f32_16x16x32_bf16 v[120:123], a[0:3], a[44:47], v[120:123]
    ds_read_b64_tr_b16 a[74:75], v20 offset:37712
    v_mfma_f32_16x16x32_bf16 v[48:51], a[20:23], a[4:7], v[48:51]
    ds_read_b64_tr_b16 a[76:77], v20 offset:33912
    v_mfma_f32_16x16x32_bf16 v[52:55], a[24:27], a[4:7], v[52:55]
    ds_read_b64_tr_b16 a[78:79], v20 offset:37752
    v_mfma_f32_16x16x32_bf16 v[56:59], a[28:31], a[4:7], v[56:59]
    ds_read_b64_tr_b16 a[80:81], v20 offset:34032
    v_mfma_f32_16x16x32_bf16 v[60:63], a[32:35], a[4:7], v[60:63]
    ds_read_b64_tr_b16 a[82:83], v20 offset:37872
    v_mfma_f32_16x16x32_bf16 v[64:67], a[4:7], a[36:39], v[64:67]
    ds_read_b64_tr_b16 a[84:85], v20 offset:34072
    v_mfma_f32_16x16x32_bf16 v[68:71], a[4:7], a[40:43], v[68:71]
    ds_read_b64_tr_b16 a[86:87], v20 offset:37912
    v_mfma_f32_16x16x32_bf16 v[124:127], a[4:7], a[44:47], v[124:127]
    ds_read_b64_tr_b16 a[88:89], v20 offset:34192
    v_mfma_f32_16x16x32_bf16 v[72:75], a[20:23], a[8:11], v[72:75]
    ds_read_b64_tr_b16 a[90:91], v20 offset:38032
    v_mfma_f32_16x16x32_bf16 v[76:79], a[24:27], a[8:11], v[76:79]
    ds_read_b64_tr_b16 a[92:93], v20 offset:34232
    v_mfma_f32_16x16x32_bf16 v[80:83], a[28:31], a[8:11], v[80:83]
    ds_read_b64_tr_b16 a[94:95], v20 offset:38072
    v_mfma_f32_16x16x32_bf16 v[84:87], a[32:35], a[8:11], v[84:87]
    ds_read_b64_tr_b16 a[96:97], v21 offset:34112
    v_mfma_f32_16x16x32_bf16 v[88:91], a[8:11], a[36:39], v[88:91]
    ds_read_b64_tr_b16 a[98:99], v21 offset:37952
    v_mfma_f32_16x16x32_bf16 v[92:95], a[8:11], a[40:43], v[92:95]
    ds_read_b64_tr_b16 a[100:101], v21 offset:33952
    v_mfma_f32_16x16x32_bf16 v[128:131], a[8:11], a[44:47], v[128:131]
    ds_read_b64_tr_b16 a[102:103], v21 offset:37792
    v_mfma_f32_16x16x32_bf16 v[96:99], a[20:23], a[12:15], v[96:99]
    v_mfma_f32_16x16x32_bf16 v[100:103], a[24:27], a[12:15], v[100:103]
    v_mfma_f32_16x16x32_bf16 v[104:107], a[28:31], a[12:15], v[104:107]
    v_mfma_f32_16x16x32_bf16 v[108:111], a[32:35], a[12:15], v[108:111]
    v_mfma_f32_16x16x32_bf16 v[112:115], a[12:15], a[36:39], v[112:115]
    v_mfma_f32_16x16x32_bf16 v[116:119], a[12:15], a[40:43], v[116:119]
    v_mfma_f32_16x16x32_bf16 v[132:135], a[12:15], a[44:47], v[132:135]
    v_mfma_f32_16x16x32_bf16 v[136:139], a[48:51], a[8:11], v[136:139]
    v_mfma_f32_16x16x32_bf16 v[140:143], a[48:51], a[12:15], v[140:143]
    v_mfma_f32_16x16x32_bf16 v[144:147], a[28:31], a[16:19], v[144:147]
    v_mfma_f32_16x16x32_bf16 v[148:151], a[32:35], a[16:19], v[148:151]
    v_mfma_f32_16x16x32_bf16 v[152:155], a[16:19], a[44:47], v[152:155]
    s_waitcnt lgkmcnt(0)
    v_mfma_f32_16x16x32_bf16 v[120:123], a[52:55], a[96:99], v[120:123]
    v_mfma_f32_16x16x32_bf16 v[124:127], a[56:59], a[96:99], v[124:127]
    v_mfma_f32_16x16x32_bf16 v[128:131], a[60:63], a[96:99], v[128:131]
    v_mfma_f32_16x16x32_bf16 v[132:135], a[64:67], a[96:99], v[132:135]
    s_nop 4
    v_cvt_pk_bf16_f32 v120, v120, v121
    v_cvt_pk_bf16_f32 v121, v122, v123
    ds_write_b64 v156, v[120:121] offset:9728
    v_mfma_f32_16x16x32_bf16 v[136:139], a[100:103], a[60:63], v[136:139]
    v_cvt_pk_bf16_f32 v124, v124, v125
    v_cvt_pk_bf16_f32 v125, v126, v127
    ds_write_b64 v156, v[124:125] offset:10240
    v_mfma_f32_16x16x32_bf16 v[140:143], a[100:103], a[64:67], v[140:143]
    v_cvt_pk_bf16_f32 v128, v128, v129
    v_cvt_pk_bf16_f32 v129, v130, v131
    ds_write_b64 v156, v[128:129] offset:10752
    v_mfma_f32_16x16x32_bf16 v[144:147], a[80:83], a[68:71], v[144:147]
    v_cvt_pk_bf16_f32 v132, v132, v133
    v_cvt_pk_bf16_f32 v133, v134, v135
    ds_write_b64 v156, v[132:133] offset:11264
    v_mfma_f32_16x16x32_bf16 v[148:151], a[84:87], a[68:71], v[148:151]
    v_cvt_pk_bf16_f32 v136, v136, v137
    v_cvt_pk_bf16_f32 v137, v138, v139
    ds_write_b64 v156, v[136:137] offset:6144
    v_mfma_f32_16x16x32_bf16 v[152:155], a[68:71], a[96:99], v[152:155]
    v_cvt_pk_bf16_f32 v140, v140, v141
    v_cvt_pk_bf16_f32 v141, v142, v143
    ds_write_b64 v156, v[140:141] offset:6656
    v_mfma_f32_16x16x32_bf16 v[104:107], a[80:83], a[64:67], v[104:107]
    v_cvt_pk_bf16_f32 v144, v144, v145
    v_cvt_pk_bf16_f32 v145, v146, v147
    ds_write_b64 v156, v[144:145] offset:14848
    v_mfma_f32_16x16x32_bf16 v[108:111], a[84:87], a[64:67], v[108:111]
    v_cvt_pk_bf16_f32 v148, v148, v149
    v_cvt_pk_bf16_f32 v149, v150, v151
    ds_write_b64 v156, v[148:149] offset:15360
    v_mfma_f32_16x16x32_bf16 v[112:115], a[64:67], a[88:91], v[112:115]
    v_cvt_pk_bf16_f32 v152, v152, v153
    v_cvt_pk_bf16_f32 v153, v154, v155
    ds_write_b64 v156, v[152:153] offset:9216
    v_mfma_f32_16x16x32_bf16 v[116:119], a[64:67], a[92:95], v[116:119]
    v_cvt_pk_bf16_f32 v104, v104, v105
    v_cvt_pk_bf16_f32 v105, v106, v107
    ds_write_b64 v156, v[104:105] offset:18944
    v_mfma_f32_16x16x32_bf16 v[32:35], a[80:83], a[52:55], v[32:35]
    v_cvt_pk_bf16_f32 v108, v108, v109
    v_cvt_pk_bf16_f32 v109, v110, v111
    ds_write_b64 v156, v[108:109] offset:19456
    v_mfma_f32_16x16x32_bf16 v[36:39], a[84:87], a[52:55], v[36:39]
    v_cvt_pk_bf16_f32 v166, v112, v113
    v_cvt_pk_bf16_f32 v167, v114, v115
    ds_write_b64 v156, v[166:167] offset:20992
    v_mfma_f32_16x16x32_bf16 v[40:43], a[52:55], a[88:91], v[40:43]
    v_cvt_pk_bf16_f32 v176, v116, v117
    v_cvt_pk_bf16_f32 v177, v118, v119
    ds_write_b64 v156, v[176:177] offset:21504
    v_mfma_f32_16x16x32_bf16 v[44:47], a[52:55], a[92:95], v[44:47]
    v_cvt_pk_bf16_f32 v32, v32, v33
    v_cvt_pk_bf16_f32 v33, v34, v35
    v_mfma_f32_16x16x32_bf16 v[56:59], a[80:83], a[56:59], v[56:59]
    v_cvt_pk_bf16_f32 v36, v36, v37
    v_cvt_pk_bf16_f32 v37, v38, v39
    v_mfma_f32_16x16x32_bf16 v[60:63], a[84:87], a[56:59], v[60:63]
    v_cvt_pk_bf16_f32 v160, v40, v41
    v_cvt_pk_bf16_f32 v161, v42, v43
    v_mfma_f32_16x16x32_bf16 v[64:67], a[56:59], a[88:91], v[64:67]
    v_cvt_pk_bf16_f32 v170, v44, v45
    v_cvt_pk_bf16_f32 v171, v46, v47
    v_mfma_f32_16x16x32_bf16 v[68:71], a[56:59], a[92:95], v[68:71]
    v_cvt_pk_bf16_f32 v56, v56, v57
    v_cvt_pk_bf16_f32 v57, v58, v59
    v_mfma_f32_16x16x32_bf16 v[80:83], a[80:83], a[60:63], v[80:83]
    v_cvt_pk_bf16_f32 v60, v60, v61
    v_cvt_pk_bf16_f32 v61, v62, v63
    v_mfma_f32_16x16x32_bf16 v[84:87], a[84:87], a[60:63], v[84:87]
    v_cvt_pk_bf16_f32 v162, v64, v65
    v_cvt_pk_bf16_f32 v163, v66, v67
    v_mfma_f32_16x16x32_bf16 v[88:91], a[60:63], a[88:91], v[88:91]
    v_cvt_pk_bf16_f32 v172, v68, v69
    v_cvt_pk_bf16_f32 v173, v70, v71
    v_mfma_f32_16x16x32_bf16 v[92:95], a[60:63], a[92:95], v[92:95]
    v_cvt_pk_bf16_f32 v80, v80, v81
    v_cvt_pk_bf16_f32 v81, v82, v83
    s_waitcnt lgkmcnt(0)
    s_barrier
    v_mfma_f32_16x16x32_bf16 v[24:27], a[72:75], a[52:55], v[24:27]
    ds_read_b64 v[214:215], v156 offset:512
    ds_read_b64 v[216:217], v156 offset:1024
    ds_read_b64 v[218:219], v156 offset:1536
    v_mfma_f32_16x16x32_bf16 v[28:31], a[76:79], a[52:55], v[28:31]
    ds_read_b64 v[220:221], v156 offset:2048
    ds_read_b64 v[188:189], v156 offset:14848
    ds_read_b64 v[190:191], v156 offset:4608
    v_mfma_f32_16x16x32_bf16 v[48:51], a[72:75], a[56:59], v[48:51]
    ds_read_b64 v[158:159], v156 offset:16896
    ds_read_b64 v[192:193], v156 offset:15360
    ds_read_b64 v[194:195], v156 offset:4608
    v_mfma_f32_16x16x32_bf16 v[52:55], a[76:79], a[56:59], v[52:55]
    ds_read_b64 v[168:169], v156 offset:17408
    ds_read_b64 v[178:179], v156 offset:9216
    ds_read_b64 v[180:181], v156 offset:9728
    v_mfma_f32_16x16x32_bf16 v[72:75], a[72:75], a[60:63], v[72:75]
    ds_read_b64 v[182:183], v156 offset:10240
    ds_read_b64 v[184:185], v156 offset:10752
    ds_read_b64 v[186:187], v156 offset:11264
    v_mfma_f32_16x16x32_bf16 v[76:79], a[76:79], a[60:63], v[76:79]
    s_waitcnt lgkmcnt(7)
    ds_read_b64 v[106:107], v156 offset:6656
    ds_read_b64 v[110:111], v156 offset:6656
    ds_read_b64 v[34:35], v156 offset:5120
    v_mfma_f32_16x16x32_bf16 v[96:99], a[72:75], a[64:67], v[96:99]
    ds_read_b64 v[38:39], v156 offset:5120
    ds_read_b64 v[58:59], v156 offset:5632
    ds_read_b64 v[62:63], v156 offset:5632
    v_mfma_f32_16x16x32_bf16 v[100:103], a[76:79], a[64:67], v[100:103]
    ds_read_b64 v[82:83], v156 offset:6144
    v_cvt_pk_bf16_f32 v84, v84, v85
    v_cvt_pk_bf16_f32 v85, v86, v87
    ds_read_b64 v[86:87], v156 offset:6144
    v_cvt_pk_bf16_f32 v164, v88, v89
    v_cvt_pk_bf16_f32 v165, v90, v91
    v_cvt_pk_bf16_f32 v174, v92, v93
    v_cvt_pk_bf16_f32 v175, v94, v95
    v_cvt_pk_bf16_f32 v24, v24, v25
    v_cvt_pk_bf16_f32 v25, v26, v27
    v_cvt_pk_bf16_f32 v28, v28, v29
    v_cvt_pk_bf16_f32 v29, v30, v31
    v_cvt_pk_bf16_f32 v48, v48, v49
    v_cvt_pk_bf16_f32 v49, v50, v51
    v_cvt_pk_bf16_f32 v52, v52, v53
    v_cvt_pk_bf16_f32 v53, v54, v55
    v_cvt_pk_bf16_f32 v72, v72, v73
    v_cvt_pk_bf16_f32 v73, v74, v75
    v_cvt_pk_bf16_f32 v76, v76, v77
    v_cvt_pk_bf16_f32 v77, v78, v79
    v_cvt_pk_bf16_f32 v96, v96, v97
    v_cvt_pk_bf16_f32 v97, v98, v99
    v_cvt_pk_bf16_f32 v100, v100, v101
    v_cvt_pk_bf16_f32 v101, v102, v103
    s_waitcnt lgkmcnt(0)
    v_and_b32 v26, v212, v214
    v_and_b32 v27, v212, v215
    v_and_b32 v30, v213, v214
    v_and_b32 v31, v213, v215
    v_and_b32 v50, v212, v216
    v_and_b32 v51, v212, v217
    v_and_b32 v54, v213, v216
    v_and_b32 v55, v213, v217
    v_and_b32 v74, v212, v218
    v_and_b32 v75, v212, v219
    v_and_b32 v78, v213, v218
    v_and_b32 v79, v213, v219
    v_and_b32 v98, v212, v220
    v_and_b32 v99, v212, v221
    v_and_b32 v102, v213, v220
    v_and_b32 v103, v213, v221
    v_mfma_f32_16x16x32_bf16 v[40:43], v[188:191], v[24:27], v[204:207]
    v_mfma_f32_16x16x32_bf16 v[64:67], v[192:195], v[28:31], v[204:207]
    v_mfma_f32_16x16x32_bf16 v[88:91], v[32:35], v[48:51], v[200:203]
    v_mfma_f32_16x16x32_bf16 v[112:115], v[36:39], v[52:55], v[200:203]
    v_mfma_f32_16x16x32_bf16 v[44:47], v[32:35], v[24:27], v[196:199]
    v_mfma_f32_16x16x32_bf16 v[68:71], v[36:39], v[28:31], v[196:199]
    v_mfma_f32_16x16x32_bf16 v[92:95], v[56:59], v[48:51], v[196:199]
    v_mfma_f32_16x16x32_bf16 v[116:119], v[60:63], v[52:55], v[196:199]
    s_nop 4
    v_max_f32 v40, v40, v44
    v_max_f32 v64, v64, v68
    v_max_f32 v88, v88, v92
    v_max_f32 v112, v112, v116
    v_max_f32 v41, v41, v45
    v_max_f32 v65, v65, v69
    v_max_f32 v89, v89, v93
    v_max_f32 v113, v113, v117
    v_max_f32 v42, v42, v46
    v_max_f32 v66, v66, v70
    v_max_f32 v90, v90, v94
    v_max_f32 v114, v114, v118
    v_max_f32 v43, v43, v47
    v_max_f32 v67, v67, v71
    v_max_f32 v91, v91, v95
    v_max_f32 v115, v115, v119
    v_max3_f32 v120, v40, v41, v42
    v_max3_f32 v128, v64, v65, v66
    v_max3_f32 v136, v88, v89, v90
    v_max3_f32 v144, v112, v113, v114
    v_max_f32 v120, v120, v43
    v_max_f32 v128, v128, v67
    v_max_f32 v136, v136, v91
    v_max_f32 v144, v144, v115
    v_mov_b32 v122, v120
    v_mov_b32 v130, v128
    v_mov_b32 v138, v136
    v_mov_b32 v146, v144
    v_permlane16_swap_b32 v120, v122
    v_permlane16_swap_b32 v128, v130
    v_permlane16_swap_b32 v136, v138
    v_permlane16_swap_b32 v144, v146
    v_max_f32 v120, v120, v122
    v_max_f32 v128, v128, v130
    v_max_f32 v136, v136, v138
    v_max_f32 v144, v144, v146
    v_mov_b32 v122, v120
    v_mov_b32 v130, v128
    v_mov_b32 v138, v136
    v_mov_b32 v146, v144
    v_permlane32_swap_b32 v120, v122
    v_permlane32_swap_b32 v128, v130
    v_permlane32_swap_b32 v136, v138
    v_permlane32_swap_b32 v144, v146
    v_max_f32 v120, v120, v122
    v_max_f32 v128, v128, v130
    v_max_f32 v136, v136, v138
    v_max_f32 v144, v144, v146
    v_mul_f32 v120, s62, v120
    v_mul_f32 v128, s62, v128
    v_mul_f32 v136, s62, v136
    v_mul_f32 v144, s62, v144
    v_pk_fma_f32 v[40:41], v[40:41], s[62:63], v[120:121] op_sel_hi:[1,0,0] neg_lo:[0,0,1] neg_hi:[0,0,1]
    v_pk_fma_f32 v[64:65], v[64:65], s[62:63], v[128:129] op_sel_hi:[1,0,0] neg_lo:[0,0,1] neg_hi:[0,0,1]
    v_pk_fma_f32 v[88:89], v[88:89], s[62:63], v[136:137] op_sel_hi:[1,0,0] neg_lo:[0,0,1] neg_hi:[0,0,1]
    v_pk_fma_f32 v[112:113], v[112:113], s[62:63], v[144:145] op_sel_hi:[1,0,0] neg_lo:[0,0,1] neg_hi:[0,0,1]
    v_pk_fma_f32 v[42:43], v[42:43], s[62:63], v[120:121] op_sel_hi:[1,0,0] neg_lo:[0,0,1] neg_hi:[0,0,1]
    v_pk_fma_f32 v[66:67], v[66:67], s[62:63], v[128:129] op_sel_hi:[1,0,0] neg_lo:[0,0,1] neg_hi:[0,0,1]
    v_pk_fma_f32 v[90:91], v[90:91], s[62:63], v[136:137] op_sel_hi:[1,0,0] neg_lo:[0,0,1] neg_hi:[0,0,1]
    v_pk_fma_f32 v[114:115], v[114:115], s[62:63], v[144:145] op_sel_hi:[1,0,0] neg_lo:[0,0,1] neg_hi:[0,0,1]
    v_exp_f32 v40, v40
    v_exp_f32 v64, v64
    v_exp_f32 v88, v88
    v_exp_f32 v112, v112
    v_exp_f32 v41, v41
    v_exp_f32 v65, v65
    v_exp_f32 v89, v89
    v_exp_f32 v113, v113
    v_exp_f32 v42, v42
    v_exp_f32 v66, v66
    v_exp_f32 v90, v90
    v_exp_f32 v114, v114
    v_exp_f32 v43, v43
    v_exp_f32 v67, v67
    v_exp_f32 v91, v91
    v_exp_f32 v115, v115
    v_cvt_pk_bf16_f32 v44, v40, v41
    v_cvt_pk_bf16_f32 v68, v64, v65
    v_cvt_pk_bf16_f32 v92, v88, v89
    v_cvt_pk_bf16_f32 v116, v112, v113
    v_cvt_pk_bf16_f32 v45, v42, v43
    v_cvt_pk_bf16_f32 v69, v66, v67
    v_cvt_pk_bf16_f32 v93, v90, v91
    v_cvt_pk_bf16_f32 v117, v114, v115
    v_and_b32 v40, v222, v44
    v_and_b32 v64, v222, v68
    v_and_b32 v88, v222, v92
    v_and_b32 v112, v222, v116
    v_and_b32 v41, v223, v45
    v_and_b32 v65, v223, v69
    v_and_b32 v89, v223, v93
    v_and_b32 v113, v223, v117
    v_and_b32 v42, v6, v44
    v_and_b32 v66, v6, v68
    v_and_b32 v90, v6, v92
    v_and_b32 v114, v6, v116
    v_and_b32 v43, v7, v45
    v_and_b32 v67, v7, v69
    v_and_b32 v91, v7, v93
    v_and_b32 v115, v7, v117
    v_mfma_f32_16x16x32_bf16 v[124:127], v[208:211], v[40:43], 0
    v_mfma_f32_16x16x32_bf16 v[132:135], v[208:211], v[64:67], 0
    v_mfma_f32_16x16x32_bf16 v[140:143], v[208:211], v[88:91], 0
    v_mfma_f32_16x16x32_bf16 v[148:151], v[208:211], v[112:115], 0
    v_mfma_f32_16x16x32_bf16 v[224:227], v[158:161], v[40:43], 0
    v_mfma_f32_16x16x32_bf16 v[232:235], v[168:171], v[64:67], 0
    v_mfma_f32_16x16x32_bf16 v[240:243], v[160:163], v[88:91], 0
    v_mfma_f32_16x16x32_bf16 v[248:251], v[170:173], v[112:115], 0
    v_mfma_f32_16x16x32_bf16 v[228:231], v[178:181], v[40:43], 0
    v_mfma_f32_16x16x32_bf16 v[236:239], v[178:181], v[64:67], 0
    v_mfma_f32_16x16x32_bf16 v[244:247], v[180:183], v[88:91], 0
    v_mfma_f32_16x16x32_bf16 v[252:255], v[180:183], v[112:115], 0
    v_rcp_f32 v120, v124
    v_rcp_f32 v128, v132
    v_rcp_f32 v136, v140
    v_rcp_f32 v144, v148
    v_pk_mul_f32 v[224:225], v[224:225], v[120:121] op_sel_hi:[1,0]
    v_pk_mul_f32 v[232:233], v[232:233], v[128:129] op_sel_hi:[1,0]
    v_pk_mul_f32 v[240:241], v[240:241], v[136:137] op_sel_hi:[1,0]
    v_pk_mul_f32 v[248:249], v[248:249], v[144:145] op_sel_hi:[1,0]
    v_pk_mul_f32 v[226:227], v[226:227], v[120:121] op_sel_hi:[1,0]
    v_pk_mul_f32 v[234:235], v[234:235], v[128:129] op_sel_hi:[1,0]
    v_pk_mul_f32 v[242:243], v[242:243], v[136:137] op_sel_hi:[1,0]
    v_pk_mul_f32 v[250:251], v[250:251], v[144:145] op_sel_hi:[1,0]
    v_pk_mul_f32 v[228:229], v[228:229], v[120:121] op_sel_hi:[1,0]
    v_pk_mul_f32 v[236:237], v[236:237], v[128:129] op_sel_hi:[1,0]
    v_pk_mul_f32 v[244:245], v[244:245], v[136:137] op_sel_hi:[1,0]
    v_pk_mul_f32 v[252:253], v[252:253], v[144:145] op_sel_hi:[1,0]
    v_pk_mul_f32 v[230:231], v[230:231], v[120:121] op_sel_hi:[1,0]
    v_pk_mul_f32 v[238:239], v[238:239], v[128:129] op_sel_hi:[1,0]
    v_pk_mul_f32 v[246:247], v[246:247], v[136:137] op_sel_hi:[1,0]
    v_pk_mul_f32 v[254:255], v[254:255], v[144:145] op_sel_hi:[1,0]
    v_cvt_pk_bf16_f32 v24, v224, v225
    v_cvt_pk_bf16_f32 v26, v232, v233
    v_cvt_pk_bf16_f32 v48, v240, v241
    v_cvt_pk_bf16_f32 v50, v248, v249
    v_cvt_pk_bf16_f32 v25, v226, v227
    v_cvt_pk_bf16_f32 v27, v234, v235
    v_cvt_pk_bf16_f32 v49, v242, v243
    v_cvt_pk_bf16_f32 v51, v250, v251
    v_cvt_pk_bf16_f32 v228, v228, v229
    v_cvt_pk_bf16_f32 v236, v236, v237
    v_cvt_pk_bf16_f32 v244, v244, v245
    v_cvt_pk_bf16_f32 v252, v252, v253
    v_cvt_pk_bf16_f32 v229, v230, v231
    v_cvt_pk_bf16_f32 v237, v238, v239
    v_cvt_pk_bf16_f32 v245, v246, v247
    v_cvt_pk_bf16_f32 v253, v254, v255
    v_cndmask_b32 v228, v228, v236, s[68:69]
    v_cndmask_b32 v229, v229, v237, s[68:69]
    s_add_u32 s59, s57, 0x0
    buffer_store_dwordx4 v[24:27], v157, s[32:35], s59 offen sc1
    s_add_u32 s60, s58, 0x0
    s_mov_b32 exec_lo, 0
    buffer_store_dwordx2 v[228:229], v157, s[32:35], s60 offen
    s_mov_b64 exec, -1
    v_cndmask_b32 v244, v244, v252, s[68:69]
    v_cndmask_b32 v245, v245, v253, s[68:69]
    s_add_u32 s59, s57, 0x11000
    buffer_store_dwordx4 v[48:51], v157, s[32:35], s59 offen sc1
    s_add_u32 s60, s58, 0x11000
    s_mov_b32 exec_lo, 0
    buffer_store_dwordx2 v[244:245], v157, s[32:35], s60 offen
    s_mov_b64 exec, -1
    v_mfma_f32_16x16x32_bf16 v[40:43], v[56:59], v[72:75], v[200:203]
    v_mfma_f32_16x16x32_bf16 v[64:67], v[60:63], v[76:79], v[200:203]
    v_mfma_f32_16x16x32_bf16 v[88:91], v[80:83], v[96:99], v[200:203]
    v_mfma_f32_16x16x32_bf16 v[112:115], v[84:87], v[100:103], v[200:203]
    v_mfma_f32_16x16x32_bf16 v[44:47], v[80:83], v[72:75], v[196:199]
    v_mfma_f32_16x16x32_bf16 v[68:71], v[84:87], v[76:79], v[196:199]
    v_mfma_f32_16x16x32_bf16 v[92:95], v[104:107], v[96:99], v[196:199]
    v_mfma_f32_16x16x32_bf16 v[116:119], v[108:111], v[100:103], v[196:199]
    s_nop 4
    v_max_f32 v40, v40, v44
    v_max_f32 v64, v64, v68
    v_max_f32 v88, v88, v92
    v_max_f32 v112, v112, v116
    v_max_f32 v41, v41, v45
    v_max_f32 v65, v65, v69
    v_max_f32 v89, v89, v93
    v_max_f32 v113, v113, v117
    v_max_f32 v42, v42, v46
    v_max_f32 v66, v66, v70
    v_max_f32 v90, v90, v94
    v_max_f32 v114, v114, v118
    v_max_f32 v43, v43, v47
    v_max_f32 v67, v67, v71
    v_max_f32 v91, v91, v95
    v_max_f32 v115, v115, v119
    v_max3_f32 v120, v40, v41, v42
    v_max3_f32 v128, v64, v65, v66
    v_max3_f32 v136, v88, v89, v90
    v_max3_f32 v144, v112, v113, v114
    v_max_f32 v120, v120, v43
    v_max_f32 v128, v128, v67
    v_max_f32 v136, v136, v91
    v_max_f32 v144, v144, v115
    v_mov_b32 v122, v120
    v_mov_b32 v130, v128
    v_mov_b32 v138, v136
    v_mov_b32 v146, v144
    v_permlane16_swap_b32 v120, v122
    v_permlane16_swap_b32 v128, v130
    v_permlane16_swap_b32 v136, v138
    v_permlane16_swap_b32 v144, v146
    v_max_f32 v120, v120, v122
    v_max_f32 v128, v128, v130
    v_max_f32 v136, v136, v138
    v_max_f32 v144, v144, v146
    v_mov_b32 v122, v120
    v_mov_b32 v130, v128
    v_mov_b32 v138, v136
    v_mov_b32 v146, v144
    v_permlane32_swap_b32 v120, v122
    v_permlane32_swap_b32 v128, v130
    v_permlane32_swap_b32 v136, v138
    v_permlane32_swap_b32 v144, v146
    v_max_f32 v120, v120, v122
    v_max_f32 v128, v128, v130
    v_max_f32 v136, v136, v138
    v_max_f32 v144, v144, v146
    v_mul_f32 v120, s62, v120
    v_mul_f32 v128, s62, v128
    v_mul_f32 v136, s62, v136
    v_mul_f32 v144, s62, v144
    v_pk_fma_f32 v[40:41], v[40:41], s[62:63], v[120:121] op_sel_hi:[1,0,0] neg_lo:[0,0,1] neg_hi:[0,0,1]
    v_pk_fma_f32 v[64:65], v[64:65], s[62:63], v[128:129] op_sel_hi:[1,0,0] neg_lo:[0,0,1] neg_hi:[0,0,1]
    v_pk_fma_f32 v[88:89], v[88:89], s[62:63], v[136:137] op_sel_hi:[1,0,0] neg_lo:[0,0,1] neg_hi:[0,0,1]
    v_pk_fma_f32 v[112:113], v[112:113], s[62:63], v[144:145] op_sel_hi:[1,0,0] neg_lo:[0,0,1] neg_hi:[0,0,1]
    v_pk_fma_f32 v[42:43], v[42:43], s[62:63], v[120:121] op_sel_hi:[1,0,0] neg_lo:[0,0,1] neg_hi:[0,0,1]
    v_pk_fma_f32 v[66:67], v[66:67], s[62:63], v[128:129] op_sel_hi:[1,0,0] neg_lo:[0,0,1] neg_hi:[0,0,1]
    v_pk_fma_f32 v[90:91], v[90:91], s[62:63], v[136:137] op_sel_hi:[1,0,0] neg_lo:[0,0,1] neg_hi:[0,0,1]
    v_pk_fma_f32 v[114:115], v[114:115], s[62:63], v[144:145] op_sel_hi:[1,0,0] neg_lo:[0,0,1] neg_hi:[0,0,1]
    v_exp_f32 v40, v40
    v_exp_f32 v64, v64
    v_exp_f32 v88, v88
    v_exp_f32 v112, v112
    v_exp_f32 v41, v41
    v_exp_f32 v65, v65
    v_exp_f32 v89, v89
    v_exp_f32 v113, v113
    v_exp_f32 v42, v42
    v_exp_f32 v66, v66
    v_exp_f32 v90, v90
    v_exp_f32 v114, v114
    v_exp_f32 v43, v43
    v_exp_f32 v67, v67
    v_exp_f32 v91, v91
    v_exp_f32 v115, v115
    v_cvt_pk_bf16_f32 v44, v40, v41
    v_cvt_pk_bf16_f32 v68, v64, v65
    v_cvt_pk_bf16_f32 v92, v88, v89
    v_cvt_pk_bf16_f32 v116, v112, v113
    v_cvt_pk_bf16_f32 v45, v42, v43
    v_cvt_pk_bf16_f32 v69, v66, v67
    v_cvt_pk_bf16_f32 v93, v90, v91
    v_cvt_pk_bf16_f32 v117, v114, v115
    v_and_b32 v40, v222, v44
    v_and_b32 v64, v222, v68
    v_and_b32 v88, v222, v92
    v_and_b32 v112, v222, v116
    v_and_b32 v41, v223, v45
    v_and_b32 v65, v223, v69
    v_and_b32 v89, v223, v93
    v_and_b32 v113, v223, v117
    v_and_b32 v42, v6, v44
    v_and_b32 v66, v6, v68
    v_and_b32 v90, v6, v92
    v_and_b32 v114, v6, v116
    v_and_b32 v43, v7, v45
    v_and_b32 v67, v7, v69
    v_and_b32 v91, v7, v93
    v_and_b32 v115, v7, v117
    v_mfma_f32_16x16x32_bf16 v[124:127], v[208:211], v[40:43], 0
    v_mfma_f32_16x16x32_bf16 v[132:135], v[208:211], v[64:67], 0
    v_mfma_f32_16x16x32_bf16 v[140:143], v[208:211], v[88:91], 0
    v_mfma_f32_16x16x32_bf16 v[148:151], v[208:211], v[112:115], 0
    v_mfma_f32_16x16x32_bf16 v[224:227], v[162:165], v[40:43], 0
    v_mfma_f32_16x16x32_bf16 v[232:235], v[172:175], v[64:67], 0
    v_mfma_f32_16x16x32_bf16 v[240:243], v[164:167], v[88:91], 0
    v_mfma_f32_16x16x32_bf16 v[248:251], v[174:177], v[112:115], 0
    v_mfma_f32_16x16x32_bf16 v[228:231], v[182:185], v[40:43], 0
    v_mfma_f32_16x16x32_bf16 v[236:239], v[182:185], v[64:67], 0
    v_mfma_f32_16x16x32_bf16 v[244:247], v[184:187], v[88:91], 0
    v_mfma_f32_16x16x32_bf16 v[252:255], v[184:187], v[112:115], 0
    v_rcp_f32 v120, v124
    v_rcp_f32 v128, v132
    v_rcp_f32 v136, v140
    v_rcp_f32 v144, v148
    v_pk_mul_f32 v[224:225], v[224:225], v[120:121] op_sel_hi:[1,0]
    v_pk_mul_f32 v[232:233], v[232:233], v[128:129] op_sel_hi:[1,0]
    v_pk_mul_f32 v[240:241], v[240:241], v[136:137] op_sel_hi:[1,0]
    v_pk_mul_f32 v[248:249], v[248:249], v[144:145] op_sel_hi:[1,0]
    v_pk_mul_f32 v[226:227], v[226:227], v[120:121] op_sel_hi:[1,0]
    v_pk_mul_f32 v[234:235], v[234:235], v[128:129] op_sel_hi:[1,0]
    v_pk_mul_f32 v[242:243], v[242:243], v[136:137] op_sel_hi:[1,0]
    v_pk_mul_f32 v[250:251], v[250:251], v[144:145] op_sel_hi:[1,0]
    v_pk_mul_f32 v[228:229], v[228:229], v[120:121] op_sel_hi:[1,0]
    v_pk_mul_f32 v[236:237], v[236:237], v[128:129] op_sel_hi:[1,0]
    v_pk_mul_f32 v[244:245], v[244:245], v[136:137] op_sel_hi:[1,0]
    v_pk_mul_f32 v[252:253], v[252:253], v[144:145] op_sel_hi:[1,0]
    v_pk_mul_f32 v[230:231], v[230:231], v[120:121] op_sel_hi:[1,0]
    v_pk_mul_f32 v[238:239], v[238:239], v[128:129] op_sel_hi:[1,0]
    v_pk_mul_f32 v[246:247], v[246:247], v[136:137] op_sel_hi:[1,0]
    v_pk_mul_f32 v[254:255], v[254:255], v[144:145] op_sel_hi:[1,0]
    v_cvt_pk_bf16_f32 v72, v224, v225
    v_cvt_pk_bf16_f32 v74, v232, v233
    v_cvt_pk_bf16_f32 v96, v240, v241
    v_cvt_pk_bf16_f32 v98, v248, v249
    v_cvt_pk_bf16_f32 v73, v226, v227
    v_cvt_pk_bf16_f32 v75, v234, v235
    v_cvt_pk_bf16_f32 v97, v242, v243
    v_cvt_pk_bf16_f32 v99, v250, v251
    v_cvt_pk_bf16_f32 v228, v228, v229
    v_cvt_pk_bf16_f32 v236, v236, v237
    v_cvt_pk_bf16_f32 v244, v244, v245
    v_cvt_pk_bf16_f32 v252, v252, v253
    v_cvt_pk_bf16_f32 v229, v230, v231
    v_cvt_pk_bf16_f32 v237, v238, v239
    v_cvt_pk_bf16_f32 v245, v246, v247
    v_cvt_pk_bf16_f32 v253, v254, v255
    v_cndmask_b32 v228, v228, v236, s[68:69]
    v_cndmask_b32 v229, v229, v237, s[68:69]
    s_add_u32 s59, s57, 0x22000
    buffer_store_dwordx4 v[72:75], v157, s[32:35], s59 offen sc1
    s_add_u32 s60, s58, 0x22000
    s_mov_b32 exec_lo, 0
    buffer_store_dwordx2 v[228:229], v157, s[32:35], s60 offen
    s_mov_b64 exec, -1
    v_cndmask_b32 v244, v244, v252, s[68:69]
    v_cndmask_b32 v245, v245, v253, s[68:69]
    s_add_u32 s59, s57, 0x33000
    buffer_store_dwordx4 v[96:99], v157, s[32:35], s59 offen sc1
    s_add_u32 s60, s58, 0x33000
    s_mov_b32 exec_lo, 0
    buffer_store_dwordx2 v[244:245], v157, s[32:35], s60 offen
    s_mov_b64 exec, -1
    s_endpgm
L_q1_end:
L_q2:
    v_lshrrev_b32 v1, 3, v0
    v_mul_u32_u24 v1, 0xa00, v1
    v_lshrrev_b32 v2, 4, v0
    v_xor_b32 v2, v2, v0
    v_and_b32 v2, 7, v2
    v_lshl_add_u32 v3, v2, 4, v1
    v_xor_b32 v4, 64, v3
    s_lshl_b32 s56, s45, 8
    s_add_u32 s56, s56, s44
    s_mul_i32 s56, s56, 0x500
    s_sub_u32 s57, s56, 0xa000
    s_cmp_eq_u32 s45, 0
    s_cselect_b32 s58, s56, s57
    s_add_u32 s59, s57, 0x28000
    v_add_u32 v12, s59, v3
    s_add_u32 s59, s57, 0x2d000
    v_add_u32 v13, s59, v4
    s_add_u32 s59, s57, 0x32000
    v_add_u32 v14, s59, v3
    s_add_u32 s59, s57, 0x37000
    v_add_u32 v15, s59, v4
    s_mul_i32 s60, s46, 160
    v_add_u32 v1, 0x200, v0
    v_mul_u32_u24 v2, 0x889, v1
    v_lshrrev_b32 v2, 16, v2
    v_mul_u32_u24 v5, 30, v2
    v_sub_u32 v1, v1, v5
    v_mul_u32_u24 v5, 0xcd, v1
    v_lshrrev_b32 v5, 11, v5
    v_mul_u32_u24 v5, 0x460, v5
    v_lshl_add_u32 v1, v1, 4, v5
    v_and_b32 v5, 0x13, v2
    v_and_b32 v6, 4, v2
    v_lshl_or_b32 v5, v6, 1, v5
    v_and_b32 v6, 8, v2
    v_lshrrev_b32 v6, 1, v6
    v_or_b32 v5, v5, v6
    v_mul_u32_u24 v5, 0xf00, v5
    v_add3_u32 v8, v1, v5, s60
    v_add_u32 v1, 0x240, v0
    v_mul_u32_u24 v2, 0x889, v1
    v_lshrrev_b32 v2, 16, v2
    v_mul_u32_u24 v5, 30, v2
    v_sub_u32 v1, v1, v5
    v_mul_u32_u24 v5, 0xcd, v1
    v_lshrrev_b32 v5, 11, v5
    v_mul_u32_u24 v5, 0x460, v5
    v_lshl_add_u32 v1, v1, 4, v5
    v_and_b32 v5, 0x13, v2
    v_and_b32 v6, 4, v2
    v_lshl_or_b32 v5, v6, 1, v5
    v_and_b32 v6, 8, v2
    v_lshrrev_b32 v6, 1, v6
    v_or_b32 v5, v5, v6
    v_mul_u32_u24 v5, 0xf00, v5
    v_add3_u32 v9, v1, v5, s60
    v_add_u32 v1, 0x280, v0
    v_mul_u32_u24 v2, 0x889, v1
    v_lshrrev_b32 v2, 16, v2
    v_mul_u32_u24 v5, 30, v2
    v_sub_u32 v1, v1, v5
    v_mul_u32_u24 v5, 0xcd, v1
    v_lshrrev_b32 v5, 11, v5
    v_mul_u32_u24 v5, 0x460, v5
    v_lshl_add_u32 v1, v1, 4, v5
    v_and_b32 v5, 0x13, v2
    v_and_b32 v6, 4, v2
    v_lshl_or_b32 v5, v6, 1, v5
    v_and_b32 v6, 8, v2
    v_lshrrev_b32 v6, 1, v6
    v_or_b32 v5, v5, v6
    v_mul_u32_u24 v5, 0xf00, v5
    v_add3_u32 v10, v1, v5, s60
    v_add_u32 v1, 0x2c0, v0
    v_mul_u32_u24 v2, 0x889, v1
    v_lshrrev_b32 v2, 16, v2
    v_mul_u32_u24 v5, 30, v2
    v_sub_u32 v1, v1, v5
    v_mul_u32_u24 v5, 0xcd, v1
    v_lshrrev_b32 v5, 11, v5
    v_mul_u32_u24 v5, 0x460, v5
    v_lshl_add_u32 v1, v1, 4, v5
    v_and_b32 v5, 0x13, v2
    v_and_b32 v6, 4, v2
    v_lshl_or_b32 v5, v6, 1, v5
    v_and_b32 v6, 8, v2
    v_lshrrev_b32 v6, 1, v6
    v_or_b32 v5, v5, v6
    v_mul_u32_u24 v5, 0xf00, v5
    v_add3_u32 v11, v1, v5, s60
    s_and_b32 s50, s46, 1
    s_lshl_b32 s50, s50, 1
    s_add_u32 s50, s50, s45
    s_mul_i32 s48, s50, 52
    s_lshr_b32 s48, s48, 8
    s_mul_i32 s48, s48, 5
    s_sub_u32 s50, s50, s48
    s_mul_i32 s50, s50, 32
    s_lshr_b32 s50, s50, 4
    s_mul_i32 s48, s50, 0x3c000
    s_lshl_b32 s50, s50, 7
    s_add_u32 s49, s48, 0x1e000
    s_mov_b32 s51, 0
    s_mov_b32 s55, 0
    s_mov_b32 s52, 0
    s_waitcnt lgkmcnt(0)
    s_mov_b32 s24, s4
    s_mov_b32 s25, s5
    s_mov_b32 s26, 0x280000
    s_mov_b32 s27, 0x20000
    s_mov_b32 s28, s6
    s_mov_b32 s29, s7
    s_mov_b32 s30, 0x258000
    s_mov_b32 s31, 0x20000
    s_mov_b32 s32, s20
    s_mov_b32 s33, s21
    s_mov_b32 s34, 0xc02000
    s_mov_b32 s35, 0x20000
    s_add_u32 m0, s51, 0x2000
    s_nop 0
    buffer_load_dwordx4 v12, s[24:27], s50 offen lds
    s_add_u32 m0, s51, 0x2400
    s_nop 0
    buffer_load_dwordx4 v13, s[24:27], s50 offen lds
    s_add_u32 m0, s51, 0x2800
    s_nop 0
    buffer_load_dwordx4 v14, s[24:27], s50 offen lds
    s_add_u32 m0, s51, 0x2c00
    s_nop 0
    buffer_load_dwordx4 v15, s[24:27], s50 offen lds
    s_add_u32 m0, s51, 0x6800
    s_nop 0
    buffer_load_dwordx4 v8, s[28:31], s48 offen lds
    s_add_u32 m0, s51, 0x6c00
    s_nop 0
    buffer_load_dwordx4 v9, s[28:31], s48 offen lds
    s_add_u32 m0, s51, 0x7000
    s_nop 0
    buffer_load_dwordx4 v10, s[28:31], s48 offen lds
    s_add_u32 m0, s51, 0x7400
    s_nop 0
    buffer_load_dwordx4 v11, s[28:31], s48 offen lds
    s_add_u32 m0, s51, 0xa400
    s_nop 0
    buffer_load_dwordx4 v8, s[28:31], s49 offen lds
    s_add_u32 m0, s51, 0xa800
    s_nop 0
    buffer_load_dwordx4 v9, s[28:31], s49 offen lds
    s_add_u32 m0, s51, 0xac00
    s_nop 0
    buffer_load_dwordx4 v10, s[28:31], s49 offen lds
    s_add_u32 m0, s51, 0xb000
    s_nop 0
    buffer_load_dwordx4 v11, s[28:31], s49 offen lds
    s_add_u32 s48, s48, 0x3c000
    s_add_u32 s55, s55, 1
    s_add_u32 s50, s50, 0x80
    s_cmp_eq_u32 s50, 0x500
    s_cselect_b32 s50, 0, s50
    s_cselect_b32 s48, 0, s48
    s_cmp_ge_u32 s55, 10
    s_cselect_b32 s50, 0x7f000000, s50
    s_cselect_b32 s48, 0x7f000000, s48
    s_add_u32 s51, s51, 0xc000
    s_cmp_eq_u32 s51, 0x24000
    s_cselect_b32 s51, 0, s51
    s_add_u32 s49, s48, 0x1e000
    s_and_b32 s94, s46, 1
    s_lshl1_add_u32 s94, s45, s94
    s_mul_i32 s92, s94, 256
    s_min_u32 s92, s92, L_q2_end-L_q2_tail-256
    s_getpc_b64 s[90:91]
L_pf4:
    s_add_u32 s92, s92, L_q2_tail-L_pf4
    s_add_u32 s90, s90, s92
    s_addc_u32 s91, s91, 0
    s_load_dword s93, s[90:91], 0
    s_load_dword s93, s[90:91], 64
    s_load_dword s93, s[90:91], 128
    s_load_dword s93, s[90:91], 192
    s_add_u32 m0, s51, 0x2000
    s_nop 0
    buffer_load_dwordx4 v12, s[24:27], s50 offen lds
    v_and_b32 v1, 15, v0
    v_lshrrev_b32 v2, 1, v1
    v_lshrrev_b32 v3, 4, v0
    v_xor_b32 v2, v2, v3
    v_lshlrev_b32 v2, 4, v2
    v_lshl_add_u32 v18, v1, 7, v2
    v_xor_b32 v19, 64, v18
    v_lshrrev_b32 v1, 5, v0
    v_lshlrev_b32 v1, 4, v1
    v_bfe_u32 v2, v0, 4, 1
    v_lshl_add_u32 v1, v2, 2, v1
    v_bfe_u32 v2, v0, 2, 2
    v_add_u32 v1, v1, v2
    s_add_u32 m0, s51, 0x2400
    s_nop 0
    buffer_load_dwordx4 v13, s[24:27], s50 offen lds
    v_mul_u32_u24 v1, 0x1e0, v1
    v_and_b32 v2, 3, v0
    v_lshl_add_u32 v20, v2, 3, v1
    v_mul_u32_u24 v2, 40, v2
    v_add3_u32 v21, v1, v2, 32
    v_mov_b64 v[24:25], 0
    v_mov_b64 v[26:27], 0
    v_mov_b64 v[28:29], 0
    v_mov_b64 v[30:31], 0
    v_mov_b64 v[32:33], 0
    v_mov_b64 v[34:35], 0
    v_mov_b64 v[36:37], 0
    v_mov_b64 v[38:39], 0
    s_add_u32 m0, s51, 0x2800
    s_nop 0
    buffer_load_dwordx4 v14, s[24:27], s50 offen lds
    v_mov_b64 v[40:41], 0
    v_mov_b64 v[42:43], 0
    v_mov_b64 v[44:45], 0
    v_mov_b64 v[46:47], 0
    v_mov_b64 v[48:49], 0
    v_mov_b64 v[50:51], 0
    v_mov_b64 v[52:53], 0
    v_mov_b64 v[54:55], 0
    v_mov_b64 v[56:57], 0
    v_mov_b64 v[58:59], 0
    v_mov_b64 v[60:61], 0
    v_mov_b64 v[62:63], 0
    v_mov_b64 v[64:65], 0
    s_add_u32 m0, s51, 0x2c00
    s_nop 0
    buffer_load_dwordx4 v15, s[24:27], s50 offen lds
    v_mov_b64 v[66:67], 0
    v_mov_b64 v[68:69], 0
    v_mov_b64 v[70:71], 0
    v_mov_b64 v[72:73], 0
    v_mov_b64 v[74:75], 0
    v_mov_b64 v[76:77], 0
    v_mov_b64 v[78:79], 0
    v_mov_b64 v[80:81], 0
    v_mov_b64 v[82:83], 0
    v_mov_b64 v[84:85], 0
    v_mov_b64 v[86:87], 0
    v_mov_b64 v[88:89], 0
    v_mov_b64 v[90:91], 0
    s_add_u32 m0, s51, 0x6800
    s_nop 0
    buffer_load_dwordx4 v8, s[28:31], s48 offen lds
    v_mov_b64 v[92:93], 0
    v_mov_b64 v[94:95], 0
    v_mov_b64 v[96:97], 0
    v_mov_b64 v[98:99], 0
    v_mov_b64 v[100:101], 0
    v_mov_b64 v[102:103], 0
    v_mov_b64 v[104:105], 0
    v_mov_b64 v[106:107], 0
    v_mov_b64 v[108:109], 0
    v_mov_b64 v[110:111], 0
    v_mov_b64 v[112:113], 0
    v_mov_b64 v[114:115], 0
    v_mov_b64 v[116:117], 0
    s_add_u32 m0, s51, 0x6c00
    s_nop 0
    buffer_load_dwordx4 v9, s[28:31], s48 offen lds
    v_mov_b64 v[118:119], 0
    v_mov_b64 v[120:121], 0
    v_mov_b64 v[122:123], 0
    v_mov_b64 v[124:125], 0
    v_mov_b64 v[126:127], 0
    v_mov_b64 v[128:129], 0
    v_mov_b64 v[130:131], 0
    v_mov_b64 v[132:133], 0
    v_mov_b64 v[134:135], 0
    v_mov_b64 v[136:137], 0
    v_mov_b64 v[138:139], 0
    v_mov_b64 v[140:141], 0
    v_mov_b64 v[142:143], 0
    s_add_u32 m0, s51, 0x7000
    s_nop 0
    buffer_load_dwordx4 v10, s[28:31], s48 offen lds
    v_mov_b64 v[144:145], 0
    v_mov_b64 v[146:147], 0
    v_mov_b64 v[148:149], 0
    v_mov_b64 v[150:151], 0
    v_mov_b64 v[152:153], 0
    v_mov_b64 v[154:155], 0
    v_and_b32 v1, 15, v0
    v_lshrrev_b32 v2, 4, v0
    v_lshlrev_b32 v3, 2, v2
    v_sub_u32 v3, v1, v3
    v_mov_b32 v4, 0xf149f2ca
    v_subrev_u32 v5, 0, v3
    v_cmp_gt_u32 vcc, 8, v5
    s_add_u32 m0, s51, 0x7400
    s_nop 0
    buffer_load_dwordx4 v11, s[28:31], s48 offen lds
    v_cndmask_b32 v196, v4, 0, vcc
    v_cmp_ge_i32 vcc, -9, v5
    s_nop 1
    v_cndmask_b32 v200, v4, 0, vcc
    v_subrev_u32 v5, 1, v3
    v_cmp_gt_u32 vcc, 8, v5
    s_nop 1
    v_cndmask_b32 v197, v4, 0, vcc
    v_cmp_ge_i32 vcc, -9, v5
    s_nop 1
    v_cndmask_b32 v201, v4, 0, vcc
    v_subrev_u32 v5, 2, v3
    v_cmp_gt_u32 vcc, 8, v5
    s_nop 1
    v_cndmask_b32 v198, v4, 0, vcc
    v_cmp_ge_i32 vcc, -9, v5
    s_nop 1
    v_cndmask_b32 v202, v4, 0, vcc
    s_add_u32 m0, s51, 0xa400
    s_nop 0
    buffer_load_dwordx4 v8, s[28:31], s49 offen lds
    v_subrev_u32 v5, 3, v3
    v_cmp_gt_u32 vcc, 8, v5
    s_nop 1
    v_cndmask_b32 v199, v4, 0, vcc
    v_cmp_ge_i32 vcc, -9, v5
    s_nop 1
    v_cndmask_b32 v203, v4, 0, vcc
    v_mov_b32 v208, 0x3f803f80
    v_mov_b32 v209, 0x3f803f80
    v_mov_b32 v210, 0x3f803f80
    v_mov_b32 v211, 0x3f803f80
    v_cmp_eq_u32 vcc, 0, v2
    s_nop 1
    v_cndmask_b32 v212, 0, -1, vcc
    v_cmp_eq_u32 s[68:69], 1, v2
    s_nop 1
    v_cndmask_b32 v213, 0, -1, s[68:69]
    s_add_u32 m0, s51, 0xa800
    s_nop 0
    buffer_load_dwordx4 v9, s[28:31], s49 offen lds
    s_mov_b32 s62, 0x3ea52b5c
    s_mov_b32 s63, 0x3ea52b5c
    s_lshl_b32 s56, s44, 6
    s_lshl_b32 s57, s45, 3
    s_add_u32 s56, s56, s57
    s_add_u32 s56, s56, 4
    s_mul_i32 s56, s56, 0x11000
    s_lshl_b32 s57, s46, 11
    s_add_u32 s57, s57, s56
    s_add_u32 s57, s57, 0
    s_lshr_b32 s58, s46, 1
    s_lshl_b32 s58, s58, 10
    s_add_u32 s58, s58, s56
    s_add_u32 m0, s51, 0xac00
    s_nop 0
    buffer_load_dwordx4 v10, s[28:31], s49 offen lds
    s_and_b32 s59, s46, 1
    s_lshl_b32 s59, s59, 3
    s_add_u32 s58, s58, s59
    s_add_u32 s58, s58, 16384
    v_lshlrev_b32 v157, 4, v0
    s_movk_i32 s59, 0x7fff
    s_lshl1_add_u32 s59, s59, 1
    v_ashrrev_i32 v1, 31, v200
    v_ashrrev_i32 v2, 31, v201
    v_bfi_b32 v1, s59, v1, v2
    v_not_b32 v222, v1
    v_ashrrev_i32 v1, 31, v202
    v_ashrrev_i32 v2, 31, v203
    s_add_u32 m0, s51, 0xb000
    s_nop 0
    buffer_load_dwordx4 v11, s[28:31], s49 offen lds
    v_bfi_b32 v1, s59, v1, v2
    v_not_b32 v223, v1
    v_ashrrev_i32 v1, 31, v196
    v_ashrrev_i32 v2, 31, v197
    v_bfi_b32 v1, s59, v1, v2
    v_not_b32 v6, v1
    v_ashrrev_i32 v1, 31, v198
    v_ashrrev_i32 v2, 31, v199
    v_bfi_b32 v1, s59, v1, v2
    v_not_b32 v7, v1
    v_lshlrev_b32 v156, 3, v0
    v_add_u32 v156, 0x20400, v156
    s_add_u32 s48, s48, 0x3c000
    s_add_u32 s55, s55, 1
    s_add_u32 s50, s50, 0x80
    s_cmp_eq_u32 s50, 0x500
    s_cselect_b32 s50, 0, s50
    s_cselect_b32 s48, 0, s48
    s_cmp_ge_u32 s55, 10
    s_cselect_b32 s50, 0x7f000000, s50
    s_cselect_b32 s48, 0x7f000000, s48
    s_add_u32 s51, s51, 0xc000
    s_cmp_eq_u32 s51, 0x24000
    s_cselect_b32 s51, 0, s51
    s_add_u32 s49, s48, 0x1e000
    s_waitcnt vmcnt(12)
    s_barrier
    ds_read_b128 a[0:3], v18 offset:10240
    ds_read_b128 a[4:7], v18 offset:12288
    ds_read_b128 a[8:11], v18 offset:14336
    ds_read_b128 a[12:15], v18 offset:16384
    ds_read_b128 a[16:19], v18 offset:0
    ds_read_b64_tr_b16 a[20:21], v20 offset:18432
    ds_read_b64_tr_b16 a[22:23], v20 offset:22272
    ds_read_b64_tr_b16 a[24:25], v20 offset:18472
    ds_read_b64_tr_b16 a[26:27], v20 offset:22312
    ds_read_b64_tr_b16 a[28:29], v20 offset:18592
    ds_read_b64_tr_b16 a[30:31], v20 offset:22432
    ds_read_b64_tr_b16 a[32:33], v20 offset:18632
    ds_read_b64_tr_b16 a[34:35], v20 offset:22472
    ds_read_b64_tr_b16 a[36:37], v20 offset:18752
    ds_read_b64_tr_b16 a[38:39], v20 offset:22592
    ds_read_b64_tr_b16 a[40:41], v20 offset:18792
    ds_read_b64_tr_b16 a[42:43], v20 offset:22632
    ds_read_b64_tr_b16 a[44:45], v21 offset:18432
    ds_read_b64_tr_b16 a[46:47], v21 offset:22272
    ds_read_b64_tr_b16 a[48:49], v21 offset:18592
    ds_read_b64_tr_b16 a[50:51], v21 offset:22432
    s_add_u32 m0, s51, 0x2000
    s_nop 0
    buffer_load_dwordx4 v12, s[24:27], s50 offen lds
    s_add_u32 m0, s51, 0x2400
    s_nop 0
    buffer_load_dwordx4 v13, s[24:27], s50 offen lds
    s_add_u32 m0, s51, 0x2800
    s_nop 0
    buffer_load_dwordx4 v14, s[24:27], s50 offen lds
    s_add_u32 m0, s51, 0x2c00
    s_nop 0
    buffer_load_dwordx4 v15, s[24:27], s50 offen lds
    s_add_u32 m0, s51, 0x6800
    s_nop 0
    buffer_load_dwordx4 v8, s[28:31], s48 offen lds
    s_add_u32 m0, s51, 0x6c00
    s_nop 0
    buffer_load_dwordx4 v9, s[28:31], s48 offen lds
    s_mov_b32 s54, 9
L_q2_loop:
    s_waitcnt lgkmcnt(0)
    v_mfma_f32_16x16x32_bf16 v[24:27], a[20:23], a[0:3], v[24:27]
    ds_read_b128 a[52:55], v19 offset:10240
    s_add_u32 m0, s51, 0x7000
    v_mfma_f32_16x16x32_bf16 v[28:31], a[24:27], a[0:3], v[28:31]
    buffer_load_dwordx4 v10, s[28:31], s48 offen lds
    ds_read_b128 a[56:59], v19 offset:12288
    v_mfma_f32_16x16x32_bf16 v[32:35], a[28:31], a[0:3], v[32:35]
    ds_read_b128 a[60:63], v19 offset:14336
    v_mfma_f32_16x16x32_bf16 v[36:39], a[32:35], a[0:3], v[36:39]
    ds_read_b128 a[64:67], v19 offset:16384
    v_mfma_f32_16x16x32_bf16 v[40:43], a[0:3], a[36:39], v[40:43]
    ds_read_b128 a[68:71], v19 offset:0
    s_add_u32 m0, s51, 0x7400
    v_mfma_f32_16x16x32_bf16 v[44:47], a[0:3], a[40:43], v[44:47]
    buffer_load_dwordx4 v11, s[28:31], s48 offen lds
    ds_read_b64_tr_b16 a[72:73], v20 offset:33792
    v_mfma_f32_16x16x32_bf16 v[120:123], a[44:47], a[0:3], v[120:123]
    ds_read_b64_tr_b16 a[74:75], v20 offset:37632
    v_mfma_f32_16x16x32_bf16 v[48:51], a[20:23], a[4:7], v[48:51]
    ds_read_b64_tr_b16 a[76:77], v20 offset:33832
    v_mfma_f32_16x16x32_bf16 v[52:55], a[24:27], a[4:7], v[52:55]
    ds_read_b64_tr_b16 a[78:79], v20 offset:37672
    s_add_u32 m0, s51, 0xa400
    v_mfma_f32_16x16x32_bf16 v[56:59], a[28:31], a[4:7], v[56:59]
    buffer_load_dwordx4 v8, s[28:31], s49 offen lds
    ds_read_b64_tr_b16 a[80:81], v20 offset:33952
    v_mfma_f32_16x16x32_bf16 v[60:63], a[32:35], a[4:7], v[60:63]
    ds_read_b64_tr_b16 a[82:83], v20 offset:37792
    v_mfma_f32_16x16x32_bf16 v[64:67], a[4:7], a[36:39], v[64:67]
    ds_read_b64_tr_b16 a[84:85], v20 offset:33992
    v_mfma_f32_16x16x32_bf16 v[68:71], a[4:7], a[40:43], v[68:71]
    ds_read_b64_tr_b16 a[86:87], v20 offset:37832
    s_add_u32 m0, s51, 0xa800
    v_mfma_f32_16x16x32_bf16 v[124:127], a[44:47], a[4:7], v[124:127]
    buffer_load_dwordx4 v9, s[28:31], s49 offen lds
    ds_read_b64_tr_b16 a[88:89], v20 offset:34112
    v_mfma_f32_16x16x32_bf16 v[72:75], a[20:23], a[8:11], v[72:75]
    ds_read_b64_tr_b16 a[90:91], v20 offset:37952
    v_mfma_f32_16x16x32_bf16 v[76:79], a[24:27], a[8:11], v[76:79]
    ds_read_b64_tr_b16 a[92:93], v20 offset:34152
    v_mfma_f32_16x16x32_bf16 v[80:83], a[28:31], a[8:11], v[80:83]
    ds_read_b64_tr_b16 a[94:95], v20 offset:37992
    s_add_u32 m0, s51, 0xac00
    v_mfma_f32_16x16x32_bf16 v[84:87], a[32:35], a[8:11], v[84:87]
    buffer_load_dwordx4 v10, s[28:31], s49 offen lds
    ds_read_b64_tr_b16 a[96:97], v21 offset:33792
    v_mfma_f32_16x16x32_bf16 v[88:91], a[8:11], a[36:39], v[88:91]
    ds_read_b64_tr_b16 a[98:99], v21 offset:37632
    v_mfma_f32_16x16x32_bf16 v[92:95], a[8:11], a[40:43], v[92:95]
    ds_read_b64_tr_b16 a[100:101], v21 offset:33952
    v_mfma_f32_16x16x32_bf16 v[128:131], a[44:47], a[8:11], v[128:131]
    ds_read_b64_tr_b16 a[102:103], v21 offset:37792
    s_add_u32 m0, s51, 0xb000
    v_mfma_f32_16x16x32_bf16 v[96:99], a[20:23], a[12:15], v[96:99]
    buffer_load_dwordx4 v11, s[28:31], s49 offen lds
    v_mfma_f32_16x16x32_bf16 v[100:103], a[24:27], a[12:15], v[100:103]
    s_add_u32 s70, s52, 0xc000
    s_cmp_eq_u32 s70, 0x24000
    s_cselect_b32 s70, 0, s70
    s_sub_u32 s53, s70, s52
    s_mov_b32 s52, s70
    v_mfma_f32_16x16x32_bf16 v[104:107], a[28:31], a[12:15], v[104:107]
    v_add_u32 v18, s53, v18
    v_mfma_f32_16x16x32_bf16 v[108:111], a[32:35], a[12:15], v[108:111]
    s_add_u32 s48, s48, 0x3c000
    s_add_u32 s55, s55, 1
    s_add_u32 s50, s50, 0x80
    v_mfma_f32_16x16x32_bf16 v[112:115], a[12:15], a[36:39], v[112:115]
    s_cmp_eq_u32 s50, 0x500
    s_cselect_b32 s50, 0, s50
    s_cselect_b32 s48, 0, s48
    v_mfma_f32_16x16x32_bf16 v[116:119], a[12:15], a[40:43], v[116:119]
    s_cmp_ge_u32 s55, 10
    s_cselect_b32 s50, 0x7f000000, s50
    s_cselect_b32 s48, 0x7f000000, s48
    v_mfma_f32_16x16x32_bf16 v[132:135], a[44:47], a[12:15], v[132:135]
    s_add_u32 s51, s51, 0xc000
    s_cmp_eq_u32 s51, 0x24000
    s_cselect_b32 s51, 0, s51
    v_mfma_f32_16x16x32_bf16 v[136:139], a[48:51], a[0:3], v[136:139]
    s_add_u32 s49, s48, 0x1e000
    v_mfma_f32_16x16x32_bf16 v[140:143], a[48:51], a[4:7], v[140:143]
    v_add_u32 v19, s53, v19
    v_mfma_f32_16x16x32_bf16 v[144:147], a[16:19], a[36:39], v[144:147]
    v_add_u32 v20, s53, v20
    v_add_u32 v21, s53, v21
    v_mfma_f32_16x16x32_bf16 v[148:151], a[16:19], a[40:43], v[148:151]
    s_waitcnt vmcnt(12) lgkmcnt(0)
    s_barrier
    v_mfma_f32_16x16x32_bf16 v[24:27], a[72:75], a[52:55], v[24:27]
    ds_read_b128 a[0:3], v18 offset:10240
    s_add_u32 m0, s51, 0x2000
    v_mfma_f32_16x16x32_bf16 v[28:31], a[76:79], a[52:55], v[28:31]
    buffer_load_dwordx4 v12, s[24:27], s50 offen lds
    ds_read_b128 a[4:7], v18 offset:12288
    v_mfma_f32_16x16x32_bf16 v[32:35], a[80:83], a[52:55], v[32:35]
    ds_read_b128 a[8:11], v18 offset:14336
    v_mfma_f32_16x16x32_bf16 v[36:39], a[84:87], a[52:55], v[36:39]
    ds_read_b128 a[12:15], v18 offset:16384
    v_mfma_f32_16x16x32_bf16 v[40:43], a[52:55], a[88:91], v[40:43]
    ds_read_b128 a[16:19], v18 offset:0
    s_add_u32 m0, s51, 0x2400
    v_mfma_f32_16x16x32_bf16 v[44:47], a[52:55], a[92:95], v[44:47]
    buffer_load_dwordx4 v13, s[24:27], s50 offen lds
    ds_read_b64_tr_b16 a[20:21], v20 offset:18432
    v_mfma_f32_16x16x32_bf16 v[120:123], a[96:99], a[52:55], v[120:123]
    ds_read_b64_tr_b16 a[22:23], v20 offset:22272
    v_mfma_f32_16x16x32_bf16 v[48:51], a[72:75], a[56:59], v[48:51]
    ds_read_b64_tr_b16 a[24:25], v20 offset:18472
    v_mfma_f32_16x16x32_bf16 v[52:55], a[76:79], a[56:59], v[52:55]
    ds_read_b64_tr_b16 a[26:27], v20 offset:22312
    s_add_u32 m0, s51, 0x2800
    v_mfma_f32_16x16x32_bf16 v[56:59], a[80:83], a[56:59], v[56:59]
    buffer_load_dwordx4 v14, s[24:27], s50 offen lds
    ds_read_b64_tr_b16 a[28:29], v20 offset:18592
    v_mfma_f32_16x16x32_bf16 v[60:63], a[84:87], a[56:59], v[60:63]
    ds_read_b64_tr_b16 a[30:31], v20 offset:22432
    v_mfma_f32_16x16x32_bf16 v[64:67], a[56:59], a[88:91], v[64:67]
    ds_read_b64_tr_b16 a[32:33], v20 offset:18632
    v_mfma_f32_16x16x32_bf16 v[68:71], a[56:59], a[92:95], v[68:71]
    ds_read_b64_tr_b16 a[34:35], v20 offset:22472
    s_add_u32 m0, s51, 0x2c00
    v_mfma_f32_16x16x32_bf16 v[124:127], a[96:99], a[56:59], v[124:127]
    buffer_load_dwordx4 v15, s[24:27], s50 offen lds
    ds_read_b64_tr_b16 a[36:37], v20 offset:18752
    v_mfma_f32_16x16x32_bf16 v[72:75], a[72:75], a[60:63], v[72:75]
    ds_read_b64_tr_b16 a[38:39], v20 offset:22592
    v_mfma_f32_16x16x32_bf16 v[76:79], a[76:79], a[60:63], v[76:79]
    ds_read_b64_tr_b16 a[40:41], v20 offset:18792
    v_mfma_f32_16x16x32_bf16 v[80:83], a[80:83], a[60:63], v[80:83]
    ds_read_b64_tr_b16 a[42:43], v20 offset:22632
    s_add_u32 m0, s51, 0x6800
    v_mfma_f32_16x16x32_bf16 v[84:87], a[84:87], a[60:63], v[84:87]
    buffer_load_dwordx4 v8, s[28:31], s48 offen lds
    ds_read_b64_tr_b16 a[44:45], v21 offset:18432
    v_mfma_f32_16x16x32_bf16 v[88:91], a[60:63], a[88:91], v[88:91]
    ds_read_b64_tr_b16 a[46:47], v21 offset:22272
    v_mfma_f32_16x16x32_bf16 v[92:95], a[60:63], a[92:95], v[92:95]
    ds_read_b64_tr_b16 a[48:49], v21 offset:18592
    v_mfma_f32_16x16x32_bf16 v[128:131], a[96:99], a[60:63], v[128:131]
    ds_read_b64_tr_b16 a[50:51], v21 offset:22432
    s_add_u32 m0, s51, 0x6c00
    v_mfma_f32_16x16x32_bf16 v[96:99], a[72:75], a[64:67], v[96:99]
    buffer_load_dwordx4 v9, s[28:31], s48 offen lds
    v_mfma_f32_16x16x32_bf16 v[100:103], a[76:79], a[64:67], v[100:103]
    v_mfma_f32_16x16x32_bf16 v[104:107], a[80:83], a[64:67], v[104:107]
    v_mfma_f32_16x16x32_bf16 v[108:111], a[84:87], a[64:67], v[108:111]
    v_mfma_f32_16x16x32_bf16 v[112:115], a[64:67], a[88:91], v[112:115]
    v_mfma_f32_16x16x32_bf16 v[116:119], a[64:67], a[92:95], v[116:119]
    s_sub_u32 s54, s54, 1
    v_mfma_f32_16x16x32_bf16 v[132:135], a[96:99], a[64:67], v[132:135]
    s_cmp_lg_u32 s54, 0
    v_mfma_f32_16x16x32_bf16 v[136:139], a[100:103], a[52:55], v[136:139]
    v_mfma_f32_16x16x32_bf16 v[140:143], a[100:103], a[56:59], v[140:143]
    v_mfma_f32_16x16x32_bf16 v[144:147], a[68:71], a[88:91], v[144:147]
    v_mfma_f32_16x16x32_bf16 v[148:151], a[68:71], a[92:95], v[148:151]
    s_cbranch_scc1 L_q2_loop
L_q2_tail:
    s_waitcnt lgkmcnt(0)
    v_mfma_f32_16x16x32_bf16 v[24:27], a[20:23], a[0:3], v[24:27]
    ds_read_b128 a[52:55], v19 offset:10240
    v_mfma_f32_16x16x32_bf16 v[28:31], a[24:27], a[0:3], v[28:31]
    ds_read_b128 a[56:59], v19 offset:12288
    v_mfma_f32_16x16x32_bf16 v[32:35], a[28:31], a[0:3], v[32:35]
    ds_read_b128 a[60:63], v19 offset:14336
    v_mfma_f32_16x16x32_bf16 v[36:39], a[32:35], a[0:3], v[36:39]
    ds_read_b128 a[64:67], v19 offset:16384
    v_mfma_f32_16x16x32_bf16 v[40:43], a[0:3], a[36:39], v[40:43]
    ds_read_b128 a[68:71], v19 offset:0
    v_mfma_f32_16x16x32_bf16 v[44:47], a[0:3], a[40:43], v[44:47]
    ds_read_b64_tr_b16 a[72:73], v20 offset:33792
    v_mfma_f32_16x16x32_bf16 v[120:123], a[44:47], a[0:3], v[120:123]
    ds_read_b64_tr_b16 a[74:75], v20 offset:37632
    v_mfma_f32_16x16x32_bf16 v[48:51], a[20:23], a[4:7], v[48:51]
    ds_read_b64_tr_b16 a[76:77], v20 offset:33832
    v_mfma_f32_16x16x32_bf16 v[52:55], a[24:27], a[4:7], v[52:55]
    ds_read_b64_tr_b16 a[78:79], v20 offset:37672
    v_mfma_f32_16x16x32_bf16 v[56:59], a[28:31], a[4:7], v[56:59]
    ds_read_b64_tr_b16 a[80:81], v20 offset:33952
    v_mfma_f32_16x16x32_bf16 v[60:63], a[32:35], a[4:7], v[60:63]
    ds_read_b64_tr_b16 a[82:83], v20 offset:37792
    v_mfma_f32_16x16x32_bf16 v[64:67], a[4:7], a[36:39], v[64:67]
    ds_read_b64_tr_b16 a[84:85], v20 offset:33992
    v_mfma_f32_16x16x32_bf16 v[68:71], a[4:7], a[40:43], v[68:71]
    ds_read_b64_tr_b16 a[86:87], v20 offset:37832
    v_mfma_f32_16x16x32_bf16 v[124:127], a[44:47], a[4:7], v[124:127]
    ds_read_b64_tr_b16 a[88:89], v20 offset:34112
    v_mfma_f32_16x16x32_bf16 v[72:75], a[20:23], a[8:11], v[72:75]
    ds_read_b64_tr_b16 a[90:91], v20 offset:37952
    v_mfma_f32_16x16x32_bf16 v[76:79], a[24:27], a[8:11], v[76:79]
    ds_read_b64_tr_b16 a[92:93], v20 offset:34152
    v_mfma_f32_16x16x32_bf16 v[80:83], a[28:31], a[8:11], v[80:83]
    ds_read_b64_tr_b16 a[94:95], v20 offset:37992
    v_mfma_f32_16x16x32_bf16 v[84:87], a[32:35], a[8:11], v[84:87]
    ds_read_b64_tr_b16 a[96:97], v21 offset:33792
    v_mfma_f32_16x16x32_bf16 v[88:91], a[8:11], a[36:39], v[88:91]
    ds_read_b64_tr_b16 a[98:99], v21 offset:37632
    v_mfma_f32_16x16x32_bf16 v[92:95], a[8:11], a[40:43], v[92:95]
    ds_read_b64_tr_b16 a[100:101], v21 offset:33952
    v_mfma_f32_16x16x32_bf16 v[128:131], a[44:47], a[8:11], v[128:131]
    ds_read_b64_tr_b16 a[102:103], v21 offset:37792
    v_mfma_f32_16x16x32_bf16 v[96:99], a[20:23], a[12:15], v[96:99]
    v_mfma_f32_16x16x32_bf16 v[100:103], a[24:27], a[12:15], v[100:103]
    v_mfma_f32_16x16x32_bf16 v[104:107], a[28:31], a[12:15], v[104:107]
    v_mfma_f32_16x16x32_bf16 v[108:111], a[32:35], a[12:15], v[108:111]
    v_mfma_f32_16x16x32_bf16 v[112:115], a[12:15], a[36:39], v[112:115]
    v_mfma_f32_16x16x32_bf16 v[116:119], a[12:15], a[40:43], v[116:119]
    v_mfma_f32_16x16x32_bf16 v[132:135], a[44:47], a[12:15], v[132:135]
    v_mfma_f32_16x16x32_bf16 v[136:139], a[48:51], a[0:3], v[136:139]
    v_mfma_f32_16x16x32_bf16 v[140:143], a[48:51], a[4:7], v[140:143]
    v_mfma_f32_16x16x32_bf16 v[144:147], a[16:19], a[36:39], v[144:147]
    v_mfma_f32_16x16x32_bf16 v[148:151], a[16:19], a[40:43], v[148:151]
    s_waitcnt lgkmcnt(0)
    v_mfma_f32_16x16x32_bf16 v[120:123], a[96:99], a[52:55], v[120:123]
    v_mfma_f32_16x16x32_bf16 v[124:127], a[96:99], a[56:59], v[124:127]
    v_mfma_f32_16x16x32_bf16 v[128:131], a[96:99], a[60:63], v[128:131]
    v_mfma_f32_16x16x32_bf16 v[132:135], a[96:99], a[64:67], v[132:135]
    s_nop 4
    v_cvt_pk_bf16_f32 v120, v120, v121
    v_cvt_pk_bf16_f32 v121, v122, v123
    ds_write_b64 v156, v[120:121] offset:2560
    v_mfma_f32_16x16x32_bf16 v[136:139], a[100:103], a[52:55], v[136:139]
    v_cvt_pk_bf16_f32 v124, v124, v125
    v_cvt_pk_bf16_f32 v125, v126, v127
    ds_write_b64 v156, v[124:125] offset:3072
    v_mfma_f32_16x16x32_bf16 v[140:143], a[100:103], a[56:59], v[140:143]
    v_cvt_pk_bf16_f32 v128, v128, v129
    v_cvt_pk_bf16_f32 v129, v130, v131
    ds_write_b64 v156, v[128:129] offset:3584
    v_mfma_f32_16x16x32_bf16 v[144:147], a[68:71], a[88:91], v[144:147]
    v_cvt_pk_bf16_f32 v132, v132, v133
    v_cvt_pk_bf16_f32 v133, v134, v135
    ds_write_b64 v156, v[132:133] offset:4096
    v_mfma_f32_16x16x32_bf16 v[148:151], a[68:71], a[92:95], v[148:151]
    v_cvt_pk_bf16_f32 v136, v136, v137
    v_cvt_pk_bf16_f32 v137, v138, v139
    ds_write_b64 v156, v[136:137] offset:7168
    v_mfma_f32_16x16x32_bf16 v[104:107], a[80:83], a[64:67], v[104:107]
    v_cvt_pk_bf16_f32 v140, v140, v141
    v_cvt_pk_bf16_f32 v141, v142, v143
    ds_write_b64 v156, v[140:141] offset:7680
    v_mfma_f32_16x16x32_bf16 v[108:111], a[84:87], a[64:67], v[108:111]
    v_cvt_pk_bf16_f32 v144, v144, v145
    v_cvt_pk_bf16_f32 v145, v146, v147
    ds_write_b64 v156, v[144:145] offset:15872
    v_mfma_f32_16x16x32_bf16 v[112:115], a[64:67], a[88:91], v[112:115]
    v_cvt_pk_bf16_f32 v148, v148, v149
    v_cvt_pk_bf16_f32 v149, v150, v151
    ds_write_b64 v156, v[148:149] offset:16384
    v_mfma_f32_16x16x32_bf16 v[116:119], a[64:67], a[92:95], v[116:119]
    v_cvt_pk_bf16_f32 v104, v104, v105
    v_cvt_pk_bf16_f32 v105, v106, v107
    v_mfma_f32_16x16x32_bf16 v[32:35], a[80:83], a[52:55], v[32:35]
    v_cvt_pk_bf16_f32 v108, v108, v109
    v_cvt_pk_bf16_f32 v109, v110, v111
    v_mfma_f32_16x16x32_bf16 v[36:39], a[84:87], a[52:55], v[36:39]
    v_cvt_pk_bf16_f32 v166, v112, v113
    v_cvt_pk_bf16_f32 v167, v114, v115
    v_mfma_f32_16x16x32_bf16 v[40:43], a[52:55], a[88:91], v[40:43]
    v_cvt_pk_bf16_f32 v176, v116, v117
    v_cvt_pk_bf16_f32 v177, v118, v119
    v_mfma_f32_16x16x32_bf16 v[44:47], a[52:55], a[92:95], v[44:47]
    v_cvt_pk_bf16_f32 v32, v32, v33
    v_cvt_pk_bf16_f32 v33, v34, v35
    v_mfma_f32_16x16x32_bf16 v[56:59], a[80:83], a[56:59], v[56:59]
    v_cvt_pk_bf16_f32 v36, v36, v37
    v_cvt_pk_bf16_f32 v37, v38, v39
    v_mfma_f32_16x16x32_bf16 v[60:63], a[84:87], a[56:59], v[60:63]
    v_cvt_pk_bf16_f32 v160, v40, v41
    v_cvt_pk_bf16_f32 v161, v42, v43
    v_mfma_f32_16x16x32_bf16 v[64:67], a[56:59], a[88:91], v[64:67]
    v_cvt_pk_bf16_f32 v170, v44, v45
    v_cvt_pk_bf16_f32 v171, v46, v47
    v_mfma_f32_16x16x32_bf16 v[68:71], a[56:59], a[92:95], v[68:71]
    v_cvt_pk_bf16_f32 v56, v56, v57
    v_cvt_pk_bf16_f32 v57, v58, v59
    v_mfma_f32_16x16x32_bf16 v[80:83], a[80:83], a[60:63], v[80:83]
    v_cvt_pk_bf16_f32 v60, v60, v61
    v_cvt_pk_bf16_f32 v61, v62, v63
    v_mfma_f32_16x16x32_bf16 v[84:87], a[84:87], a[60:63], v[84:87]
    v_cvt_pk_bf16_f32 v162, v64, v65
    v_cvt_pk_bf16_f32 v163, v66, v67
    v_mfma_f32_16x16x32_bf16 v[88:91], a[60:63], a[88:91], v[88:91]
    v_cvt_pk_bf16_f32 v172, v68, v69
    v_cvt_pk_bf16_f32 v173, v70, v71
    v_mfma_f32_16x16x32_bf16 v[92:95], a[60:63], a[92:95], v[92:95]
    v_cvt_pk_bf16_f32 v80, v80, v81
    v_cvt_pk_bf16_f32 v81, v82, v83
    v_mfma_f32_16x16x32_bf16 v[24:27], a[72:75], a[52:55], v[24:27]
    v_cvt_pk_bf16_f32 v84, v84, v85
    v_cvt_pk_bf16_f32 v85, v86, v87
    s_waitcnt lgkmcnt(0)
    s_barrier
    v_mfma_f32_16x16x32_bf16 v[28:31], a[76:79], a[52:55], v[28:31]
    ds_read_b64 v[214:215], v156 offset:2560
    ds_read_b64 v[216:217], v156 offset:3072
    ds_read_b64 v[218:219], v156 offset:3584
    v_mfma_f32_16x16x32_bf16 v[48:51], a[72:75], a[56:59], v[48:51]
    ds_read_b64 v[220:221], v156 offset:4096
    ds_read_b64 v[188:189], v156 offset:17920
    ds_read_b64 v[190:191], v156 offset:6656
    v_mfma_f32_16x16x32_bf16 v[52:55], a[76:79], a[56:59], v[52:55]
    ds_read_b64 v[158:159], v156 offset:19968
    ds_read_b64 v[192:193], v156 offset:18432
    ds_read_b64 v[194:195], v156 offset:6656
    v_mfma_f32_16x16x32_bf16 v[72:75], a[72:75], a[60:63], v[72:75]
    ds_read_b64 v[168:169], v156 offset:20480
    ds_read_b64 v[178:179], v156 offset:11264
    ds_read_b64 v[180:181], v156 offset:11776
    v_mfma_f32_16x16x32_bf16 v[76:79], a[76:79], a[60:63], v[76:79]
    ds_read_b64 v[182:183], v156 offset:12288
    ds_read_b64 v[184:185], v156 offset:12800
    ds_read_b64 v[186:187], v156 offset:13312
    v_mfma_f32_16x16x32_bf16 v[96:99], a[72:75], a[64:67], v[96:99]
    s_waitcnt lgkmcnt(7)
    ds_read_b64 v[106:107], v156 offset:8704
    ds_read_b64 v[110:111], v156 offset:8704
    ds_read_b64 v[34:35], v156 offset:7168
    v_mfma_f32_16x16x32_bf16 v[100:103], a[76:79], a[64:67], v[100:103]
    ds_read_b64 v[38:39], v156 offset:7168
    ds_read_b64 v[58:59], v156 offset:7680
    ds_read_b64 v[62:63], v156 offset:7680
    ds_read_b64 v[82:83], v156 offset:8192
    ds_read_b64 v[86:87], v156 offset:8192
    v_cvt_pk_bf16_f32 v164, v88, v89
    v_cvt_pk_bf16_f32 v165, v90, v91
    v_cvt_pk_bf16_f32 v174, v92, v93
    v_cvt_pk_bf16_f32 v175, v94, v95
    v_cvt_pk_bf16_f32 v24, v24, v25
    v_cvt_pk_bf16_f32 v25, v26, v27
    v_cvt_pk_bf16_f32 v28, v28, v29
    v_cvt_pk_bf16_f32 v29, v30, v31
    v_cvt_pk_bf16_f32 v48, v48, v49
    v_cvt_pk_bf16_f32 v49, v50, v51
    v_cvt_pk_bf16_f32 v52, v52, v53
    v_cvt_pk_bf16_f32 v53, v54, v55
    v_cvt_pk_bf16_f32 v72, v72, v73
    v_cvt_pk_bf16_f32 v73, v74, v75
    v_cvt_pk_bf16_f32 v76, v76, v77
    v_cvt_pk_bf16_f32 v77, v78, v79
    v_cvt_pk_bf16_f32 v96, v96, v97
    v_cvt_pk_bf16_f32 v97, v98, v99
    v_cvt_pk_bf16_f32 v100, v100, v101
    v_cvt_pk_bf16_f32 v101, v102, v103
    s_waitcnt lgkmcnt(0)
    v_and_b32 v26, v212, v214
    v_and_b32 v27, v212, v215
    v_and_b32 v30, v213, v214
    v_and_b32 v31, v213, v215
    v_and_b32 v50, v212, v216
    v_and_b32 v51, v212, v217
    v_and_b32 v54, v213, v216
    v_and_b32 v55, v213, v217
    v_and_b32 v74, v212, v218
    v_and_b32 v75, v212, v219
    v_and_b32 v78, v213, v218
    v_and_b32 v79, v213, v219
    v_and_b32 v98, v212, v220
    v_and_b32 v99, v212, v221
    v_and_b32 v102, v213, v220
    v_and_b32 v103, v213, v221
    v_mfma_f32_16x16x32_bf16 v[40:43], v[188:191], v[24:27], v[200:203]
    v_mfma_f32_16x16x32_bf16 v[64:67], v[192:195], v[28:31], v[200:203]
    v_mfma_f32_16x16x32_bf16 v[88:91], v[32:35], v[48:51], v[200:203]
    v_mfma_f32_16x16x32_bf16 v[112:115], v[36:39], v[52:55], v[200:203]
    v_mfma_f32_16x16x32_bf16 v[44:47], v[32:35], v[24:27], v[196:199]
    v_mfma_f32_16x16x32_bf16 v[68:71], v[36:39], v[28:31], v[196:199]
    v_mfma_f32_16x16x32_bf16 v[92:95], v[56:59], v[48:51], v[196:199]
    v_mfma_f32_16x16x32_bf16 v[116:119], v[60:63], v[52:55], v[196:199]
    s_nop 4
    v_max_f32 v40, v40, v44
    v_max_f32 v64, v64, v68
    v_max_f32 v88, v88, v92
    v_max_f32 v112, v112, v116
    v_max_f32 v41, v41, v45
    v_max_f32 v65, v65, v69
    v_max_f32 v89, v89, v93
    v_max_f32 v113, v113, v117
    v_max_f32 v42, v42, v46
    v_max_f32 v66, v66, v70
    v_max_f32 v90, v90, v94
    v_max_f32 v114, v114, v118
    v_max_f32 v43, v43, v47
    v_max_f32 v67, v67, v71
    v_max_f32 v91, v91, v95
    v_max_f32 v115, v115, v119
    v_max3_f32 v120, v40, v41, v42
    v_max3_f32 v128, v64, v65, v66
    v_max3_f32 v136, v88, v89, v90
    v_max3_f32 v144, v112, v113, v114
    v_max_f32 v120, v120, v43
    v_max_f32 v128, v128, v67
    v_max_f32 v136, v136, v91
    v_max_f32 v144, v144, v115
    v_mov_b32 v122, v120
    v_mov_b32 v130, v128
    v_mov_b32 v138, v136
    v_mov_b32 v146, v144
    v_permlane16_swap_b32 v120, v122
    v_permlane16_swap_b32 v128, v130
    v_permlane16_swap_b32 v136, v138
    v_permlane16_swap_b32 v144, v146
    v_max_f32 v120, v120, v122
    v_max_f32 v128, v128, v130
    v_max_f32 v136, v136, v138
    v_max_f32 v144, v144, v146
    v_mov_b32 v122, v120
    v_mov_b32 v130, v128
    v_mov_b32 v138, v136
    v_mov_b32 v146, v144
    v_permlane32_swap_b32 v120, v122
    v_permlane32_swap_b32 v128, v130
    v_permlane32_swap_b32 v136, v138
    v_permlane32_swap_b32 v144, v146
    v_max_f32 v120, v120, v122
    v_max_f32 v128, v128, v130
    v_max_f32 v136, v136, v138
    v_max_f32 v144, v144, v146
    v_mul_f32 v120, s62, v120
    v_mul_f32 v128, s62, v128
    v_mul_f32 v136, s62, v136
    v_mul_f32 v144, s62, v144
    v_pk_fma_f32 v[40:41], v[40:41], s[62:63], v[120:121] op_sel_hi:[1,0,0] neg_lo:[0,0,1] neg_hi:[0,0,1]
    v_pk_fma_f32 v[64:65], v[64:65], s[62:63], v[128:129] op_sel_hi:[1,0,0] neg_lo:[0,0,1] neg_hi:[0,0,1]
    v_pk_fma_f32 v[88:89], v[88:89], s[62:63], v[136:137] op_sel_hi:[1,0,0] neg_lo:[0,0,1] neg_hi:[0,0,1]
    v_pk_fma_f32 v[112:113], v[112:113], s[62:63], v[144:145] op_sel_hi:[1,0,0] neg_lo:[0,0,1] neg_hi:[0,0,1]
    v_pk_fma_f32 v[42:43], v[42:43], s[62:63], v[120:121] op_sel_hi:[1,0,0] neg_lo:[0,0,1] neg_hi:[0,0,1]
    v_pk_fma_f32 v[66:67], v[66:67], s[62:63], v[128:129] op_sel_hi:[1,0,0] neg_lo:[0,0,1] neg_hi:[0,0,1]
    v_pk_fma_f32 v[90:91], v[90:91], s[62:63], v[136:137] op_sel_hi:[1,0,0] neg_lo:[0,0,1] neg_hi:[0,0,1]
    v_pk_fma_f32 v[114:115], v[114:115], s[62:63], v[144:145] op_sel_hi:[1,0,0] neg_lo:[0,0,1] neg_hi:[0,0,1]
    v_exp_f32 v40, v40
    v_exp_f32 v64, v64
    v_exp_f32 v88, v88
    v_exp_f32 v112, v112
    v_exp_f32 v41, v41
    v_exp_f32 v65, v65
    v_exp_f32 v89, v89
    v_exp_f32 v113, v113
    v_exp_f32 v42, v42
    v_exp_f32 v66, v66
    v_exp_f32 v90, v90
    v_exp_f32 v114, v114
    v_exp_f32 v43, v43
    v_exp_f32 v67, v67
    v_exp_f32 v91, v91
    v_exp_f32 v115, v115
    v_cvt_pk_bf16_f32 v44, v40, v41
    v_cvt_pk_bf16_f32 v68, v64, v65
    v_cvt_pk_bf16_f32 v92, v88, v89
    v_cvt_pk_bf16_f32 v116, v112, v113
    v_cvt_pk_bf16_f32 v45, v42, v43
    v_cvt_pk_bf16_f32 v69, v66, v67
    v_cvt_pk_bf16_f32 v93, v90, v91
    v_cvt_pk_bf16_f32 v117, v114, v115
    v_and_b32 v40, v222, v44
    v_and_b32 v64, v222, v68
    v_and_b32 v88, v222, v92
    v_and_b32 v112, v222, v116
    v_and_b32 v41, v223, v45
    v_and_b32 v65, v223, v69
    v_and_b32 v89, v223, v93
    v_and_b32 v113, v223, v117
    v_and_b32 v42, v6, v44
    v_and_b32 v66, v6, v68
    v_and_b32 v90, v6, v92
    v_and_b32 v114, v6, v116
    v_and_b32 v43, v7, v45
    v_and_b32 v67, v7, v69
    v_and_b32 v91, v7, v93
    v_and_b32 v115, v7, v117
    v_mfma_f32_16x16x32_bf16 v[124:127], v[208:211], v[40:43], 0
    v_mfma_f32_16x16x32_bf16 v[132:135], v[208:211], v[64:67], 0
    v_mfma_f32_16x16x32_bf16 v[140:143], v[208:211], v[88:91], 0
    v_mfma_f32_16x16x32_bf16 v[148:151], v[208:211], v[112:115], 0
    v_mfma_f32_16x16x32_bf16 v[224:227], v[158:161], v[40:43], 0
    v_mfma_f32_16x16x32_bf16 v[232:235], v[168:171], v[64:67], 0
    v_mfma_f32_16x16x32_bf16 v[240:243], v[160:163], v[88:91], 0
    v_mfma_f32_16x16x32_bf16 v[248:251], v[170:173], v[112:115], 0
    v_mfma_f32_16x16x32_bf16 v[228:231], v[178:181], v[40:43], 0
    v_mfma_f32_16x16x32_bf16 v[236:239], v[178:181], v[64:67], 0
    v_mfma_f32_16x16x32_bf16 v[244:247], v[180:183], v[88:91], 0
    v_mfma_f32_16x16x32_bf16 v[252:255], v[180:183], v[112:115], 0
    v_rcp_f32 v120, v124
    v_rcp_f32 v128, v132
    v_rcp_f32 v136, v140
    v_rcp_f32 v144, v148
    v_pk_mul_f32 v[224:225], v[224:225], v[120:121] op_sel_hi:[1,0]
    v_pk_mul_f32 v[232:233], v[232:233], v[128:129] op_sel_hi:[1,0]
    v_pk_mul_f32 v[240:241], v[240:241], v[136:137] op_sel_hi:[1,0]
    v_pk_mul_f32 v[248:249], v[248:249], v[144:145] op_sel_hi:[1,0]
    v_pk_mul_f32 v[226:227], v[226:227], v[120:121] op_sel_hi:[1,0]
    v_pk_mul_f32 v[234:235], v[234:235], v[128:129] op_sel_hi:[1,0]
    v_pk_mul_f32 v[242:243], v[242:243], v[136:137] op_sel_hi:[1,0]
    v_pk_mul_f32 v[250:251], v[250:251], v[144:145] op_sel_hi:[1,0]
    v_pk_mul_f32 v[228:229], v[228:229], v[120:121] op_sel_hi:[1,0]
    v_pk_mul_f32 v[236:237], v[236:237], v[128:129] op_sel_hi:[1,0]
    v_pk_mul_f32 v[244:245], v[244:245], v[136:137] op_sel_hi:[1,0]
    v_pk_mul_f32 v[252:253], v[252:253], v[144:145] op_sel_hi:[1,0]
    v_pk_mul_f32 v[230:231], v[230:231], v[120:121] op_sel_hi:[1,0]
    v_pk_mul_f32 v[238:239], v[238:239], v[128:129] op_sel_hi:[1,0]
    v_pk_mul_f32 v[246:247], v[246:247], v[136:137] op_sel_hi:[1,0]
    v_pk_mul_f32 v[254:255], v[254:255], v[144:145] op_sel_hi:[1,0]
    v_cvt_pk_bf16_f32 v24, v224, v225
    v_cvt_pk_bf16_f32 v26, v232, v233
    v_cvt_pk_bf16_f32 v48, v240, v241
    v_cvt_pk_bf16_f32 v50, v248, v249
    v_cvt_pk_bf16_f32 v25, v226, v227
    v_cvt_pk_bf16_f32 v27, v234, v235
    v_cvt_pk_bf16_f32 v49, v242, v243
    v_cvt_pk_bf16_f32 v51, v250, v251
    v_cvt_pk_bf16_f32 v228, v228, v229
    v_cvt_pk_bf16_f32 v236, v236, v237
    v_cvt_pk_bf16_f32 v244, v244, v245
    v_cvt_pk_bf16_f32 v252, v252, v253
    v_cvt_pk_bf16_f32 v229, v230, v231
    v_cvt_pk_bf16_f32 v237, v238, v239
    v_cvt_pk_bf16_f32 v245, v246, v247
    v_cvt_pk_bf16_f32 v253, v254, v255
    v_cndmask_b32 v228, v228, v236, s[68:69]
    v_cndmask_b32 v229, v229, v237, s[68:69]
    s_add_u32 s59, s57, 0x0
    buffer_store_dwordx4 v[24:27], v157, s[32:35], s59 offen sc1
    s_add_u32 s60, s58, 0x0
    s_mov_b32 exec_hi, 0
    buffer_store_dwordx2 v[228:229], v157, s[32:35], s60 offen
    s_mov_b64 exec, -1
    v_cndmask_b32 v244, v244, v252, s[68:69]
    v_cndmask_b32 v245, v245, v253, s[68:69]
    s_add_u32 s59, s57, 0x11000
    buffer_store_dwordx4 v[48:51], v157, s[32:35], s59 offen sc1
    s_add_u32 s60, s58, 0x11000
    s_mov_b32 exec_hi, 0
    buffer_store_dwordx2 v[244:245], v157, s[32:35], s60 offen
    s_mov_b64 exec, -1
    v_mfma_f32_16x16x32_bf16 v[40:43], v[56:59], v[72:75], v[200:203]
    v_mfma_f32_16x16x32_bf16 v[64:67], v[60:63], v[76:79], v[200:203]
    v_mfma_f32_16x16x32_bf16 v[88:91], v[80:83], v[96:99], v[200:203]
    v_mfma_f32_16x16x32_bf16 v[112:115], v[84:87], v[100:103], v[200:203]
    v_mfma_f32_16x16x32_bf16 v[44:47], v[80:83], v[72:75], v[196:199]
    v_mfma_f32_16x16x32_bf16 v[68:71], v[84:87], v[76:79], v[196:199]
    v_mfma_f32_16x16x32_bf16 v[92:95], v[104:107], v[96:99], v[196:199]
    v_mfma_f32_16x16x32_bf16 v[116:119], v[108:111], v[100:103], v[196:199]
    s_nop 4
    v_max_f32 v40, v40, v44
    v_max_f32 v64, v64, v68
    v_max_f32 v88, v88, v92
    v_max_f32 v112, v112, v116
    v_max_f32 v41, v41, v45
    v_max_f32 v65, v65, v69
    v_max_f32 v89, v89, v93
    v_max_f32 v113, v113, v117
    v_max_f32 v42, v42, v46
    v_max_f32 v66, v66, v70
    v_max_f32 v90, v90, v94
    v_max_f32 v114, v114, v118
    v_max_f32 v43, v43, v47
    v_max_f32 v67, v67, v71
    v_max_f32 v91, v91, v95
    v_max_f32 v115, v115, v119
    v_max3_f32 v120, v40, v41, v42
    v_max3_f32 v128, v64, v65, v66
    v_max3_f32 v136, v88, v89, v90
    v_max3_f32 v144, v112, v113, v114
    v_max_f32 v120, v120, v43
    v_max_f32 v128, v128, v67
    v_max_f32 v136, v136, v91
    v_max_f32 v144, v144, v115
    v_mov_b32 v122, v120
    v_mov_b32 v130, v128
    v_mov_b32 v138, v136
    v_mov_b32 v146, v144
    v_permlane16_swap_b32 v120, v122
    v_permlane16_swap_b32 v128, v130
    v_permlane16_swap_b32 v136, v138
    v_permlane16_swap_b32 v144, v146
    v_max_f32 v120, v120, v122
    v_max_f32 v128, v128, v130
    v_max_f32 v136, v136, v138
    v_max_f32 v144, v144, v146
    v_mov_b32 v122, v120
    v_mov_b32 v130, v128
    v_mov_b32 v138, v136
    v_mov_b32 v146, v144
    v_permlane32_swap_b32 v120, v122
    v_permlane32_swap_b32 v128, v130
    v_permlane32_swap_b32 v136, v138
    v_permlane32_swap_b32 v144, v146
    v_max_f32 v120, v120, v122
    v_max_f32 v128, v128, v130
    v_max_f32 v136, v136, v138
    v_max_f32 v144, v144, v146
    v_mul_f32 v120, s62, v120
    v_mul_f32 v128, s62, v128
    v_mul_f32 v136, s62, v136
    v_mul_f32 v144, s62, v144
    v_pk_fma_f32 v[40:41], v[40:41], s[62:63], v[120:121] op_sel_hi:[1,0,0] neg_lo:[0,0,1] neg_hi:[0,0,1]
    v_pk_fma_f32 v[64:65], v[64:65], s[62:63], v[128:129] op_sel_hi:[1,0,0] neg_lo:[0,0,1] neg_hi:[0,0,1]
    v_pk_fma_f32 v[88:89], v[88:89], s[62:63], v[136:137] op_sel_hi:[1,0,0] neg_lo:[0,0,1] neg_hi:[0,0,1]
    v_pk_fma_f32 v[112:113], v[112:113], s[62:63], v[144:145] op_sel_hi:[1,0,0] neg_lo:[0,0,1] neg_hi:[0,0,1]
    v_pk_fma_f32 v[42:43], v[42:43], s[62:63], v[120:121] op_sel_hi:[1,0,0] neg_lo:[0,0,1] neg_hi:[0,0,1]
    v_pk_fma_f32 v[66:67], v[66:67], s[62:63], v[128:129] op_sel_hi:[1,0,0] neg_lo:[0,0,1] neg_hi:[0,0,1]
    v_pk_fma_f32 v[90:91], v[90:91], s[62:63], v[136:137] op_sel_hi:[1,0,0] neg_lo:[0,0,1] neg_hi:[0,0,1]
    v_pk_fma_f32 v[114:115], v[114:115], s[62:63], v[144:145] op_sel_hi:[1,0,0] neg_lo:[0,0,1] neg_hi:[0,0,1]
    v_exp_f32 v40, v40
    v_exp_f32 v64, v64
    v_exp_f32 v88, v88
    v_exp_f32 v112, v112
    v_exp_f32 v41, v41
    v_exp_f32 v65, v65
    v_exp_f32 v89, v89
    v_exp_f32 v113, v113
    v_exp_f32 v42, v42
    v_exp_f32 v66, v66
    v_exp_f32 v90, v90
    v_exp_f32 v114, v114
    v_exp_f32 v43, v43
    v_exp_f32 v67, v67
    v_exp_f32 v91, v91
    v_exp_f32 v115, v115
    v_cvt_pk_bf16_f32 v44, v40, v41
    v_cvt_pk_bf16_f32 v68, v64, v65
    v_cvt_pk_bf16_f32 v92, v88, v89
    v_cvt_pk_bf16_f32 v116, v112, v113
    v_cvt_pk_bf16_f32 v45, v42, v43
    v_cvt_pk_bf16_f32 v69, v66, v67
    v_cvt_pk_bf16_f32 v93, v90, v91
    v_cvt_pk_bf16_f32 v117, v114, v115
    v_and_b32 v40, v222, v44
    v_and_b32 v64, v222, v68
    v_and_b32 v88, v222, v92
    v_and_b32 v112, v222, v116
    v_and_b32 v41, v223, v45
    v_and_b32 v65, v223, v69
    v_and_b32 v89, v223, v93
    v_and_b32 v113, v223, v117
    v_and_b32 v42, v6, v44
    v_and_b32 v66, v6, v68
    v_and_b32 v90, v6, v92
    v_and_b32 v114, v6, v116
    v_and_b32 v43, v7, v45
    v_and_b32 v67, v7, v69
    v_and_b32 v91, v7, v93
    v_and_b32 v115, v7, v117
    v_mfma_f32_16x16x32_bf16 v[124:127], v[208:211], v[40:43], 0
    v_mfma_f32_16x16x32_bf16 v[132:135], v[208:211], v[64:67], 0
    v_mfma_f32_16x16x32_bf16 v[140:143], v[208:211], v[88:91], 0
    v_mfma_f32_16x16x32_bf16 v[148:151], v[208:211], v[112:115], 0
    v_mfma_f32_16x16x32_bf16 v[224:227], v[162:165], v[40:43], 0
    v_mfma_f32_16x16x32_bf16 v[232:235], v[172:175], v[64:67], 0
    v_mfma_f32_16x16x32_bf16 v[240:243], v[164:167], v[88:91], 0
    v_mfma_f32_16x16x32_bf16 v[248:251], v[174:177], v[112:115], 0
    v_mfma_f32_16x16x32_bf16 v[228:231], v[182:185], v[40:43], 0
    v_mfma_f32_16x16x32_bf16 v[236:239], v[182:185], v[64:67], 0
    v_mfma_f32_16x16x32_bf16 v[244:247], v[184:187], v[88:91], 0
    v_mfma_f32_16x16x32_bf16 v[252:255], v[184:187], v[112:115], 0
    v_rcp_f32 v120, v124
    v_rcp_f32 v128, v132
    v_rcp_f32 v136, v140
    v_rcp_f32 v144, v148
    v_pk_mul_f32 v[224:225], v[224:225], v[120:121] op_sel_hi:[1,0]
    v_pk_mul_f32 v[232:233], v[232:233], v[128:129] op_sel_hi:[1,0]
    v_pk_mul_f32 v[240:241], v[240:241], v[136:137] op_sel_hi:[1,0]
    v_pk_mul_f32 v[248:249], v[248:249], v[144:145] op_sel_hi:[1,0]
    v_pk_mul_f32 v[226:227], v[226:227], v[120:121] op_sel_hi:[1,0]
    v_pk_mul_f32 v[234:235], v[234:235], v[128:129] op_sel_hi:[1,0]
    v_pk_mul_f32 v[242:243], v[242:243], v[136:137] op_sel_hi:[1,0]
    v_pk_mul_f32 v[250:251], v[250:251], v[144:145] op_sel_hi:[1,0]
    v_pk_mul_f32 v[228:229], v[228:229], v[120:121] op_sel_hi:[1,0]
    v_pk_mul_f32 v[236:237], v[236:237], v[128:129] op_sel_hi:[1,0]
    v_pk_mul_f32 v[244:245], v[244:245], v[136:137] op_sel_hi:[1,0]
    v_pk_mul_f32 v[252:253], v[252:253], v[144:145] op_sel_hi:[1,0]
    v_pk_mul_f32 v[230:231], v[230:231], v[120:121] op_sel_hi:[1,0]
    v_pk_mul_f32 v[238:239], v[238:239], v[128:129] op_sel_hi:[1,0]
    v_pk_mul_f32 v[246:247], v[246:247], v[136:137] op_sel_hi:[1,0]
    v_pk_mul_f32 v[254:255], v[254:255], v[144:145] op_sel_hi:[1,0]
    v_cvt_pk_bf16_f32 v72, v224, v225
    v_cvt_pk_bf16_f32 v74, v232, v233
    v_cvt_pk_bf16_f32 v96, v240, v241
    v_cvt_pk_bf16_f32 v98, v248, v249
    v_cvt_pk_bf16_f32 v73, v226, v227
    v_cvt_pk_bf16_f32 v75, v234, v235
    v_cvt_pk_bf16_f32 v97, v242, v243
    v_cvt_pk_bf16_f32 v99, v250, v251
    v_cvt_pk_bf16_f32 v228, v228, v229
    v_cvt_pk_bf16_f32 v236, v236, v237
    v_cvt_pk_bf16_f32 v244, v244, v245
    v_cvt_pk_bf16_f32 v252, v252, v253
    v_cvt_pk_bf16_f32 v229, v230, v231
    v_cvt_pk_bf16_f32 v237, v238, v239
    v_cvt_pk_bf16_f32 v245, v246, v247
    v_cvt_pk_bf16_f32 v253, v254, v255
    v_cndmask_b32 v228, v228, v236, s[68:69]
    v_cndmask_b32 v229, v229, v237, s[68:69]
    s_add_u32 s59, s57, 0x22000
    buffer_store_dwordx4 v[72:75], v157, s[32:35], s59 offen sc1
    s_add_u32 s60, s58, 0x22000
    s_mov_b32 exec_hi, 0
    buffer_store_dwordx2 v[228:229], v157, s[32:35], s60 offen
    s_mov_b64 exec, -1
    v_cndmask_b32 v244, v244, v252, s[68:69]
    v_cndmask_b32 v245, v245, v253, s[68:69]
    s_add_u32 s59, s57, 0x33000
    buffer_store_dwordx4 v[96:99], v157, s[32:35], s59 offen sc1
    s_add_u32 s60, s58, 0x33000
    s_mov_b32 exec_hi, 0
    buffer_store_dwordx2 v[244:245], v157, s[32:35], s60 offen
    s_mov_b64 exec, -1
    s_endpgm
L_q2_end:
L_q3:
    v_lshrrev_b32 v1, 3, v0
    v_mul_u32_u24 v1, 0xa00, v1
    v_lshrrev_b32 v2, 4, v0
    v_xor_b32 v2, v2, v0
    v_and_b32 v2, 7, v2
    v_lshl_add_u32 v3, v2, 4, v1
    v_xor_b32 v4, 64, v3
    s_lshl_b32 s56, s45, 8
    s_add_u32 s56, s56, s44
    s_mul_i32 s56, s56, 0x500
    s_sub_u32 s57, s56, 0xa000
    s_cmp_eq_u32 s45, 0
    s_cselect_b32 s58, s56, s57
    s_add_u32 s59, s57, 0x3c000
    v_add_u32 v12, s59, v3
    s_add_u32 s59, s57, 0x41000
    v_add_u32 v13, s59, v4
    s_add_u32 s59, s57, 0x46000
    v_add_u32 v14, s59, v3
    s_add_u32 s59, s57, 0x4b000
    v_add_u32 v15, s59, v4
    s_add_u32 s59, s57, 0x50000
    v_add_u32 v16, s59, v3
    s_add_u32 s59, s57, 0x55000
    v_add_u32 v17, s59, v4
    s_mul_i32 s60, s46, 160
    v_add_u32 v1, 0x300, v0
    v_mul_u32_u24 v2, 0x889, v1
    v_lshrrev_b32 v2, 16, v2
    v_mul_u32_u24 v5, 30, v2
    v_sub_u32 v1, v1, v5
    v_mul_u32_u24 v5, 0xcd, v1
    v_lshrrev_b32 v5, 11, v5
    v_mul_u32_u24 v5, 0x460, v5
    v_lshl_add_u32 v1, v1, 4, v5
    v_and_b32 v5, 0x13, v2
    v_and_b32 v6, 4, v2
    v_lshl_or_b32 v5, v6, 1, v5
    v_and_b32 v6, 8, v2
    v_lshrrev_b32 v6, 1, v6
    v_or_b32 v5, v5, v6
    v_mul_u32_u24 v5, 0xf00, v5
    v_add3_u32 v8, v1, v5, s60
    v_add_u32 v1, 0x340, v0
    v_mul_u32_u24 v2, 0x889, v1
    v_lshrrev_b32 v2, 16, v2
    v_mul_u32_u24 v5, 30, v2
    v_sub_u32 v1, v1, v5
    v_mul_u32_u24 v5, 0xcd, v1
    v_lshrrev_b32 v5, 11, v5
    v_mul_u32_u24 v5, 0x460, v5
    v_lshl_add_u32 v1, v1, 4, v5
    v_and_b32 v5, 0x13, v2
    v_and_b32 v6, 4, v2
    v_lshl_or_b32 v5, v6, 1, v5
    v_and_b32 v6, 8, v2
    v_lshrrev_b32 v6, 1, v6
    v_or_b32 v5, v5, v6
    v_mul_u32_u24 v5, 0xf00, v5
    v_add3_u32 v9, v1, v5, s60
    v_add_u32 v1, 0x380, v0
    v_mul_u32_u24 v2, 0x889, v1
    v_lshrrev_b32 v2, 16, v2
    v_mul_u32_u24 v5, 30, v2
    v_sub_u32 v1, v1, v5
    v_mul_u32_u24 v5, 0xcd, v1
    v_lshrrev_b32 v5, 11, v5
    v_mul_u32_u24 v5, 0x460, v5
    v_lshl_add_u32 v1, v1, 4, v5
    v_and_b32 v5, 0x13, v2
    v_and_b32 v6, 4, v2
    v_lshl_or_b32 v5, v6, 1, v5
    v_and_b32 v6, 8, v2
    v_lshrrev_b32 v6, 1, v6
    v_or_b32 v5, v5, v6
    v_mul_u32_u24 v5, 0xf00, v5
    v_add3_u32 v10, v1, v5, s60
    s_and_b32 s50, s46, 1
    s_lshl_b32 s50, s50, 1
    s_add_u32 s50, s50, s45
    s_mul_i32 s48, s50, 52
    s_lshr_b32 s48, s48, 8
    s_mul_i32 s48, s48, 5
    s_sub_u32 s50, s50, s48
    s_mul_i32 s50, s50, 32
    s_lshr_b32 s50, s50, 4
    s_mul_i32 s48, s50, 0x3c000
    s_lshl_b32 s50, s50, 7
    s_add_u32 s49, s48, 0x1e000
    s_mov_b32 s51, 0
    s_mov_b32 s55, 0
    s_mov_b32 s52, 0
    s_waitcnt lgkmcnt(0)
    s_mov_b32 s24, s4
    s_mov_b32 s25, s5
    s_mov_b32 s26, 0x280000
    s_mov_b32 s27, 0x20000
    s_mov_b32 s28, s6
    s_mov_b32 s29, s7
    s_mov_b32 s30, 0x258000
    s_mov_b32 s31, 0x20000
    s_mov_b32 s32, s20
    s_mov_b32 s33, s21
    s_mov_b32 s34, 0xc02000
    s_mov_b32 s35, 0x20000
    s_add_u32 m0, s51, 0x3000
    s_nop 0
    buffer_load_dwordx4 v12, s[24:27], s50 offen lds
    s_add_u32 m0, s51, 0x3400
    s_nop 0
    buffer_load_dwordx4 v13, s[24:27], s50 offen lds
    s_add_u32 m0, s51, 0x3800
    s_nop 0
    buffer_load_dwordx4 v14, s[24:27], s50 offen lds
    s_add_u32 m0, s51, 0x3c00
    s_nop 0
    buffer_load_dwordx4 v15, s[24:27], s50 offen lds
    s_add_u32 m0, s51, 0x4000
    s_nop 0
    buffer_load_dwordx4 v16, s[24:27], s50 offen lds
    s_add_u32 m0, s51, 0x4400
    s_nop 0
    buffer_load_dwordx4 v17, s[24:27], s50 offen lds
    s_add_u32 m0, s51, 0x7800
    s_nop 0
    buffer_load_dwordx4 v8, s[28:31], s48 offen lds
    s_add_u32 m0, s51, 0x7c00
    s_nop 0
    buffer_load_dwordx4 v9, s[28:31], s48 offen lds
    s_add_u32 m0, s51, 0x8000
    s_nop 0
    buffer_load_dwordx4 v10, s[28:31], s48 offen lds
    s_add_u32 m0, s51, 0xb400
    s_nop 0
    buffer_load_dwordx4 v8, s[28:31], s49 offen lds
    s_add_u32 m0, s51, 0xb800
    s_nop 0
    buffer_load_dwordx4 v9, s[28:31], s49 offen lds
    s_add_u32 m0, s51, 0xbc00
    s_nop 0
    buffer_load_dwordx4 v10, s[28:31], s49 offen lds
    s_add_u32 s48, s48, 0x3c000
    s_add_u32 s55, s55, 1
    s_add_u32 s50, s50, 0x80
    s_cmp_eq_u32 s50, 0x500
    s_cselect_b32 s50, 0, s50
    s_cselect_b32 s48, 0, s48
    s_cmp_ge_u32 s55, 10
    s_cselect_b32 s50, 0x7f000000, s50
    s_cselect_b32 s48, 0x7f000000, s48
    s_add_u32 s51, s51, 0xc000
    s_cmp_eq_u32 s51, 0x24000
    s_cselect_b32 s51, 0, s51
    s_add_u32 s49, s48, 0x1e000
    s_and_b32 s94, s46, 1
    s_lshl1_add_u32 s94, s45, s94
    s_mul_i32 s92, s94, 256
    s_min_u32 s92, s92, L_q3_end-L_q3_tail-256
    s_getpc_b64 s[90:91]
L_pf5:
    s_add_u32 s92, s92, L_q3_tail-L_pf5
    s_add_u32 s90, s90, s92
    s_addc_u32 s91, s91, 0
    s_load_dword s93, s[90:91], 0
    s_load_dword s93, s[90:91], 64
    s_load_dword s93, s[90:91], 128
    s_load_dword s93, s[90:91], 192
    s_add_u32 m0, s51, 0x3000
    s_nop 0
    buffer_load_dwordx4 v12, s[24:27], s50 offen lds
    v_and_b32 v1, 15, v0
    v_lshrrev_b32 v2, 1, v1
    v_lshrrev_b32 v3, 4, v0
    v_xor_b32 v2, v2, v3
    v_lshlrev_b32 v2, 4, v2
    v_lshl_add_u32 v18, v1, 7, v2
    v_xor_b32 v19, 64, v18
    v_lshrrev_b32 v1, 5, v0
    v_lshlrev_b32 v1, 4, v1
    v_bfe_u32 v2, v0, 4, 1
    v_lshl_add_u32 v1, v2, 2, v1
    v_bfe_u32 v2, v0, 2, 2
    v_add_u32 v1, v1, v2
    s_add_u32 m0, s51, 0x3400
    s_nop 0
    buffer_load_dwordx4 v13, s[24:27], s50 offen lds
    v_mul_u32_u24 v1, 0x1e0, v1
    v_and_b32 v2, 3, v0
    v_lshl_add_u32 v20, v2, 3, v1
    v_mul_u32_u24 v2, 40, v2
    v_add3_u32 v21, v1, v2, 32
    v_mov_b64 v[24:25], 0
    v_mov_b64 v[26:27], 0
    v_mov_b64 v[28:29], 0
    v_mov_b64 v[30:31], 0
    v_mov_b64 v[32:33], 0
    v_mov_b64 v[34:35], 0
    v_mov_b64 v[36:37], 0
    v_mov_b64 v[38:39], 0
    s_add_u32 m0, s51, 0x3800
    s_nop 0
    buffer_load_dwordx4 v14, s[24:27], s50 offen lds
    v_mov_b64 v[40:41], 0
    v_mov_b64 v[42:43], 0
    v_mov_b64 v[44:45], 0
    v_mov_b64 v[46:47], 0
    v_mov_b64 v[48:49], 0
    v_mov_b64 v[50:51], 0
    v_mov_b64 v[52:53], 0
    v_mov_b64 v[54:55], 0
    v_mov_b64 v[56:57], 0
    v_mov_b64 v[58:59], 0
    v_mov_b64 v[60:61], 0
    v_mov_b64 v[62:63], 0
    v_mov_b64 v[64:65], 0
    s_add_u32 m0, s51, 0x3c00
    s_nop 0
    buffer_load_dwordx4 v15, s[24:27], s50 offen lds
    v_mov_b64 v[66:67], 0
    v_mov_b64 v[68:69], 0
    v_mov_b64 v[70:71], 0
    v_mov_b64 v[72:73], 0
    v_mov_b64 v[74:75], 0
    v_mov_b64 v[76:77], 0
    v_mov_b64 v[78:79], 0
    v_mov_b64 v[80:81], 0
    v_mov_b64 v[82:83], 0
    v_mov_b64 v[84:85], 0
    v_mov_b64 v[86:87], 0
    v_mov_b64 v[88:89], 0
    v_mov_b64 v[90:91], 0
    s_add_u32 m0, s51, 0x4000
    s_nop 0
    buffer_load_dwordx4 v16, s[24:27], s50 offen lds
    v_mov_b64 v[92:93], 0
    v_mov_b64 v[94:95], 0
    v_mov_b64 v[96:97], 0
    v_mov_b64 v[98:99], 0
    v_mov_b64 v[100:101], 0
    v_mov_b64 v[102:103], 0
    v_mov_b64 v[104:105], 0
    v_mov_b64 v[106:107], 0
    v_mov_b64 v[108:109], 0
    v_mov_b64 v[110:111], 0
    v_mov_b64 v[112:113], 0
    v_mov_b64 v[114:115], 0
    v_mov_b64 v[116:117], 0
    s_add_u32 m0, s51, 0x4400
    s_nop 0
    buffer_load_dwordx4 v17, s[24:27], s50 offen lds
    v_mov_b64 v[118:119], 0
    v_mov_b64 v[120:121], 0
    v_mov_b64 v[122:123], 0
    v_mov_b64 v[124:125], 0
    v_mov_b64 v[126:127], 0
    v_mov_b64 v[128:129], 0
    v_mov_b64 v[130:131], 0
    v_mov_b64 v[132:133], 0
    v_mov_b64 v[134:135], 0
    v_mov_b64 v[136:137], 0
    v_mov_b64 v[138:139], 0
    v_mov_b64 v[140:141], 0
    v_mov_b64 v[142:143], 0
    s_add_u32 m0, s51, 0x7800
    s_nop 0
    buffer_load_dwordx4 v8, s[28:31], s48 offen lds
    v_mov_b64 v[144:145], 0
    v_mov_b64 v[146:147], 0
    v_mov_b64 v[148:149], 0
    v_mov_b64 v[150:151], 0
    v_mov_b64 v[152:153], 0
    v_mov_b64 v[154:155], 0
    v_and_b32 v1, 15, v0
    v_lshrrev_b32 v2, 4, v0
    v_lshlrev_b32 v3, 2, v2
    v_sub_u32 v3, v1, v3
    v_mov_b32 v4, 0xf149f2ca
    v_subrev_u32 v5, 0, v3
    v_cmp_gt_u32 vcc, 8, v5
    s_add_u32 m0, s51, 0x7c00
    s_nop 0
    buffer_load_dwordx4 v9, s[28:31], s48 offen lds
    v_cndmask_b32 v196, v4, 0, vcc
    v_cmp_ge_i32 vcc, -9, v5
    s_nop 1
    v_cndmask_b32 v200, v4, 0, vcc
    v_subrev_u32 v5, 1, v3
    v_cmp_gt_u32 vcc, 8, v5
    s_nop 1
    v_cndmask_b32 v197, v4, 0, vcc
    v_cmp_ge_i32 vcc, -9, v5
    s_nop 1
    v_cndmask_b32 v201, v4, 0, vcc
    v_subrev_u32 v5, 2, v3
    v_cmp_gt_u32 vcc, 8, v5
    s_nop 1
    v_cndmask_b32 v198, v4, 0, vcc
    v_cmp_ge_i32 vcc, -9, v5
    s_nop 1
    v_cndmask_b32 v202, v4, 0, vcc
    s_add_u32 m0, s51, 0x8000
    s_nop 0
    buffer_load_dwordx4 v10, s[28:31], s48 offen lds
    v_subrev_u32 v5, 3, v3
    v_cmp_gt_u32 vcc, 8, v5
    s_nop 1
    v_cndmask_b32 v199, v4, 0, vcc
    v_cmp_ge_i32 vcc, -9, v5
    s_nop 1
    v_cndmask_b32 v203, v4, 0, vcc
    v_mov_b32 v208, 0x3f803f80
    v_mov_b32 v209, 0x3f803f80
    v_mov_b32 v210, 0x3f803f80
    v_mov_b32 v211, 0x3f803f80
    v_cmp_eq_u32 vcc, 2, v2
    s_nop 1
    v_cndmask_b32 v212, 0, -1, vcc
    v_cmp_eq_u32 s[68:69], 3, v2
    s_nop 1
    v_cndmask_b32 v213, 0, -1, s[68:69]
    s_add_u32 m0, s51, 0xb400
    s_nop 0
    buffer_load_dwordx4 v8, s[28:31], s49 offen lds
    s_mov_b32 s62, 0x3ea52b5c
    s_mov_b32 s63, 0x3ea52b5c
    s_lshl_b32 s56, s44, 6
    s_lshl_b32 s57, s45, 3
    s_add_u32 s56, s56, s57
    s_add_u32 s56, s56, 4
    s_mul_i32 s56, s56, 0x11000
    s_lshl_b32 s57, s46, 11
    s_add_u32 s57, s57, s56
    s_add_u32 s57, s57, 1024
    s_lshr_b32 s58, s46, 1
    s_lshl_b32 s58, s58, 10
    s_add_u32 s58, s58, s56
    s_add_u32 m0, s51, 0xb800
    s_nop 0
    buffer_load_dwordx4 v9, s[28:31], s49 offen lds
    s_and_b32 s59, s46, 1
    s_lshl_b32 s59, s59, 3
    s_add_u32 s58, s58, s59
    s_add_u32 s58, s58, 16384
    v_lshlrev_b32 v157, 4, v0
    s_movk_i32 s59, 0x7fff
    s_lshl1_add_u32 s59, s59, 1
    v_ashrrev_i32 v1, 31, v200
    v_ashrrev_i32 v2, 31, v201
    v_bfi_b32 v1, s59, v1, v2
    v_not_b32 v222, v1
    v_ashrrev_i32 v1, 31, v202
    v_ashrrev_i32 v2, 31, v203
    s_add_u32 m0, s51, 0xbc00
    s_nop 0
    buffer_load_dwordx4 v10, s[28:31], s49 offen lds
    v_bfi_b32 v1, s59, v1, v2
    v_not_b32 v223, v1
    v_ashrrev_i32 v1, 31, v196
    v_ashrrev_i32 v2, 31, v197
    v_bfi_b32 v1, s59, v1, v2
    v_not_b32 v6, v1
    v_ashrrev_i32 v1, 31, v198
    v_ashrrev_i32 v2, 31, v199
    v_bfi_b32 v1, s59, v1, v2
    v_not_b32 v7, v1
    v_lshlrev_b32 v156, 3, v0
    v_add_u32 v156, 0x20400, v156
    s_add_u32 s48, s48, 0x3c000
    s_add_u32 s55, s55, 1
    s_add_u32 s50, s50, 0x80
    s_cmp_eq_u32 s50, 0x500
    s_cselect_b32 s50, 0, s50
    s_cselect_b32 s48, 0, s48
    s_cmp_ge_u32 s55, 10
    s_cselect_b32 s50, 0x7f000000, s50
    s_cselect_b32 s48, 0x7f000000, s48
    s_add_u32 s51, s51, 0xc000
    s_cmp_eq_u32 s51, 0x24000
    s_cselect_b32 s51, 0, s51
    s_add_u32 s49, s48, 0x1e000
    s_waitcnt vmcnt(12)
    s_barrier
    ds_read_b128 a[0:3], v18 offset:10240
    ds_read_b128 a[4:7], v18 offset:12288
    ds_read_b128 a[8:11], v18 offset:14336
    ds_read_b128 a[12:15], v18 offset:16384
    ds_read_b128 a[16:19], v18 offset:0
    ds_read_b64_tr_b16 a[20:21], v20 offset:18512
    ds_read_b64_tr_b16 a[22:23], v20 offset:22352
    ds_read_b64_tr_b16 a[24:25], v20 offset:18552
    ds_read_b64_tr_b16 a[26:27], v20 offset:22392
    ds_read_b64_tr_b16 a[28:29], v20 offset:18672
    ds_read_b64_tr_b16 a[30:31], v20 offset:22512
    ds_read_b64_tr_b16 a[32:33], v20 offset:18712
    ds_read_b64_tr_b16 a[34:35], v20 offset:22552
    ds_read_b64_tr_b16 a[36:37], v20 offset:18832
    ds_read_b64_tr_b16 a[38:39], v20 offset:22672
    ds_read_b64_tr_b16 a[40:41], v20 offset:18872
    ds_read_b64_tr_b16 a[42:43], v20 offset:22712
    ds_read_b64_tr_b16 a[44:45], v21 offset:18752
    ds_read_b64_tr_b16 a[46:47], v21 offset:22592
    ds_read_b64_tr_b16 a[48:49], v21 offset:18592
    ds_read_b64_tr_b16 a[50:51], v21 offset:22432
    s_add_u32 m0, s51, 0x3000
    s_nop 0
    buffer_load_dwordx4 v12, s[24:27], s50 offen lds
    s_add_u32 m0, s51, 0x3400
    s_nop 0
    buffer_load_dwordx4 v13, s[24:27], s50 offen lds
    s_add_u32 m0, s51, 0x3800
    s_nop 0
    buffer_load_dwordx4 v14, s[24:27], s50 offen lds
    s_add_u32 m0, s51, 0x3c00
    s_nop 0
    buffer_load_dwordx4 v15, s[24:27], s50 offen lds
    s_add_u32 m0, s51, 0x4000
    s_nop 0
    buffer_load_dwordx4 v16, s[24:27], s50 offen lds
    s_add_u32 m0, s51, 0x4400
    s_nop 0
    buffer_load_dwordx4 v17, s[24:27], s50 offen lds
    s_mov_b32 s54, 9
L_q3_loop:
    s_waitcnt lgkmcnt(0)
    v_mfma_f32_16x16x32_bf16 v[24:27], a[20:23], a[0:3], v[24:27]
    ds_read_b128 a[52:55], v19 offset:10240
    s_add_u32 m0, s51, 0x7800
    v_mfma_f32_16x16x32_bf16 v[28:31], a[24:27], a[0:3], v[28:31]
    buffer_load_dwordx4 v8, s[28:31], s48 offen lds
    ds_read_b128 a[56:59], v19 offset:12288
    v_mfma_f32_16x16x32_bf16 v[32:35], a[28:31], a[0:3], v[32:35]
    ds_read_b128 a[60:63], v19 offset:14336
    v_mfma_f32_16x16x32_bf16 v[36:39], a[32:35], a[0:3], v[36:39]
    ds_read_b128 a[64:67], v19 offset:16384
    v_mfma_f32_16x16x32_bf16 v[40:43], a[0:3], a[36:39], v[40:43]
    ds_read_b128 a[68:71], v19 offset:0
    s_add_u32 m0, s51, 0x7c00
    v_mfma_f32_16x16x32_bf16 v[44:47], a[0:3], a[40:43], v[44:47]
    buffer_load_dwordx4 v9, s[28:31], s48 offen lds
    ds_read_b64_tr_b16 a[72:73], v20 offset:33872
    v_mfma_f32_16x16x32_bf16 v[120:123], a[0:3], a[44:47], v[120:123]
    ds_read_b64_tr_b16 a[74:75], v20 offset:37712
    v_mfma_f32_16x16x32_bf16 v[48:51], a[20:23], a[4:7], v[48:51]
    ds_read_b64_tr_b16 a[76:77], v20 offset:33912
    v_mfma_f32_16x16x32_bf16 v[52:55], a[24:27], a[4:7], v[52:55]
    ds_read_b64_tr_b16 a[78:79], v20 offset:37752
    s_add_u32 m0, s51, 0x8000
    v_mfma_f32_16x16x32_bf16 v[56:59], a[28:31], a[4:7], v[56:59]
    buffer_load_dwordx4 v10, s[28:31], s48 offen lds
    ds_read_b64_tr_b16 a[80:81], v20 offset:34032
    v_mfma_f32_16x16x32_bf16 v[60:63], a[32:35], a[4:7], v[60:63]
    ds_read_b64_tr_b16 a[82:83], v20 offset:37872
    v_mfma_f32_16x16x32_bf16 v[64:67], a[4:7], a[36:39], v[64:67]
    ds_read_b64_tr_b16 a[84:85], v20 offset:34072
    v_mfma_f32_16x16x32_bf16 v[68:71], a[4:7], a[40:43], v[68:71]
    ds_read_b64_tr_b16 a[86:87], v20 offset:37912
    s_add_u32 m0, s51, 0xb400
    v_mfma_f32_16x16x32_bf16 v[124:127], a[4:7], a[44:47], v[124:127]
    buffer_load_dwordx4 v8, s[28:31], s49 offen lds
    ds_read_b64_tr_b16 a[88:89], v20 offset:34192
    v_mfma_f32_16x16x32_bf16 v[72:75], a[20:23], a[8:11], v[72:75]
    ds_read_b64_tr_b16 a[90:91], v20 offset:38032
    v_mfma_f32_16x16x32_bf16 v[76:79], a[24:27], a[8:11], v[76:79]
    ds_read_b64_tr_b16 a[92:93], v20 offset:34232
    v_mfma_f32_16x16x32_bf16 v[80:83], a[28:31], a[8:11], v[80:83]
    ds_read_b64_tr_b16 a[94:95], v20 offset:38072
    s_add_u32 m0, s51, 0xb800
    v_mfma_f32_16x16x32_bf16 v[84:87], a[32:35], a[8:11], v[84:87]
    buffer_load_dwordx4 v9, s[28:31], s49 offen lds
    ds_read_b64_tr_b16 a[96:97], v21 offset:34112
    v_mfma_f32_16x16x32_bf16 v[88:91], a[8:11], a[36:39], v[88:91]
    ds_read_b64_tr_b16 a[98:99], v21 offset:37952
    v_mfma_f32_16x16x32_bf16 v[92:95], a[8:11], a[40:43], v[92:95]
    ds_read_b64_tr_b16 a[100:101], v21 offset:33952
    v_mfma_f32_16x16x32_bf16 v[128:131], a[8:11], a[44:47], v[128:131]
    ds_read_b64_tr_b16 a[102:103], v21 offset:37792
    s_add_u32 m0, s51, 0xbc00
    v_mfma_f32_16x16x32_bf16 v[96:99], a[20:23], a[12:15], v[96:99]
    buffer_load_dwordx4 v10, s[28:31], s49 offen lds
    v_mfma_f32_16x16x32_bf16 v[100:103], a[24:27], a[12:15], v[100:103]
    s_add_u32 s70, s52, 0xc000
    s_cmp_eq_u32 s70, 0x24000
    s_cselect_b32 s70, 0, s70
    s_sub_u32 s53, s70, s52
    s_mov_b32 s52, s70
    v_mfma_f32_16x16x32_bf16 v[104:107], a[28:31], a[12:15], v[104:107]
    v_add_u32 v18, s53, v18
    v_mfma_f32_16x16x32_bf16 v[108:111], a[32:35], a[12:15], v[108:111]
    s_add_u32 s48, s48, 0x3c000
    s_add_u32 s55, s55, 1
    s_add_u32 s50, s50, 0x80
    v_mfma_f32_16x16x32_bf16 v[112:115], a[12:15], a[36:39], v[112:115]
    s_cmp_eq_u32 s50, 0x500
    s_cselect_b32 s50, 0, s50
    s_cselect_b32 s48, 0, s48
    v_mfma_f32_16x16x32_bf16 v[116:119], a[12:15], a[40:43], v[116:119]
    s_cmp_ge_u32 s55, 10
    s_cselect_b32 s50, 0x7f000000, s50
    s_cselect_b32 s48, 0x7f000000, s48
    v_mfma_f32_16x16x32_bf16 v[132:135], a[12:15], a[44:47], v[132:135]
    s_add_u32 s51, s51, 0xc000
    s_cmp_eq_u32 s51, 0x24000
    s_cselect_b32 s51, 0, s51
    v_mfma_f32_16x16x32_bf16 v[136:139], a[48:51], a[8:11], v[136:139]
    s_add_u32 s49, s48, 0x1e000
    v_mfma_f32_16x16x32_bf16 v[140:143], a[48:51], a[12:15], v[140:143]
    v_add_u32 v19, s53, v19
    v_mfma_f32_16x16x32_bf16 v[144:147], a[16:19], a[36:39], v[144:147]
    v_add_u32 v20, s53, v20
    v_add_u32 v21, s53, v21
    v_mfma_f32_16x16x32_bf16 v[148:151], a[16:19], a[40:43], v[148:151]
    s_waitcnt vmcnt(12) lgkmcnt(0)
    s_barrier
    v_mfma_f32_16x16x32_bf16 v[24:27], a[72:75], a[52:55], v[24:27]
    ds_read_b128 a[0:3], v18 offset:10240
    s_add_u32 m0, s51, 0x3000
    v_mfma_f32_16x16x32_bf16 v[28:31], a[76:79], a[52:55], v[28:31]
    buffer_load_dwordx4 v12, s[24:27], s50 offen lds
    ds_read_b128 a[4:7], v18 offset:12288
    v_mfma_f32_16x16x32_bf16 v[32:35], a[80:83], a[52:55], v[32:35]
    ds_read_b128 a[8:11], v18 offset:14336
    v_mfma_f32_16x16x32_bf16 v[36:39], a[84:87], a[52:55], v[36:39]
    ds_read_b128 a[12:15], v18 offset:16384
    v_mfma_f32_16x16x32_bf16 v[40:43], a[52:55], a[88:91], v[40:43]
    ds_read_b128 a[16:19], v18 offset:0
    s_add_u32 m0, s51, 0x3400
    v_mfma_f32_16x16x32_bf16 v[44:47], a[52:55], a[92:95], v[44:47]
    buffer_load_dwordx4 v13, s[24:27], s50 offen lds
    ds_read_b64_tr_b16 a[20:21], v20 offset:18512
    v_mfma_f32_16x16x32_bf16 v[120:123], a[52:55], a[96:99], v[120:123]
    ds_read_b64_tr_b16 a[22:23], v20 offset:22352
    v_mfma_f32_16x16x32_bf16 v[48:51], a[72:75], a[56:59], v[48:51]
    ds_read_b64_tr_b16 a[24:25], v20 offset:18552
    v_mfma_f32_16x16x32_bf16 v[52:55], a[76:79], a[56:59], v[52:55]
    ds_read_b64_tr_b16 a[26:27], v20 offset:22392
    s_add_u32 m0, s51, 0x3800
    v_mfma_f32_16x16x32_bf16 v[56:59], a[80:83], a[56:59], v[56:59]
    buffer_load_dwordx4 v14, s[24:27], s50 offen lds
    ds_read_b64_tr_b16 a[28:29], v20 offset:18672
    v_mfma_f32_16x16x32_bf16 v[60:63], a[84:87], a[56:59], v[60:63]
    ds_read_b64_tr_b16 a[30:31], v20 offset:22512
    v_mfma_f32_16x16x32_bf16 v[64:67], a[56:59], a[88:91], v[64:67]
    ds_read_b64_tr_b16 a[32:33], v20 offset:18712
    v_mfma_f32_16x16x32_bf16 v[68:71], a[56:59], a[92:95], v[68:71]
    ds_read_b64_tr_b16 a[34:35], v20 offset:22552
    s_add_u32 m0, s51, 0x3c00
    v_mfma_f32_16x16x32_bf16 v[124:127], a[56:59], a[96:99], v[124:127]
    buffer_load_dwordx4 v15, s[24:27], s50 offen lds
    ds_read_b64_tr_b16 a[36:37], v20 offset:18832
    v_mfma_f32_16x16x32_bf16 v[72:75], a[72:75], a[60:63], v[72:75]
    ds_read_b64_tr_b16 a[38:39], v20 offset:22672
    v_mfma_f32_16x16x32_bf16 v[76:79], a[76:79], a[60:63], v[76:79]
    ds_read_b64_tr_b16 a[40:41], v20 offset:18872
    v_mfma_f32_16x16x32_bf16 v[80:83], a[80:83], a[60:63], v[80:83]
    ds_read_b64_tr_b16 a[42:43], v20 offset:22712
    s_add_u32 m0, s51, 0x4000
    v_mfma_f32_16x16x32_bf16 v[84:87], a[84:87], a[60:63], v[84:87]
    buffer_load_dwordx4 v16, s[24:27], s50 offen lds
    ds_read_b64_tr_b16 a[44:45], v21 offset:18752
    v_mfma_f32_16x16x32_bf16 v[88:91], a[60:63], a[88:91], v[88:91]
    ds_read_b64_tr_b16 a[46:47], v21 offset:22592
    v_mfma_f32_16x16x32_bf16 v[92:95], a[60:63], a[92:95], v[92:95]
    ds_read_b64_tr_b16 a[48:49], v21 offset:18592
    v_mfma_f32_16x16x32_bf16 v[128:131], a[60:63], a[96:99], v[128:131]
    ds_read_b64_tr_b16 a[50:51], v21 offset:22432
    s_add_u32 m0, s51, 0x4400
    v_mfma_f32_16x16x32_bf16 v[96:99], a[72:75], a[64:67], v[96:99]
    buffer_load_dwordx4 v17, s[24:27], s50 offen lds
    v_mfma_f32_16x16x32_bf16 v[100:103], a[76:79], a[64:67], v[100:103]
    v_mfma_f32_16x16x32_bf16 v[104:107], a[80:83], a[64:67], v[104:107]
    v_mfma_f32_16x16x32_bf16 v[108:111], a[84:87], a[64:67], v[108:111]
    v_mfma_f32_16x16x32_bf16 v[112:115], a[64:67], a[88:91], v[112:115]
    v_mfma_f32_16x16x32_bf16 v[116:119], a[64:67], a[92:95], v[116:119]
    s_sub_u32 s54, s54, 1
    v_mfma_f32_16x16x32_bf16 v[132:135], a[64:67], a[96:99], v[132:135]
    s_cmp_lg_u32 s54, 0
    v_mfma_f32_16x16x32_bf16 v[136:139], a[100:103], a[60:63], v[136:139]
    v_mfma_f32_16x16x32_bf16 v[140:143], a[100:103], a[64:67], v[140:143]
    v_mfma_f32_16x16x32_bf16 v[144:147], a[68:71], a[88:91], v[144:147]
    v_mfma_f32_16x16x32_bf16 v[148:151], a[68:71], a[92:95], v[148:151]
    s_cbranch_scc1 L_q3_loop
L_q3_tail:
    s_waitcnt lgkmcnt(0)
    v_mfma_f32_16x16x32_bf16 v[24:27], a[20:23], a[0:3], v[24:27]
    ds_read_b128 a[52:55], v19 offset:10240
    v_mfma_f32_16x16x32_bf16 v[28:31], a[24:27], a[0:3], v[28:31]
    ds_read_b128 a[56:59], v19 offset:12288
    v_mfma_f32_16x16x32_bf16 v[32:35], a[28:31], a[0:3], v[32:35]
    ds_read_b128 a[60:63], v19 offset:14336
    v_mfma_f32_16x16x32_bf16 v[36:39], a[32:35], a[0:3], v[36:39]
    ds_read_b128 a[64:67], v19 offset:16384
    v_mfma_f32_16x16x32_bf16 v[40:43], a[0:3], a[36:39], v[40:43]
    ds_read_b128 a[68:71], v19 offset:0
    v_mfma_f32_16x16x32_bf16 v[44:47], a[0:3], a[40:43], v[44:47]
    ds_read_b64_tr_b16 a[72:73], v20 offset:33872
    v_mfma_f32_16x16x32_bf16 v[120:123], a[0:3], a[44:47], v[120:123]
    ds_read_b64_tr_b16 a[74:75], v20 offset:37712
    v_mfma_f32_16x16x32_bf16 v[48:51], a[20:23], a[4:7], v[48:51]
    ds_read_b64_tr_b16 a[76:77], v20 offset:33912
    v_mfma_f32_16x16x32_bf16 v[52:55], a[24:27], a[4:7], v[52:55]
    ds_read_b64_tr_b16 a[78:79], v20 offset:37752
    v_mfma_f32_16x16x32_bf16 v[56:59], a[28:31], a[4:7], v[56:59]
    ds_read_b64_tr_b16 a[80:81], v20 offset:34032
    v_mfma_f32_16x16x32_bf16 v[60:63], a[32:35], a[4:7], v[60:63]
    ds_read_b64_tr_b16 a[82:83], v20 offset:37872
    v_mfma_f32_16x16x32_bf16 v[64:67], a[4:7], a[36:39], v[64:67]
    ds_read_b64_tr_b16 a[84:85], v20 offset:34072
    v_mfma_f32_16x16x32_bf16 v[68:71], a[4:7], a[40:43], v[68:71]
    ds_read_b64_tr_b16 a[86:87], v20 offset:37912
    v_mfma_f32_16x16x32_bf16 v[124:127], a[4:7], a[44:47], v[124:127]
    ds_read_b64_tr_b16 a[88:89], v20 offset:34192
    v_mfma_f32_16x16x32_bf16 v[72:75], a[20:23], a[8:11], v[72:75]
    ds_read_b64_tr_b16 a[90:91], v20 offset:38032
    v_mfma_f32_16x16x32_bf16 v[76:79], a[24:27], a[8:11], v[76:79]
    ds_read_b64_tr_b16 a[92:93], v20 offset:34232
    v_mfma_f32_16x16x32_bf16 v[80:83], a[28:31], a[8:11], v[80:83]
    ds_read_b64_tr_b16 a[94:95], v20 offset:38072
    v_mfma_f32_16x16x32_bf16 v[84:87], a[32:35], a[8:11], v[84:87]
    ds_read_b64_tr_b16 a[96:97], v21 offset:34112
    v_mfma_f32_16x16x32_bf16 v[88:91], a[8:11], a[36:39], v[88:91]
    ds_read_b64_tr_b16 a[98:99], v21 offset:37952
    v_mfma_f32_16x16x32_bf16 v[92:95], a[8:11], a[40:43], v[92:95]
    ds_read_b64_tr_b16 a[100:101], v21 offset:33952
    v_mfma_f32_16x16x32_bf16 v[128:131], a[8:11], a[44:47], v[128:131]
    ds_read_b64_tr_b16 a[102:103], v21 offset:37792
    v_mfma_f32_16x16x32_bf16 v[96:99], a[20:23], a[12:15], v[96:99]
    v_mfma_f32_16x16x32_bf16 v[100:103], a[24:27], a[12:15], v[100:103]
    v_mfma_f32_16x16x32_bf16 v[104:107], a[28:31], a[12:15], v[104:107]
    v_mfma_f32_16x16x32_bf16 v[108:111], a[32:35], a[12:15], v[108:111]
    v_mfma_f32_16x16x32_bf16 v[112:115], a[12:15], a[36:39], v[112:115]
    v_mfma_f32_16x16x32_bf16 v[116:119], a[12:15], a[40:43], v[116:119]
    v_mfma_f32_16x16x32_bf16 v[132:135], a[12:15], a[44:47], v[132:135]
    v_mfma_f32_16x16x32_bf16 v[136:139], a[48:51], a[8:11], v[136:139]
    v_mfma_f32_16x16x32_bf16 v[140:143], a[48:51], a[12:15], v[140:143]
    v_mfma_f32_16x16x32_bf16 v[144:147], a[16:19], a[36:39], v[144:147]
    v_mfma_f32_16x16x32_bf16 v[148:151], a[16:19], a[40:43], v[148:151]
    s_waitcnt lgkmcnt(0)
    v_mfma_f32_16x16x32_bf16 v[120:123], a[52:55], a[96:99], v[120:123]
    v_mfma_f32_16x16x32_bf16 v[124:127], a[56:59], a[96:99], v[124:127]
    v_mfma_f32_16x16x32_bf16 v[128:131], a[60:63], a[96:99], v[128:131]
    v_mfma_f32_16x16x32_bf16 v[132:135], a[64:67], a[96:99], v[132:135]
    s_nop 4
    v_cvt_pk_bf16_f32 v120, v120, v121
    v_cvt_pk_bf16_f32 v121, v122, v123
    ds_write_b64 v156, v[120:121] offset:11776
    v_mfma_f32_16x16x32_bf16 v[136:139], a[100:103], a[60:63], v[136:139]
    v_cvt_pk_bf16_f32 v124, v124, v125
    v_cvt_pk_bf16_f32 v125, v126, v127
    ds_write_b64 v156, v[124:125] offset:12288
    v_mfma_f32_16x16x32_bf16 v[140:143], a[100:103], a[64:67], v[140:143]
    v_cvt_pk_bf16_f32 v128, v128, v129
    v_cvt_pk_bf16_f32 v129, v130, v131
    ds_write_b64 v156, v[128:129] offset:12800
    v_mfma_f32_16x16x32_bf16 v[144:147], a[68:71], a[88:91], v[144:147]
    v_cvt_pk_bf16_f32 v132, v132, v133
    v_cvt_pk_bf16_f32 v133, v134, v135
    ds_write_b64 v156, v[132:133] offset:13312
    v_mfma_f32_16x16x32_bf16 v[148:151], a[68:71], a[92:95], v[148:151]
    v_cvt_pk_bf16_f32 v136, v136, v137
    v_cvt_pk_bf16_f32 v137, v138, v139
    ds_write_b64 v156, v[136:137] offset:8192
    v_mfma_f32_16x16x32_bf16 v[104:107], a[80:83], a[64:67], v[104:107]
    v_cvt_pk_bf16_f32 v140, v140, v141
    v_cvt_pk_bf16_f32 v141, v142, v143
    ds_write_b64 v156, v[140:141] offset:8704
    v_mfma_f32_16x16x32_bf16 v[108:111], a[84:87], a[64:67], v[108:111]
    v_cvt_pk_bf16_f32 v144, v144, v145
    v_cvt_pk_bf16_f32 v145, v146, v147
    ds_write_b64 v156, v[144:145] offset:16896
    v_mfma_f32_16x16x32_bf16 v[112:115], a[64:67], a[88:91], v[112:115]
    v_cvt_pk_bf16_f32 v148, v148, v149
    v_cvt_pk_bf16_f32 v149, v150, v151
    ds_write_b64 v156, v[148:149] offset:17408
    v_mfma_f32_16x16x32_bf16 v[116:119], a[64:67], a[92:95], v[116:119]
    v_cvt_pk_bf16_f32 v104, v104, v105
    v_cvt_pk_bf16_f32 v105, v106, v107
    v_mfma_f32_16x16x32_bf16 v[32:35], a[80:83], a[52:55], v[32:35]
    v_cvt_pk_bf16_f32 v108, v108, v109
    v_cvt_pk_bf16_f32 v109, v110, v111
    v_mfma_f32_16x16x32_bf16 v[36:39], a[84:87], a[52:55], v[36:39]
    v_cvt_pk_bf16_f32 v166, v112, v113
    v_cvt_pk_bf16_f32 v167, v114, v115
    v_mfma_f32_16x16x32_bf16 v[40:43], a[52:55], a[88:91], v[40:43]
    v_cvt_pk_bf16_f32 v176, v116, v117
    v_cvt_pk_bf16_f32 v177, v118, v119
    v_mfma_f32_16x16x32_bf16 v[44:47], a[52:55], a[92:95], v[44:47]
    v_cvt_pk_bf16_f32 v32, v32, v33
    v_cvt_pk_bf16_f32 v33, v34, v35
    v_mfma_f32_16x16x32_bf16 v[56:59], a[80:83], a[56:59], v[56:59]
    v_cvt_pk_bf16_f32 v36, v36, v37
    v_cvt_pk_bf16_f32 v37, v38, v39
    v_mfma_f32_16x16x32_bf16 v[60:63], a[84:87], a[56:59], v[60:63]
    v_cvt_pk_bf16_f32 v160, v40, v41
    v_cvt_pk_bf16_f32 v161, v42, v43
    v_mfma_f32_16x16x32_bf16 v[64:67], a[56:59], a[88:91], v[64:67]
    v_cvt_pk_bf16_f32 v170, v44, v45
    v_cvt_pk_bf16_f32 v171, v46, v47
    v_mfma_f32_16x16x32_bf16 v[68:71], a[56:59], a[92:95], v[68:71]
    v_cvt_pk_bf16_f32 v56, v56, v57
    v_cvt_pk_bf16_f32 v57, v58, v59
    v_mfma_f32_16x16x32_bf16 v[80:83], a[80:83], a[60:63], v[80:83]
    v_cvt_pk_bf16_f32 v60, v60, v61
    v_cvt_pk_bf16_f32 v61, v62, v63
    v_mfma_f32_16x16x32_bf16 v[84:87], a[84:87], a[60:63], v[84:87]
    v_cvt_pk_bf16_f32 v162, v64, v65
    v_cvt_pk_bf16_f32 v163, v66, v67
    v_mfma_f32_16x16x32_bf16 v[88:91], a[60:63], a[88:91], v[88:91]
    v_cvt_pk_bf16_f32 v172, v68, v69
    v_cvt_pk_bf16_f32 v173, v70, v71
    v_mfma_f32_16x16x32_bf16 v[92:95], a[60:63], a[92:95], v[92:95]
    v_cvt_pk_bf16_f32 v80, v80, v81
    v_cvt_pk_bf16_f32 v81, v82, v83
    v_mfma_f32_16x16x32_bf16 v[24:27], a[72:75], a[52:55], v[24:27]
    v_cvt_pk_bf16_f32 v84, v84, v85
    v_cvt_pk_bf16_f32 v85, v86, v87
    s_waitcnt lgkmcnt(0)
    s_barrier
    v_mfma_f32_16x16x32_bf16 v[28:31], a[76:79], a[52:55], v[28:31]
    ds_read_b64 v[214:215], v156 offset:2560
    ds_read_b64 v[216:217], v156 offset:3072
    ds_read_b64 v[218:219], v156 offset:3584
    v_mfma_f32_16x16x32_bf16 v[48:51], a[72:75], a[56:59], v[48:51]
    ds_read_b64 v[220:221], v156 offset:4096
    ds_read_b64 v[188:189], v156 offset:18944
    ds_read_b64 v[190:191], v156 offset:6656
    v_mfma_f32_16x16x32_bf16 v[52:55], a[76:79], a[56:59], v[52:55]
    ds_read_b64 v[158:159], v156 offset:20992
    ds_read_b64 v[192:193], v156 offset:19456
    ds_read_b64 v[194:195], v156 offset:6656
    v_mfma_f32_16x16x32_bf16 v[72:75], a[72:75], a[60:63], v[72:75]
    ds_read_b64 v[168:169], v156 offset:21504
    ds_read_b64 v[178:179], v156 offset:11264
    ds_read_b64 v[180:181], v156 offset:11776
    v_mfma_f32_16x16x32_bf16 v[76:79], a[76:79], a[60:63], v[76:79]
    ds_read_b64 v[182:183], v156 offset:12288
    ds_read_b64 v[184:185], v156 offset:12800
    ds_read_b64 v[186:187], v156 offset:13312
    v_mfma_f32_16x16x32_bf16 v[96:99], a[72:75], a[64:67], v[96:99]
    s_waitcnt lgkmcnt(7)
    ds_read_b64 v[106:107], v156 offset:8704
    ds_read_b64 v[110:111], v156 offset:8704
    ds_read_b64 v[34:35], v156 offset:7168
    v_mfma_f32_16x16x32_bf16 v[100:103], a[76:79], a[64:67], v[100:103]
    ds_read_b64 v[38:39], v156 offset:7168
    ds_read_b64 v[58:59], v156 offset:7680
    ds_read_b64 v[62:63], v156 offset:7680
    ds_read_b64 v[82:83], v156 offset:8192
    ds_read_b64 v[86:87], v156 offset:8192
    v_cvt_pk_bf16_f32 v164, v88, v89
    v_cvt_pk_bf16_f32 v165, v90, v91
    v_cvt_pk_bf16_f32 v174, v92, v93
    v_cvt_pk_bf16_f32 v175, v94, v95
    v_cvt_pk_bf16_f32 v24, v24, v25
    v_cvt_pk_bf16_f32 v25, v26, v27
    v_cvt_pk_bf16_f32 v28, v28, v29
    v_cvt_pk_bf16_f32 v29, v30, v31
    v_cvt_pk_bf16_f32 v48, v48, v49
    v_cvt_pk_bf16_f32 v49, v50, v51
    v_cvt_pk_bf16_f32 v52, v52, v53
    v_cvt_pk_bf16_f32 v53, v54, v55
    v_cvt_pk_bf16_f32 v72, v72, v73
    v_cvt_pk_bf16_f32 v73, v74, v75
    v_cvt_pk_bf16_f32 v76, v76, v77
    v_cvt_pk_bf16_f32 v77, v78, v79
    v_cvt_pk_bf16_f32 v96, v96, v97
    v_cvt_pk_bf16_f32 v97, v98, v99
    v_cvt_pk_bf16_f32 v100, v100, v101
    v_cvt_pk_bf16_f32 v101, v102, v103
    s_waitcnt lgkmcnt(0)
    v_and_b32 v26, v212, v214
    v_and_b32 v27, v212, v215
    v_and_b32 v30, v213, v214
    v_and_b32 v31, v213, v215
    v_and_b32 v50, v212, v216
    v_and_b32 v51, v212, v217
    v_and_b32 v54, v213, v216
    v_and_b32 v55, v213, v217
    v_and_b32 v74, v212, v218
    v_and_b32 v75, v212, v219
    v_and_b32 v78, v213, v218
    v_and_b32 v79, v213, v219
    v_and_b32 v98, v212, v220
    v_and_b32 v99, v212, v221
    v_and_b32 v102, v213, v220
    v_and_b32 v103, v213, v221
    v_mfma_f32_16x16x32_bf16 v[40:43], v[188:191], v[24:27], v[200:203]
    v_mfma_f32_16x16x32_bf16 v[64:67], v[192:195], v[28:31], v[200:203]
    v_mfma_f32_16x16x32_bf16 v[88:91], v[32:35], v[48:51], v[200:203]
    v_mfma_f32_16x16x32_bf16 v[112:115], v[36:39], v[52:55], v[200:203]
    v_mfma_f32_16x16x32_bf16 v[44:47], v[32:35], v[24:27], v[196:199]
    v_mfma_f32_16x16x32_bf16 v[68:71], v[36:39], v[28:31], v[196:199]
    v_mfma_f32_16x16x32_bf16 v[92:95], v[56:59], v[48:51], v[196:199]
    v_mfma_f32_16x16x32_bf16 v[116:119], v[60:63], v[52:55], v[196:199]
    s_nop 4
    v_max_f32 v40, v40, v44
    v_max_f32 v64, v64, v68
    v_max_f32 v88, v88, v92
    v_max_f32 v112, v112, v116
    v_max_f32 v41, v41, v45
    v_max_f32 v65, v65, v69
    v_max_f32 v89, v89, v93
    v_max_f32 v113, v113, v117
    v_max_f32 v42, v42, v46
    v_max_f32 v66, v66, v70
    v_max_f32 v90, v90, v94
    v_max_f32 v114, v114, v118
    v_max_f32 v43, v43, v47
    v_max_f32 v67, v67, v71
    v_max_f32 v91, v91, v95
    v_max_f32 v115, v115, v119
    v_max3_f32 v120, v40, v41, v42
    v_max3_f32 v128, v64, v65, v66
    v_max3_f32 v136, v88, v89, v90
    v_max3_f32 v144, v112, v113, v114
    v_max_f32 v120, v120, v43
    v_max_f32 v128, v128, v67
    v_max_f32 v136, v136, v91
    v_max_f32 v144, v144, v115
    v_mov_b32 v122, v120
    v_mov_b32 v130, v128
    v_mov_b32 v138, v136
    v_mov_b32 v146, v144
    v_permlane16_swap_b32 v120, v122
    v_permlane16_swap_b32 v128, v130
    v_permlane16_swap_b32 v136, v138
    v_permlane16_swap_b32 v144, v146
    v_max_f32 v120, v120, v122
    v_max_f32 v128, v128, v130
    v_max_f32 v136, v136, v138
    v_max_f32 v144, v144, v146
    v_mov_b32 v122, v120
    v_mov_b32 v130, v128
    v_mov_b32 v138, v136
    v_mov_b32 v146, v144
    v_permlane32_swap_b32 v120, v122
    v_permlane32_swap_b32 v128, v130
    v_permlane32_swap_b32 v136, v138
    v_permlane32_swap_b32 v144, v146
    v_max_f32 v120, v120, v122
    v_max_f32 v128, v128, v130
    v_max_f32 v136, v136, v138
    v_max_f32 v144, v144, v146
    v_mul_f32 v120, s62, v120
    v_mul_f32 v128, s62, v128
    v_mul_f32 v136, s62, v136
    v_mul_f32 v144, s62, v144
    v_pk_fma_f32 v[40:41], v[40:41], s[62:63], v[120:121] op_sel_hi:[1,0,0] neg_lo:[0,0,1] neg_hi:[0,0,1]
    v_pk_fma_f32 v[64:65], v[64:65], s[62:63], v[128:129] op_sel_hi:[1,0,0] neg_lo:[0,0,1] neg_hi:[0,0,1]
    v_pk_fma_f32 v[88:89], v[88:89], s[62:63], v[136:137] op_sel_hi:[1,0,0] neg_lo:[0,0,1] neg_hi:[0,0,1]
    v_pk_fma_f32 v[112:113], v[112:113], s[62:63], v[144:145] op_sel_hi:[1,0,0] neg_lo:[0,0,1] neg_hi:[0,0,1]
    v_pk_fma_f32 v[42:43], v[42:43], s[62:63], v[120:121] op_sel_hi:[1,0,0] neg_lo:[0,0,1] neg_hi:[0,0,1]
    v_pk_fma_f32 v[66:67], v[66:67], s[62:63], v[128:129] op_sel_hi:[1,0,0] neg_lo:[0,0,1] neg_hi:[0,0,1]
    v_pk_fma_f32 v[90:91], v[90:91], s[62:63], v[136:137] op_sel_hi:[1,0,0] neg_lo:[0,0,1] neg_hi:[0,0,1]
    v_pk_fma_f32 v[114:115], v[114:115], s[62:63], v[144:145] op_sel_hi:[1,0,0] neg_lo:[0,0,1] neg_hi:[0,0,1]
    v_exp_f32 v40, v40
    v_exp_f32 v64, v64
    v_exp_f32 v88, v88
    v_exp_f32 v112, v112
    v_exp_f32 v41, v41
    v_exp_f32 v65, v65
    v_exp_f32 v89, v89
    v_exp_f32 v113, v113
    v_exp_f32 v42, v42
    v_exp_f32 v66, v66
    v_exp_f32 v90, v90
    v_exp_f32 v114, v114
    v_exp_f32 v43, v43
    v_exp_f32 v67, v67
    v_exp_f32 v91, v91
    v_exp_f32 v115, v115
    v_cvt_pk_bf16_f32 v44, v40, v41
    v_cvt_pk_bf16_f32 v68, v64, v65
    v_cvt_pk_bf16_f32 v92, v88, v89
    v_cvt_pk_bf16_f32 v116, v112, v113
    v_cvt_pk_bf16_f32 v45, v42, v43
    v_cvt_pk_bf16_f32 v69, v66, v67
    v_cvt_pk_bf16_f32 v93, v90, v91
    v_cvt_pk_bf16_f32 v117, v114, v115
    v_and_b32 v40, v222, v44
    v_and_b32 v64, v222, v68
    v_and_b32 v88, v222, v92
    v_and_b32 v112, v222, v116
    v_and_b32 v41, v223, v45
    v_and_b32 v65, v223, v69
    v_and_b32 v89, v223, v93
    v_and_b32 v113, v223, v117
    v_and_b32 v42, v6, v44
    v_and_b32 v66, v6, v68
    v_and_b32 v90, v6, v92
    v_and_b32 v114, v6, v116
    v_and_b32 v43, v7, v45
    v_and_b32 v67, v7, v69
    v_and_b32 v91, v7, v93
    v_and_b32 v115, v7, v117
    v_mfma_f32_16x16x32_bf16 v[124:127], v[208:211], v[40:43], 0
    v_mfma_f32_16x16x32_bf16 v[132:135], v[208:211], v[64:67], 0
    v_mfma_f32_16x16x32_bf16 v[140:143], v[208:211], v[88:91], 0
    v_mfma_f32_16x16x32_bf16 v[148:151], v[208:211], v[112:115], 0
    v_mfma_f32_16x16x32_bf16 v[224:227], v[158:161], v[40:43], 0
    v_mfma_f32_16x16x32_bf16 v[232:235], v[168:171], v[64:67], 0
    v_mfma_f32_16x16x32_bf16 v[240:243], v[160:163], v[88:91], 0
    v_mfma_f32_16x16x32_bf16 v[248:251], v[170:173], v[112:115], 0
    v_mfma_f32_16x16x32_bf16 v[228:231], v[178:181], v[40:43], 0
    v_mfma_f32_16x16x32_bf16 v[236:239], v[178:181], v[64:67], 0
    v_mfma_f32_16x16x32_bf16 v[244:247], v[180:183], v[88:91], 0
    v_mfma_f32_16x16x32_bf16 v[252:255], v[180:183], v[112:115], 0
    v_rcp_f32 v120, v124
    v_rcp_f32 v128, v132
    v_rcp_f32 v136, v140
    v_rcp_f32 v144, v148
    v_pk_mul_f32 v[224:225], v[224:225], v[120:121] op_sel_hi:[1,0]
    v_pk_mul_f32 v[232:233], v[232:233], v[128:129] op_sel_hi:[1,0]
    v_pk_mul_f32 v[240:241], v[240:241], v[136:137] op_sel_hi:[1,0]
    v_pk_mul_f32 v[248:249], v[248:249], v[144:145] op_sel_hi:[1,0]
    v_pk_mul_f32 v[226:227], v[226:227], v[120:121] op_sel_hi:[1,0]
    v_pk_mul_f32 v[234:235], v[234:235], v[128:129] op_sel_hi:[1,0]
    v_pk_mul_f32 v[242:243], v[242:243], v[136:137] op_sel_hi:[1,0]
    v_pk_mul_f32 v[250:251], v[250:251], v[144:145] op_sel_hi:[1,0]
    v_pk_mul_f32 v[228:229], v[228:229], v[120:121] op_sel_hi:[1,0]
    v_pk_mul_f32 v[236:237], v[236:237], v[128:129] op_sel_hi:[1,0]
    v_pk_mul_f32 v[244:245], v[244:245], v[136:137] op_sel_hi:[1,0]
    v_pk_mul_f32 v[252:253], v[252:253], v[144:145] op_sel_hi:[1,0]
    v_pk_mul_f32 v[230:231], v[230:231], v[120:121] op_sel_hi:[1,0]
    v_pk_mul_f32 v[238:239], v[238:239], v[128:129] op_sel_hi:[1,0]
    v_pk_mul_f32 v[246:247], v[246:247], v[136:137] op_sel_hi:[1,0]
    v_pk_mul_f32 v[254:255], v[254:255], v[144:145] op_sel_hi:[1,0]
    v_cvt_pk_bf16_f32 v24, v224, v225
    v_cvt_pk_bf16_f32 v26, v232, v233
    v_cvt_pk_bf16_f32 v48, v240, v241
    v_cvt_pk_bf16_f32 v50, v248, v249
    v_cvt_pk_bf16_f32 v25, v226, v227
    v_cvt_pk_bf16_f32 v27, v234, v235
    v_cvt_pk_bf16_f32 v49, v242, v243
    v_cvt_pk_bf16_f32 v51, v250, v251
    v_cvt_pk_bf16_f32 v228, v228, v229
    v_cvt_pk_bf16_f32 v236, v236, v237
    v_cvt_pk_bf16_f32 v244, v244, v245
    v_cvt_pk_bf16_f32 v252, v252, v253
    v_cvt_pk_bf16_f32 v229, v230, v231
    v_cvt_pk_bf16_f32 v237, v238, v239
    v_cvt_pk_bf16_f32 v245, v246, v247
    v_cvt_pk_bf16_f32 v253, v254, v255
    v_cndmask_b32 v228, v228, v236, s[68:69]
    v_cndmask_b32 v229, v229, v237, s[68:69]
    s_add_u32 s59, s57, 0x0
    buffer_store_dwordx4 v[24:27], v157, s[32:35], s59 offen sc1
    s_add_u32 s60, s58, 0x0
    s_mov_b32 exec_lo, 0
    buffer_store_dwordx2 v[228:229], v157, s[32:35], s60 offen
    s_mov_b64 exec, -1
    v_cndmask_b32 v244, v244, v252, s[68:69]
    v_cndmask_b32 v245, v245, v253, s[68:69]
    s_add_u32 s59, s57, 0x11000
    buffer_store_dwordx4 v[48:51], v157, s[32:35], s59 offen sc1
    s_add_u32 s60, s58, 0x11000
    s_mov_b32 exec_lo, 0
    buffer_store_dwordx2 v[244:245], v157, s[32:35], s60 offen
    s_mov_b64 exec, -1
    v_mfma_f32_16x16x32_bf16 v[40:43], v[56:59], v[72:75], v[200:203]
    v_mfma_f32_16x16x32_bf16 v[64:67], v[60:63], v[76:79], v[200:203]
    v_mfma_f32_16x16x32_bf16 v[88:91], v[80:83], v[96:99], v[200:203]
    v_mfma_f32_16x16x32_bf16 v[112:115], v[84:87], v[100:103], v[200:203]
    v_mfma_f32_16x16x32_bf16 v[44:47], v[80:83], v[72:75], v[196:199]
    v_mfma_f32_16x16x32_bf16 v[68:71], v[84:87], v[76:79], v[196:199]
    v_mfma_f32_16x16x32_bf16 v[92:95], v[104:107], v[96:99], v[196:199]
    v_mfma_f32_16x16x32_bf16 v[116:119], v[108:111], v[100:103], v[196:199]
    s_nop 4
    v_max_f32 v40, v40, v44
    v_max_f32 v64, v64, v68
    v_max_f32 v88, v88, v92
    v_max_f32 v112, v112, v116
    v_max_f32 v41, v41, v45
    v_max_f32 v65, v65, v69
    v_max_f32 v89, v89, v93
    v_max_f32 v113, v113, v117
    v_max_f32 v42, v42, v46
    v_max_f32 v66, v66, v70
    v_max_f32 v90, v90, v94
    v_max_f32 v114, v114, v118
    v_max_f32 v43, v43, v47
    v_max_f32 v67, v67, v71
    v_max_f32 v91, v91, v95
    v_max_f32 v115, v115, v119
    v_max3_f32 v120, v40, v41, v42
    v_max3_f32 v128, v64, v65, v66
    v_max3_f32 v136, v88, v89, v90
    v_max3_f32 v144, v112, v113, v114
    v_max_f32 v120, v120, v43
    v_max_f32 v128, v128, v67
    v_max_f32 v136, v136, v91
    v_max_f32 v144, v144, v115
    v_mov_b32 v122, v120
    v_mov_b32 v130, v128
    v_mov_b32 v138, v136
    v_mov_b32 v146, v144
    v_permlane16_swap_b32 v120, v122
    v_permlane16_swap_b32 v128, v130
    v_permlane16_swap_b32 v136, v138
    v_permlane16_swap_b32 v144, v146
    v_max_f32 v120, v120, v122
    v_max_f32 v128, v128, v130
    v_max_f32 v136, v136, v138
    v_max_f32 v144, v144, v146
    v_mov_b32 v122, v120
    v_mov_b32 v130, v128
    v_mov_b32 v138, v136
    v_mov_b32 v146, v144
    v_permlane32_swap_b32 v120, v122
    v_permlane32_swap_b32 v128, v130
    v_permlane32_swap_b32 v136, v138
    v_permlane32_swap_b32 v144, v146
    v_max_f32 v120, v120, v122
    v_max_f32 v128, v128, v130
    v_max_f32 v136, v136, v138
    v_max_f32 v144, v144, v146
    v_mul_f32 v120, s62, v120
    v_mul_f32 v128, s62, v128
    v_mul_f32 v136, s62, v136
    v_mul_f32 v144, s62, v144
    v_pk_fma_f32 v[40:41], v[40:41], s[62:63], v[120:121] op_sel_hi:[1,0,0] neg_lo:[0,0,1] neg_hi:[0,0,1]
    v_pk_fma_f32 v[64:65], v[64:65], s[62:63], v[128:129] op_sel_hi:[1,0,0] neg_lo:[0,0,1] neg_hi:[0,0,1]
    v_pk_fma_f32 v[88:89], v[88:89], s[62:63], v[136:137] op_sel_hi:[1,0,0] neg_lo:[0,0,1] neg_hi:[0,0,1]
    v_pk_fma_f32 v[112:113], v[112:113], s[62:63], v[144:145] op_sel_hi:[1,0,0] neg_lo:[0,0,1] neg_hi:[0,0,1]
    v_pk_fma_f32 v[42:43], v[42:43], s[62:63], v[120:121] op_sel_hi:[1,0,0] neg_lo:[0,0,1] neg_hi:[0,0,1]
    v_pk_fma_f32 v[66:67], v[66:67], s[62:63], v[128:129] op_sel_hi:[1,0,0] neg_lo:[0,0,1] neg_hi:[0,0,1]
    v_pk_fma_f32 v[90:91], v[90:91], s[62:63], v[136:137] op_sel_hi:[1,0,0] neg_lo:[0,0,1] neg_hi:[0,0,1]
    v_pk_fma_f32 v[114:115], v[114:115], s[62:63], v[144:145] op_sel_hi:[1,0,0] neg_lo:[0,0,1] neg_hi:[0,0,1]
    v_exp_f32 v40, v40
    v_exp_f32 v64, v64
    v_exp_f32 v88, v88
    v_exp_f32 v112, v112
    v_exp_f32 v41, v41
    v_exp_f32 v65, v65
    v_exp_f32 v89, v89
    v_exp_f32 v113, v113
    v_exp_f32 v42, v42
    v_exp_f32 v66, v66
    v_exp_f32 v90, v90
    v_exp_f32 v114, v114
    v_exp_f32 v43, v43
    v_exp_f32 v67, v67
    v_exp_f32 v91, v91
    v_exp_f32 v115, v115
    v_cvt_pk_bf16_f32 v44, v40, v41
    v_cvt_pk_bf16_f32 v68, v64, v65
    v_cvt_pk_bf16_f32 v92, v88, v89
    v_cvt_pk_bf16_f32 v116, v112, v113
    v_cvt_pk_bf16_f32 v45, v42, v43
    v_cvt_pk_bf16_f32 v69, v66, v67
    v_cvt_pk_bf16_f32 v93, v90, v91
    v_cvt_pk_bf16_f32 v117, v114, v115
    v_and_b32 v40, v222, v44
    v_and_b32 v64, v222, v68
    v_and_b32 v88, v222, v92
    v_and_b32 v112, v222, v116
    v_and_b32 v41, v223, v45
    v_and_b32 v65, v223, v69
    v_and_b32 v89, v223, v93
    v_and_b32 v113, v223, v117
    v_and_b32 v42, v6, v44
    v_and_b32 v66, v6, v68
    v_and_b32 v90, v6, v92
    v_and_b32 v114, v6, v116
    v_and_b32 v43, v7, v45
    v_and_b32 v67, v7, v69
    v_and_b32 v91, v7, v93
    v_and_b32 v115, v7, v117
    v_mfma_f32_16x16x32_bf16 v[124:127], v[208:211], v[40:43], 0
    v_mfma_f32_16x16x32_bf16 v[132:135], v[208:211], v[64:67], 0
    v_mfma_f32_16x16x32_bf16 v[140:143], v[208:211], v[88:91], 0
    v_mfma_f32_16x16x32_bf16 v[148:151], v[208:211], v[112:115], 0
    v_mfma_f32_16x16x32_bf16 v[224:227], v[162:165], v[40:43], 0
    v_mfma_f32_16x16x32_bf16 v[232:235], v[172:175], v[64:67], 0
    v_mfma_f32_16x16x32_bf16 v[240:243], v[164:167], v[88:91], 0
    v_mfma_f32_16x16x32_bf16 v[248:251], v[174:177], v[112:115], 0
    v_mfma_f32_16x16x32_bf16 v[228:231], v[182:185], v[40:43], 0
    v_mfma_f32_16x16x32_bf16 v[236:239], v[182:185], v[64:67], 0
    v_mfma_f32_16x16x32_bf16 v[244:247], v[184:187], v[88:91], 0
    v_mfma_f32_16x16x32_bf16 v[252:255], v[184:187], v[112:115], 0
    v_rcp_f32 v120, v124
    v_rcp_f32 v128, v132
    v_rcp_f32 v136, v140
    v_rcp_f32 v144, v148
    v_pk_mul_f32 v[224:225], v[224:225], v[120:121] op_sel_hi:[1,0]
    v_pk_mul_f32 v[232:233], v[232:233], v[128:129] op_sel_hi:[1,0]
    v_pk_mul_f32 v[240:241], v[240:241], v[136:137] op_sel_hi:[1,0]
    v_pk_mul_f32 v[248:249], v[248:249], v[144:145] op_sel_hi:[1,0]
    v_pk_mul_f32 v[226:227], v[226:227], v[120:121] op_sel_hi:[1,0]
    v_pk_mul_f32 v[234:235], v[234:235], v[128:129] op_sel_hi:[1,0]
    v_pk_mul_f32 v[242:243], v[242:243], v[136:137] op_sel_hi:[1,0]
    v_pk_mul_f32 v[250:251], v[250:251], v[144:145] op_sel_hi:[1,0]
    v_pk_mul_f32 v[228:229], v[228:229], v[120:121] op_sel_hi:[1,0]
    v_pk_mul_f32 v[236:237], v[236:237], v[128:129] op_sel_hi:[1,0]
    v_pk_mul_f32 v[244:245], v[244:245], v[136:137] op_sel_hi:[1,0]
    v_pk_mul_f32 v[252:253], v[252:253], v[144:145] op_sel_hi:[1,0]
    v_pk_mul_f32 v[230:231], v[230:231], v[120:121] op_sel_hi:[1,0]
    v_pk_mul_f32 v[238:239], v[238:239], v[128:129] op_sel_hi:[1,0]
    v_pk_mul_f32 v[246:247], v[246:247], v[136:137] op_sel_hi:[1,0]
    v_pk_mul_f32 v[254:255], v[254:255], v[144:145] op_sel_hi:[1,0]
    v_cvt_pk_bf16_f32 v72, v224, v225
    v_cvt_pk_bf16_f32 v74, v232, v233
    v_cvt_pk_bf16_f32 v96, v240, v241
    v_cvt_pk_bf16_f32 v98, v248, v249
    v_cvt_pk_bf16_f32 v73, v226, v227
    v_cvt_pk_bf16_f32 v75, v234, v235
    v_cvt_pk_bf16_f32 v97, v242, v243
    v_cvt_pk_bf16_f32 v99, v250, v251
    v_cvt_pk_bf16_f32 v228, v228, v229
    v_cvt_pk_bf16_f32 v236, v236, v237
    v_cvt_pk_bf16_f32 v244, v244, v245
    v_cvt_pk_bf16_f32 v252, v252, v253
    v_cvt_pk_bf16_f32 v229, v230, v231
    v_cvt_pk_bf16_f32 v237, v238, v239
    v_cvt_pk_bf16_f32 v245, v246, v247
    v_cvt_pk_bf16_f32 v253, v254, v255
    v_cndmask_b32 v228, v228, v236, s[68:69]
    v_cndmask_b32 v229, v229, v237, s[68:69]
    s_add_u32 s59, s57, 0x22000
    buffer_store_dwordx4 v[72:75], v157, s[32:35], s59 offen sc1
    s_add_u32 s60, s58, 0x22000
    s_mov_b32 exec_lo, 0
    buffer_store_dwordx2 v[228:229], v157, s[32:35], s60 offen
    s_mov_b64 exec, -1
    v_cndmask_b32 v244, v244, v252, s[68:69]
    v_cndmask_b32 v245, v245, v253, s[68:69]
    s_add_u32 s59, s57, 0x33000
    buffer_store_dwordx4 v[96:99], v157, s[32:35], s59 offen sc1
    s_add_u32 s60, s58, 0x33000
    s_mov_b32 exec_lo, 0
    buffer_store_dwordx2 v[244:245], v157, s[32:35], s60 offen
    s_mov_b64 exec, -1
    s_endpgm
L_q3_end:
L_h:
    s_lshr_b32 s61, s47, 1
    v_lshrrev_b32 v1, 3, v0
    v_mul_u32_u24 v1, 0xa00, v1
    v_lshrrev_b32 v2, 4, v0
    v_xor_b32 v2, v2, v0
    v_and_b32 v2, 7, v2
    v_lshl_add_u32 v3, v2, 4, v1
    v_xor_b32 v4, 64, v3
    s_lshl_b32 s56, s45, 8
    s_add_u32 s56, s56, s44
    s_lshl_b32 s57, s47, 6
    s_add_u32 s57, s57, s56
    s_mul_i32 s57, s57, 0x500
    s_add_u32 s59, s57, 0x0
    v_add_u32 v14, s59, v3
    s_add_u32 s59, s57, 0x5000
    v_add_u32 v15, s59, v4
    s_add_u32 s59, s57, 0xa000
    v_add_u32 v16, s59, v3
    s_add_u32 s59, s57, 0xf000
    v_add_u32 v17, s59, v4
    s_mul_i32 s60, s46, 384
    s_mul_i32 s59, s47, 0xc000
    s_add_u32 s60, s60, s59
    v_add_u32 v1, 0x0, v0
    v_mul_u32_u24 v2, 0xaab, v1
    v_lshrrev_b32 v2, 16, v2
    v_mul_u32_u24 v5, 24, v2
    v_sub_u32 v1, v1, v5
    v_and_b32 v5, 2, v2
    v_lshrrev_b32 v6, 1, v2
    v_and_or_b32 v5, v6, 4, v5
    v_xor_b32 v1, v1, v5
    v_mul_u32_u24 v2, 0xc00, v2
    v_lshl_add_u32 v1, v1, 4, v2
    v_add_u32 v8, s60, v1
    v_add_u32 v1, 0x40, v0
    v_mul_u32_u24 v2, 0xaab, v1
    v_lshrrev_b32 v2, 16, v2
    v_mul_u32_u24 v5, 24, v2
    v_sub_u32 v1, v1, v5
    v_and_b32 v5, 2, v2
    v_lshrrev_b32 v6, 1, v2
    v_and_or_b32 v5, v6, 4, v5
    v_xor_b32 v1, v1, v5
    v_mul_u32_u24 v2, 0xc00, v2
    v_lshl_add_u32 v1, v1, 4, v2
    v_add_u32 v9, s60, v1
    v_add_u32 v1, 0x80, v0
    v_mul_u32_u24 v2, 0xaab, v1
    v_lshrrev_b32 v2, 16, v2
    v_mul_u32_u24 v5, 24, v2
    v_sub_u32 v1, v1, v5
    v_and_b32 v5, 2, v2
    v_lshrrev_b32 v6, 1, v2
    v_and_or_b32 v5, v6, 4, v5
    v_xor_b32 v1, v1, v5
    v_mul_u32_u24 v2, 0xc00, v2
    v_lshl_add_u32 v1, v1, 4, v2
    v_add_u32 v10, s60, v1
    v_add_u32 v1, 0xc0, v0
    v_mul_u32_u24 v2, 0xaab, v1
    v_lshrrev_b32 v2, 16, v2
    v_mul_u32_u24 v5, 24, v2
    v_sub_u32 v1, v1, v5
    v_and_b32 v5, 2, v2
    v_lshrrev_b32 v6, 1, v2
    v_and_or_b32 v5, v6, 4, v5
    v_xor_b32 v1, v1, v5
    v_mul_u32_u24 v2, 0xc00, v2
    v_lshl_add_u32 v1, v1, 4, v2
    v_add_u32 v11, s60, v1
    v_add_u32 v1, 0x100, v0
    v_mul_u32_u24 v2, 0xaab, v1
    v_lshrrev_b32 v2, 16, v2
    v_mul_u32_u24 v5, 24, v2
    v_sub_u32 v1, v1, v5
    v_and_b32 v5, 2, v2
    v_lshrrev_b32 v6, 1, v2
    v_and_or_b32 v5, v6, 4, v5
    v_xor_b32 v1, v1, v5
    v_mul_u32_u24 v2, 0xc00, v2
    v_lshl_add_u32 v1, v1, 4, v2
    v_add_u32 v12, s60, v1
    v_add_u32 v1, 0x140, v0
    v_mul_u32_u24 v2, 0xaab, v1
    v_lshrrev_b32 v2, 16, v2
    v_mul_u32_u24 v5, 24, v2
    v_sub_u32 v1, v1, v5
    v_and_b32 v5, 2, v2
    v_lshrrev_b32 v6, 1, v2
    v_and_or_b32 v5, v6, 4, v5
    v_xor_b32 v1, v1, v5
    v_mul_u32_u24 v2, 0xc00, v2
    v_lshl_add_u32 v1, v1, 4, v2
    v_add_u32 v13, s60, v1
    v_and_b32 v1, 15, v0
    v_lshrrev_b32 v2, 4, v0
    s_and_b32 s58, s47, 1
    s_mul_i32 s59, s58, 192
    s_mul_i32 s60, s46, 384
    s_add_u32 s59, s59, s60
    v_lshlrev_b32 v5, 3, v2
    s_lshl_b32 s49, s47, 12
    s_mul_i32 s68, s47, 6144
    s_mov_b32 s64, s49
    s_mov_b32 s65, s68
    s_and_b32 s50, s46, 1
    s_lshl_b32 s50, s50, 1
    s_add_u32 s50, s50, s45
    s_add_u32 s50, s50, 1
    s_mul_i32 s48, s50, 52
    s_lshr_b32 s48, s48, 8
    s_mul_i32 s48, s48, 5
    s_sub_u32 s50, s50, s48
    s_mul_i32 s50, s50, 32
    s_lshr_b32 s50, s50, 4
    s_mul_i32 s48, s50, 0x30000
    s_lshl_b32 s50, s50, 7
    s_mov_b32 s51, 0
    s_mov_b32 s55, 0
    s_mov_b32 s52, 0
    s_waitcnt lgkmcnt(0)
    s_mov_b32 s24, s4
    s_mov_b32 s25, s5
    s_mov_b32 s26, 0x280000
    s_mov_b32 s27, 0x20000
    s_mov_b32 s28, s12
    s_mov_b32 s29, s13
    s_mov_b32 s30, 0x1e0000
    s_mov_b32 s31, 0x20000
    s_mov_b32 s40, s14
    s_mov_b32 s41, s15
    s_mov_b32 s42, 0xc00
    s_mov_b32 s43, 0x20000
    buffer_load_dwordx2 v[200:201], v5, s[40:43], s59 offen offset:0
    buffer_load_dwordx2 v[202:203], v5, s[40:43], s59 offen offset:32
    buffer_load_dwordx2 v[204:205], v5, s[40:43], s59 offen offset:64
    buffer_load_dwordx2 v[206:207], v5, s[40:43], s59 offen offset:96
    buffer_load_dwordx2 v[208:209], v5, s[40:43], s59 offen offset:128
    buffer_load_dwordx2 v[210:211], v5, s[40:43], s59 offen offset:160
    s_mov_b32 s36, s18
    s_mov_b32 s37, s19
    s_mov_b32 s38, 0x500
    s_mov_b32 s39, 0x20000
    v_lshlrev_b32 v195, 4, v1
    buffer_load_dwordx4 v[172:175], v195, s[36:39], 0 offen offset:0
    buffer_load_dwordx4 v[176:179], v195, s[36:39], 0 offen offset:256
    buffer_load_dwordx4 v[180:183], v195, s[36:39], 0 offen offset:512
    buffer_load_dwordx4 v[184:187], v195, s[36:39], 0 offen offset:768
    buffer_load_dwordx4 v[188:191], v195, s[36:39], 0 offen offset:1024
    s_add_u32 m0, s64, 0x0
    s_nop 0
    buffer_load_dwordx4 v14, s[24:27], s50 offen lds
    s_add_u32 m0, s64, 0x400
    s_nop 0
    buffer_load_dwordx4 v15, s[24:27], s50 offen lds
    s_add_u32 m0, s64, 0x800
    s_nop 0
    buffer_load_dwordx4 v16, s[24:27], s50 offen lds
    s_add_u32 m0, s64, 0xc00
    s_nop 0
    buffer_load_dwordx4 v17, s[24:27], s50 offen lds
    s_add_u32 m0, s65, 0x4000
    s_nop 0
    buffer_load_dwordx4 v8, s[28:31], s48 offen lds
    s_add_u32 m0, s65, 0x4400
    s_nop 0
    buffer_load_dwordx4 v9, s[28:31], s48 offen lds
    s_add_u32 m0, s65, 0x4800
    s_nop 0
    buffer_load_dwordx4 v10, s[28:31], s48 offen lds
    s_add_u32 m0, s65, 0x4c00
    s_nop 0
    buffer_load_dwordx4 v11, s[28:31], s48 offen lds
    s_add_u32 m0, s65, 0x5000
    s_nop 0
    buffer_load_dwordx4 v12, s[28:31], s48 offen lds
    s_add_u32 m0, s65, 0x5400
    s_nop 0
    buffer_load_dwordx4 v13, s[28:31], s48 offen lds
    s_add_u32 s48, s48, 0x30000
    s_add_u32 s55, s55, 1
    s_add_u32 s50, s50, 0x80
    s_cmp_eq_u32 s50, 0x500
    s_cselect_b32 s50, 0, s50
    s_cselect_b32 s48, 0, s48
    s_cmp_ge_u32 s55, 10
    s_cselect_b32 s50, 0x7f000000, s50
    s_cselect_b32 s48, 0x7f000000, s48
    s_add_u32 s51, s51, 0xa000
    s_cmp_eq_u32 s51, 0x1e000
    s_cselect_b32 s51, 0, s51
    s_add_u32 s64, s51, s49
    s_add_u32 s65, s51, s68
    s_add_u32 m0, s64, 0x0
    s_nop 0
    buffer_load_dwordx4 v14, s[24:27], s50 offen lds
    s_add_u32 m0, s64, 0x400
    s_nop 0
    buffer_load_dwordx4 v15, s[24:27], s50 offen lds
    s_add_u32 m0, s64, 0x800
    s_nop 0
    buffer_load_dwordx4 v16, s[24:27], s50 offen lds
    s_add_u32 m0, s64, 0xc00
    s_nop 0
    buffer_load_dwordx4 v17, s[24:27], s50 offen lds
    s_add_u32 m0, s65, 0x4000
    s_nop 0
    buffer_load_dwordx4 v8, s[28:31], s48 offen lds
    s_and_b32 s94, s46, 1
    s_lshl1_add_u32 s94, s45, s94
    s_lshl2_add_u32 s94, s94, s47
    s_mul_i32 s92, s94, 128
    s_min_u32 s92, s92, L_k1_end-L_h_tail-128
    s_getpc_b64 s[90:91]
L_pf6:
    s_add_u32 s92, s92, L_h_tail-L_pf6
    s_add_u32 s90, s90, s92
    s_addc_u32 s91, s91, 0
    s_load_dword s93, s[90:91], 0
    s_load_dword s93, s[90:91], 64
    s_mov_b32 s32, s20
    s_mov_b32 s33, s21
    s_mov_b32 s34, 0xc02000
    s_mov_b32 s35, 0x20000
    s_mov_b32 s40, s18
    s_mov_b32 s41, s19
    s_mov_b32 s42, 0x500
    s_mov_b32 s43, 0x20000
    v_lshrrev_b32 v3, 1, v1
    v_xor_b32 v3, v3, v2
    v_lshlrev_b32 v3, 4, v3
    v_lshl_add_u32 v3, v1, 7, v3
    s_lshl_b32 s57, s61, 13
    v_add_u32 v18, s57, v3
    v_xor_b32 v19, 64, v18
    v_bfe_u32 v3, v0, 2, 2
    v_lshl_add_u32 v4, v2, 3, v3
    v_mul_u32_u24 v4, 0x180, v4
    v_and_b32 v5, 3, v0
    v_lshl_add_u32 v4, v5, 3, v4
    v_lshrrev_b32 v3, 1, v3
    v_and_b32 v5, 1, v2
    v_lshl_or_b32 v3, v5, 1, v3
    s_mul_i32 s58, s58, 6
    s_add_u32 s59, s58, 0
    v_xor_b32 v5, s59, v3
    v_lshl_add_u32 v20, v5, 5, v4
    s_add_u32 s59, s58, 1
    v_xor_b32 v5, s59, v3
    v_lshl_add_u32 v21, v5, 5, v4
    s_add_u32 s59, s58, 2
    v_xor_b32 v5, s59, v3
    v_lshl_add_u32 v22, v5, 5, v4
    s_add_u32 s59, s58, 3
    v_xor_b32 v5, s59, v3
    v_lshl_add_u32 v23, v5, 5, v4
    v_lshlrev_b32 v195, 4, v1
    s_lshl_b32 s57, s46, 5
    s_lshl_b32 s58, s47, 3
    s_add_u32 s57, s57, s58
    s_add_u32 s57, s57, s56
    s_mul_i32 s57, s57, 0x500
    v_mul_u32_u24 v4, 0xa00, v2
    v_add3_u32 v194, v4, v195, s57
    s_lshl_b32 s66, s47, 6
    s_lshl_b32 s56, s45, 3
    s_add_u32 s66, s66, s56
    s_lshl_b32 s56, s44, 2
    s_add_u32 s66, s66, s56
    s_and_b32 s56, s46, 3
    s_add_u32 s66, s66, s56
    s_mul_i32 s56, s66, 0xcccd
    s_lshr_b32 s56, s56, 18
    s_mul_i32 s57, s56, 5
    s_sub_u32 s58, s66, s57
    s_lshr_b32 s59, s46, 2
    s_mul_i32 s57, s59, 3
    s_and_b32 s60, s58, 1
    s_add_u32 s57, s57, s60
    s_lshr_b32 s60, s58, 1
    s_cmp_eq_u32 s58, 4
    s_cselect_b32 s57, 2, s57
    s_cselect_b32 s60, s59, s60
    s_lshl_b32 s56, s56, 1
    s_add_u32 s56, s56, s60
    s_lshl_b32 s58, s56, 5
    s_sub_u32 s58, s58, 640
    s_mov_b32 s59, 16
    s_mov_b32 s60, 4
    s_mul_i32 s62, s56, 160
    s_sub_u32 s62, s62, 2544
    s_mov_b32 s38, 0x1e0000
    s_mov_b32 s39, 0x20000
    s_cmp_lt_u32 s56, 20
    s_cselect_b32 s58, s62, s58
    s_cselect_b32 s59, 80, s59
    s_cselect_b32 s60, 20, s60
    s_cselect_b32 s36, s8, s16
    s_cselect_b32 s37, s9, s17
    s_cselect_b32 s38, 0xc8000, s38
    s_mul_i32 s62, s56, 40
    s_cmp_lt_u32 s56, 16
    s_cselect_b32 s58, s62, s58
    s_cselect_b32 s59, 20, s59
    s_cselect_b32 s60, 4, s60
    s_mul_i32 s60, s60, 0x500
    v_mad_u32_u24 v196, v2, s60, v195
    s_mul_i32 s58, s58, 0x500
    s_lshl_b32 s62, s57, 8
    s_add_u32 s82, s58, s62
    s_mul_i32 s59, s59, 0x500
    s_add_u32 s83, s59, s82
    s_mul_i32 s56, s56, 40
    s_lshl_b32 s57, s57, 3
    s_add_u32 s56, s56, s57
    s_lshl_b32 s56, s56, 10
    s_add_u32 s56, s56, 0x900000
    s_cmp_ge_u32 s66, 170
    s_cselect_b32 s56, 0x7f000000, s56
    s_cselect_b32 s82, 0x7f000000, s82
    s_cselect_b32 s83, 0x7f000000, s83
    v_lshrrev_b32 v6, 1, v1
    v_lshlrev_b32 v6, 10, v6
    v_and_b32 v7, 1, v1
    v_lshl_add_u32 v6, v7, 7, v6
    v_lshl_add_u32 v6, v2, 8, v6
    s_lshl_b32 s57, s47, 13
    s_add_u32 s57, s57, 0xa000
    v_and_b32 v7, 7, v0
    v_lshl_add_u32 v6, v7, 4, v6
    v_add_u32 v232, s57, v6
    v_lshrrev_b32 v6, 3, v0
    v_and_b32 v233, 1, v6
    v_xor_b32 v7, v7, v233
    v_lshlrev_b32 v7, 4, v7
    v_lshl_add_u32 v7, v6, 7, v7
    v_add_u32 v233, s57, v7
    v_xor_b32 v234, 0x20, v233
    v_xor_b32 v235, 0x40, v233
    v_xor_b32 v236, 0x60, v233
    v_lshlrev_b32 v6, 4, v0
    v_add_u32 v193, s56, v6
    s_waitcnt vmcnt(15)
    s_add_u32 m0, s65, 0x4400
    s_nop 0
    buffer_load_dwordx4 v9, s[28:31], s48 offen lds
    v_lshlrev_b32 v24, 16, v200
    v_and_b32 v25, 0xffff0000, v200
    v_lshlrev_b32 v26, 16, v201
    v_and_b32 v27, 0xffff0000, v201
    v_lshlrev_b32 v28, 16, v202
    v_and_b32 v29, 0xffff0000, v202
    v_lshlrev_b32 v30, 16, v203
    v_and_b32 v31, 0xffff0000, v203
    v_lshlrev_b32 v32, 16, v204
    v_and_b32 v33, 0xffff0000, v204
    v_lshlrev_b32 v34, 16, v205
    v_and_b32 v35, 0xffff0000, v205
    v_lshlrev_b32 v36, 16, v206
    v_and_b32 v37, 0xffff0000, v206
    v_lshlrev_b32 v38, 16, v207
    v_and_b32 v39, 0xffff0000, v207
    v_lshlrev_b32 v40, 16, v208
    v_and_b32 v41, 0xffff0000, v208
    v_lshlrev_b32 v42, 16, v209
    v_and_b32 v43, 0xffff0000, v209
    s_add_u32 m0, s65, 0x4800
    s_nop 0
    buffer_load_dwordx4 v10, s[28:31], s48 offen lds
    v_lshlrev_b32 v44, 16, v210
    v_and_b32 v45, 0xffff0000, v210
    v_lshlrev_b32 v46, 16, v211
    v_and_b32 v47, 0xffff0000, v211
    v_lshlrev_b32 v48, 16, v200
    v_and_b32 v49, 0xffff0000, v200
    v_lshlrev_b32 v50, 16, v201
    v_and_b32 v51, 0xffff0000, v201
    v_lshlrev_b32 v52, 16, v202
    v_and_b32 v53, 0xffff0000, v202
    v_lshlrev_b32 v54, 16, v203
    v_and_b32 v55, 0xffff0000, v203
    v_lshlrev_b32 v56, 16, v204
    v_and_b32 v57, 0xffff0000, v204
    v_lshlrev_b32 v58, 16, v205
    v_and_b32 v59, 0xffff0000, v205
    v_lshlrev_b32 v60, 16, v206
    v_and_b32 v61, 0xffff0000, v206
    v_lshlrev_b32 v62, 16, v207
    v_and_b32 v63, 0xffff0000, v207
    s_add_u32 m0, s65, 0x4c00
    s_nop 0
    buffer_load_dwordx4 v11, s[28:31], s48 offen lds
    v_lshlrev_b32 v64, 16, v208
    v_and_b32 v65, 0xffff0000, v208
    v_lshlrev_b32 v66, 16, v209
    v_and_b32 v67, 0xffff0000, v209
    v_lshlrev_b32 v68, 16, v210
    v_and_b32 v69, 0xffff0000, v210
    v_lshlrev_b32 v70, 16, v211
    v_and_b32 v71, 0xffff0000, v211
    v_lshlrev_b32 v72, 16, v200
    v_and_b32 v73, 0xffff0000, v200
    v_lshlrev_b32 v74, 16, v201
    v_and_b32 v75, 0xffff0000, v201
    v_lshlrev_b32 v76, 16, v202
    v_and_b32 v77, 0xffff0000, v202
    v_lshlrev_b32 v78, 16, v203
    v_and_b32 v79, 0xffff0000, v203
    v_lshlrev_b32 v80, 16, v204
    v_and_b32 v81, 0xffff0000, v204
    v_lshlrev_b32 v82, 16, v205
    v_and_b32 v83, 0xffff0000, v205
    s_add_u32 m0, s65, 0x5000
    s_nop 0
    buffer_load_dwordx4 v12, s[28:31], s48 offen lds
    v_lshlrev_b32 v84, 16, v206
    v_and_b32 v85, 0xffff0000, v206
    v_lshlrev_b32 v86, 16, v207
    v_and_b32 v87, 0xffff0000, v207
    v_lshlrev_b32 v88, 16, v208
    v_and_b32 v89, 0xffff0000, v208
    v_lshlrev_b32 v90, 16, v209
    v_and_b32 v91, 0xffff0000, v209
    v_lshlrev_b32 v92, 16, v210
    v_and_b32 v93, 0xffff0000, v210
    v_lshlrev_b32 v94, 16, v211
    v_and_b32 v95, 0xffff0000, v211
    v_lshlrev_b32 v96, 16, v200
    v_and_b32 v97, 0xffff0000, v200
    v_lshlrev_b32 v98, 16, v201
    v_and_b32 v99, 0xffff0000, v201
    v_lshlrev_b32 v100, 16, v202
    v_and_b32 v101, 0xffff0000, v202
    v_lshlrev_b32 v102, 16, v203
    v_and_b32 v103, 0xffff0000, v203
    s_add_u32 m0, s65, 0x5400
    s_nop 0
    buffer_load_dwordx4 v13, s[28:31], s48 offen lds
    v_lshlrev_b32 v104, 16, v204
    v_and_b32 v105, 0xffff0000, v204
    v_lshlrev_b32 v106, 16, v205
    v_and_b32 v107, 0xffff0000, v205
    v_lshlrev_b32 v108, 16, v206
    v_and_b32 v109, 0xffff0000, v206
    v_lshlrev_b32 v110, 16, v207
    v_and_b32 v111, 0xffff0000, v207
    v_lshlrev_b32 v112, 16, v208
    v_and_b32 v113, 0xffff0000, v208
    v_lshlrev_b32 v114, 16, v209
    v_and_b32 v115, 0xffff0000, v209
    v_lshlrev_b32 v116, 16, v210
    v_and_b32 v117, 0xffff0000, v210
    v_lshlrev_b32 v118, 16, v211
    v_and_b32 v119, 0xffff0000, v211
    s_add_u32 s48, s48, 0x30000
    s_add_u32 s55, s55, 1
    s_add_u32 s50, s50, 0x80
    s_cmp_eq_u32 s50, 0x500
    s_cselect_b32 s50, 0, s50
    s_cselect_b32 s48, 0, s48
    s_cmp_ge_u32 s55, 10
    s_cselect_b32 s50, 0x7f000000, s50
    s_cselect_b32 s48, 0x7f000000, s48
    s_add_u32 s51, s51, 0xa000
    s_cmp_eq_u32 s51, 0x1e000
    s_cselect_b32 s51, 0, s51
    s_add_u32 s64, s51, s49
    s_add_u32 s65, s51, s68
    s_waitcnt vmcnt(10)
    s_barrier
    ds_read_b128 a[0:3], v18 offset:0
    ds_read_b128 a[4:7], v18 offset:2048
    ds_read_b128 a[8:11], v18 offset:4096
    ds_read_b128 a[12:15], v18 offset:6144
    ds_read_b64_tr_b16 a[16:17], v20 offset:16384
    ds_read_b64_tr_b16 a[18:19], v20 offset:17920
    ds_read_b64_tr_b16 a[20:21], v21 offset:16384
    ds_read_b64_tr_b16 a[22:23], v21 offset:17920
    ds_read_b64_tr_b16 a[24:25], v22 offset:16384
    ds_read_b64_tr_b16 a[26:27], v22 offset:17920
    ds_read_b64_tr_b16 a[28:29], v23 offset:16384
    ds_read_b64_tr_b16 a[30:31], v23 offset:17920
    ds_read_b64_tr_b16 a[32:33], v20 offset:16512
    ds_read_b64_tr_b16 a[34:35], v20 offset:18048
    ds_read_b64_tr_b16 a[36:37], v21 offset:16512
    ds_read_b64_tr_b16 a[38:39], v21 offset:18048
    s_add_u32 m0, s64, 0x0
    s_nop 0
    buffer_load_dwordx4 v14, s[24:27], s50 offen lds
    s_add_u32 m0, s64, 0x400
    s_nop 0
    buffer_load_dwordx4 v15, s[24:27], s50 offen lds
    s_add_u32 m0, s64, 0x800
    s_nop 0
    buffer_load_dwordx4 v16, s[24:27], s50 offen lds
    s_add_u32 m0, s64, 0xc00
    s_nop 0
    buffer_load_dwordx4 v17, s[24:27], s50 offen lds
    s_add_u32 m0, s65, 0x4000
    s_nop 0
    buffer_load_dwordx4 v8, s[28:31], s48 offen lds
    s_mov_b32 s54, 7
L_h_loop:
    s_waitcnt lgkmcnt(0)
    v_mfma_f32_16x16x32_bf16 v[24:27], a[16:19], a[0:3], v[24:27]
    ds_read_b128 a[40:43], v19 offset:0
    s_add_u32 m0, s65, 0x4400
    v_mfma_f32_16x16x32_bf16 v[28:31], a[20:23], a[0:3], v[28:31]
    buffer_load_dwordx4 v9, s[28:31], s48 offen lds
    ds_read_b128 a[44:47], v19 offset:2048
    v_mfma_f32_16x16x32_bf16 v[32:35], a[24:27], a[0:3], v[32:35]
    ds_read_b128 a[48:51], v19 offset:4096
    v_mfma_f32_16x16x32_bf16 v[36:39], a[28:31], a[0:3], v[36:39]
    ds_read_b128 a[52:55], v19 offset:6144
    v_mfma_f32_16x16x32_bf16 v[40:43], a[32:35], a[0:3], v[40:43]
    ds_read_b64_tr_b16 a[56:57], v20 offset:28672
    s_add_u32 m0, s65, 0x4800
    v_mfma_f32_16x16x32_bf16 v[44:47], a[36:39], a[0:3], v[44:47]
    buffer_load_dwordx4 v10, s[28:31], s48 offen lds
    ds_read_b64_tr_b16 a[58:59], v20 offset:30208
    v_mfma_f32_16x16x32_bf16 v[48:51], a[16:19], a[4:7], v[48:51]
    ds_read_b64_tr_b16 a[60:61], v21 offset:28672
    v_mfma_f32_16x16x32_bf16 v[52:55], a[20:23], a[4:7], v[52:55]
    ds_read_b64_tr_b16 a[62:63], v21 offset:30208
    v_mfma_f32_16x16x32_bf16 v[56:59], a[24:27], a[4:7], v[56:59]
    ds_read_b64_tr_b16 a[64:65], v22 offset:28672
    s_add_u32 m0, s65, 0x4c00
    v_mfma_f32_16x16x32_bf16 v[60:63], a[28:31], a[4:7], v[60:63]
    buffer_load_dwordx4 v11, s[28:31], s48 offen lds
    ds_read_b64_tr_b16 a[66:67], v22 offset:30208
    v_mfma_f32_16x16x32_bf16 v[64:67], a[32:35], a[4:7], v[64:67]
    ds_read_b64_tr_b16 a[68:69], v23 offset:28672
    v_mfma_f32_16x16x32_bf16 v[68:71], a[36:39], a[4:7], v[68:71]
    ds_read_b64_tr_b16 a[70:71], v23 offset:30208
    v_mfma_f32_16x16x32_bf16 v[72:75], a[16:19], a[8:11], v[72:75]
    ds_read_b64_tr_b16 a[72:73], v20 offset:28800
    s_add_u32 m0, s65, 0x5000
    v_mfma_f32_16x16x32_bf16 v[76:79], a[20:23], a[8:11], v[76:79]
    buffer_load_dwordx4 v12, s[28:31], s48 offen lds
    ds_read_b64_tr_b16 a[74:75], v20 offset:30336
    v_mfma_f32_16x16x32_bf16 v[80:83], a[24:27], a[8:11], v[80:83]
    ds_read_b64_tr_b16 a[76:77], v21 offset:28800
    v_mfma_f32_16x16x32_bf16 v[84:87], a[28:31], a[8:11], v[84:87]
    ds_read_b64_tr_b16 a[78:79], v21 offset:30336
    v_mfma_f32_16x16x32_bf16 v[88:91], a[32:35], a[8:11], v[88:91]
    s_add_u32 s70, s52, 0xa000
    s_cmp_eq_u32 s70, 0x1e000
    s_cselect_b32 s70, 0, s70
    s_sub_u32 s53, s70, s52
    s_mov_b32 s52, s70
    s_add_u32 m0, s65, 0x5400
    v_mfma_f32_16x16x32_bf16 v[92:95], a[36:39], a[8:11], v[92:95]
    buffer_load_dwordx4 v13, s[28:31], s48 offen lds
    v_add_u32 v18, s53, v18
    v_add_u32 v19, s53, v19
    v_mfma_f32_16x16x32_bf16 v[96:99], a[16:19], a[12:15], v[96:99]
    s_add_u32 s48, s48, 0x30000
    s_add_u32 s55, s55, 1
    s_add_u32 s50, s50, 0x80
    v_mfma_f32_16x16x32_bf16 v[100:103], a[20:23], a[12:15], v[100:103]
    s_cmp_eq_u32 s50, 0x500
    s_cselect_b32 s50, 0, s50
    s_cselect_b32 s48, 0, s48
    v_mfma_f32_16x16x32_bf16 v[104:107], a[24:27], a[12:15], v[104:107]
    s_cmp_ge_u32 s55, 10
    s_cselect_b32 s50, 0x7f000000, s50
    s_cselect_b32 s48, 0x7f000000, s48
    v_mfma_f32_16x16x32_bf16 v[108:111], a[28:31], a[12:15], v[108:111]
    s_add_u32 s51, s51, 0xa000
    s_cmp_eq_u32 s51, 0x1e000
    s_cselect_b32 s51, 0, s51
    v_mfma_f32_16x16x32_bf16 v[112:115], a[32:35], a[12:15], v[112:115]
    s_add_u32 s64, s51, s49
    s_add_u32 s65, s51, s68
    v_add_u32 v20, s53, v20
    v_add_u32 v21, s53, v21
    v_mfma_f32_16x16x32_bf16 v[116:119], a[36:39], a[12:15], v[116:119]
    v_add_u32 v22, s53, v22
    v_add_u32 v23, s53, v23
    s_waitcnt vmcnt(10) lgkmcnt(0)
    s_barrier
    v_mfma_f32_16x16x32_bf16 v[24:27], a[56:59], a[40:43], v[24:27]
    ds_read_b128 a[0:3], v18 offset:0
    s_add_u32 m0, s64, 0x0
    v_mfma_f32_16x16x32_bf16 v[28:31], a[60:63], a[40:43], v[28:31]
    buffer_load_dwordx4 v14, s[24:27], s50 offen lds
    ds_read_b128 a[4:7], v18 offset:2048
    v_mfma_f32_16x16x32_bf16 v[32:35], a[64:67], a[40:43], v[32:35]
    ds_read_b128 a[8:11], v18 offset:4096
    v_mfma_f32_16x16x32_bf16 v[36:39], a[68:71], a[40:43], v[36:39]
    ds_read_b128 a[12:15], v18 offset:6144
    v_mfma_f32_16x16x32_bf16 v[40:43], a[72:75], a[40:43], v[40:43]
    ds_read_b64_tr_b16 a[16:17], v20 offset:16384
    s_add_u32 m0, s64, 0x400
    v_mfma_f32_16x16x32_bf16 v[44:47], a[76:79], a[40:43], v[44:47]
    buffer_load_dwordx4 v15, s[24:27], s50 offen lds
    ds_read_b64_tr_b16 a[18:19], v20 offset:17920
    v_mfma_f32_16x16x32_bf16 v[48:51], a[56:59], a[44:47], v[48:51]
    ds_read_b64_tr_b16 a[20:21], v21 offset:16384
    v_mfma_f32_16x16x32_bf16 v[52:55], a[60:63], a[44:47], v[52:55]
    ds_read_b64_tr_b16 a[22:23], v21 offset:17920
    v_mfma_f32_16x16x32_bf16 v[56:59], a[64:67], a[44:47], v[56:59]
    ds_read_b64_tr_b16 a[24:25], v22 offset:16384
    s_add_u32 m0, s64, 0x800
    v_mfma_f32_16x16x32_bf16 v[60:63], a[68:71], a[44:47], v[60:63]
    buffer_load_dwordx4 v16, s[24:27], s50 offen lds
    ds_read_b64_tr_b16 a[26:27], v22 offset:17920
    v_mfma_f32_16x16x32_bf16 v[64:67], a[72:75], a[44:47], v[64:67]
    ds_read_b64_tr_b16 a[28:29], v23 offset:16384
    v_mfma_f32_16x16x32_bf16 v[68:71], a[76:79], a[44:47], v[68:71]
    ds_read_b64_tr_b16 a[30:31], v23 offset:17920
    v_mfma_f32_16x16x32_bf16 v[72:75], a[56:59], a[48:51], v[72:75]
    ds_read_b64_tr_b16 a[32:33], v20 offset:16512
    s_add_u32 m0, s64, 0xc00
    v_mfma_f32_16x16x32_bf16 v[76:79], a[60:63], a[48:51], v[76:79]
    buffer_load_dwordx4 v17, s[24:27], s50 offen lds
    ds_read_b64_tr_b16 a[34:35], v20 offset:18048
    v_mfma_f32_16x16x32_bf16 v[80:83], a[64:67], a[48:51], v[80:83]
    ds_read_b64_tr_b16 a[36:37], v21 offset:16512
    v_mfma_f32_16x16x32_bf16 v[84:87], a[68:71], a[48:51], v[84:87]
    ds_read_b64_tr_b16 a[38:39], v21 offset:18048
    v_mfma_f32_16x16x32_bf16 v[88:91], a[72:75], a[48:51], v[88:91]
    s_add_u32 m0, s65, 0x4000
    v_mfma_f32_16x16x32_bf16 v[92:95], a[76:79], a[48:51], v[92:95]
    buffer_load_dwordx4 v8, s[28:31], s48 offen lds
    v_mfma_f32_16x16x32_bf16 v[96:99], a[56:59], a[52:55], v[96:99]
    v_mfma_f32_16x16x32_bf16 v[100:103], a[60:63], a[52:55], v[100:103]
    v_mfma_f32_16x16x32_bf16 v[104:107], a[64:67], a[52:55], v[104:107]
    s_sub_u32 s54, s54, 1
    v_mfma_f32_16x16x32_bf16 v[108:111], a[68:71], a[52:55], v[108:111]
    s_cmp_lg_u32 s54, 0
    v_mfma_f32_16x16x32_bf16 v[112:115], a[72:75], a[52:55], v[112:115]
    v_mfma_f32_16x16x32_bf16 v[116:119], a[76:79], a[52:55], v[116:119]
    s_cbranch_scc1 L_h_loop
L_h_tail:
    s_waitcnt lgkmcnt(0)
    v_mfma_f32_16x16x32_bf16 v[24:27], a[16:19], a[0:3], v[24:27]
    ds_read_b128 a[40:43], v19 offset:0
    s_add_u32 m0, s65, 0x4400
    v_mfma_f32_16x16x32_bf16 v[28:31], a[20:23], a[0:3], v[28:31]
    buffer_load_dwordx4 v9, s[28:31], s48 offen lds
    ds_read_b128 a[44:47], v19 offset:2048
    v_mfma_f32_16x16x32_bf16 v[32:35], a[24:27], a[0:3], v[32:35]
    ds_read_b128 a[48:51], v19 offset:4096
    buffer_load_dwordx4 v[152:155], v194, s[24:27], 0 offen offset:0
    v_mfma_f32_16x16x32_bf16 v[36:39], a[28:31], a[0:3], v[36:39]
    ds_read_b128 a[52:55], v19 offset:6144
    buffer_load_dwordx4 v[156:159], v194, s[24:27], 0 offen offset:256
    v_mfma_f32_16x16x32_bf16 v[40:43], a[32:35], a[0:3], v[40:43]
    ds_read_b64_tr_b16 a[56:57], v20 offset:28672
    buffer_load_dwordx4 v[160:163], v194, s[24:27], 0 offen offset:512
    s_add_u32 m0, s65, 0x4800
    v_mfma_f32_16x16x32_bf16 v[44:47], a[36:39], a[0:3], v[44:47]
    buffer_load_dwordx4 v10, s[28:31], s48 offen lds
    ds_read_b64_tr_b16 a[58:59], v20 offset:30208
    v_mfma_f32_16x16x32_bf16 v[48:51], a[16:19], a[4:7], v[48:51]
    ds_read_b64_tr_b16 a[60:61], v21 offset:28672
    buffer_load_dwordx4 v[164:167], v194, s[24:27], 0 offen offset:768
    v_mfma_f32_16x16x32_bf16 v[52:55], a[20:23], a[4:7], v[52:55]
    ds_read_b64_tr_b16 a[62:63], v21 offset:30208
    buffer_load_dwordx4 v[168:171], v194, s[24:27], 0 offen offset:1024
    v_mfma_f32_16x16x32_bf16 v[56:59], a[24:27], a[4:7], v[56:59]
    ds_read_b64_tr_b16 a[64:65], v22 offset:28672
    s_add_u32 m0, s65, 0x4c00
    v_mfma_f32_16x16x32_bf16 v[60:63], a[28:31], a[4:7], v[60:63]
    buffer_load_dwordx4 v11, s[28:31], s48 offen lds
    ds_read_b64_tr_b16 a[66:67], v22 offset:30208
    v_mfma_f32_16x16x32_bf16 v[64:67], a[32:35], a[4:7], v[64:67]
    ds_read_b64_tr_b16 a[68:69], v23 offset:28672
    v_mfma_f32_16x16x32_bf16 v[68:71], a[36:39], a[4:7], v[68:71]
    ds_read_b64_tr_b16 a[70:71], v23 offset:30208
    v_mfma_f32_16x16x32_bf16 v[72:75], a[16:19], a[8:11], v[72:75]
    ds_read_b64_tr_b16 a[72:73], v20 offset:28800
    s_add_u32 m0, s65, 0x5000
    v_mfma_f32_16x16x32_bf16 v[76:79], a[20:23], a[8:11], v[76:79]
    buffer_load_dwordx4 v12, s[28:31], s48 offen lds
    ds_read_b64_tr_b16 a[74:75], v20 offset:30336
    v_mfma_f32_16x16x32_bf16 v[80:83], a[24:27], a[8:11], v[80:83]
    ds_read_b64_tr_b16 a[76:77], v21 offset:28800
    v_mfma_f32_16x16x32_bf16 v[84:87], a[28:31], a[8:11], v[84:87]
    ds_read_b64_tr_b16 a[78:79], v21 offset:30336
    v_mfma_f32_16x16x32_bf16 v[88:91], a[32:35], a[8:11], v[88:91]
    s_add_u32 s70, s52, 0xa000
    s_cmp_eq_u32 s70, 0x1e000
    s_cselect_b32 s70, 0, s70
    s_sub_u32 s53, s70, s52
    s_mov_b32 s52, s70
    s_add_u32 m0, s65, 0x5400
    v_mfma_f32_16x16x32_bf16 v[92:95], a[36:39], a[8:11], v[92:95]
    buffer_load_dwordx4 v13, s[28:31], s48 offen lds
    v_add_u32 v18, s53, v18
    v_add_u32 v19, s53, v19
    v_mfma_f32_16x16x32_bf16 v[96:99], a[16:19], a[12:15], v[96:99]
    buffer_load_dwordx4 v[120:123], v196, s[36:39], s82 offen offset:0
    v_mfma_f32_16x16x32_bf16 v[100:103], a[20:23], a[12:15], v[100:103]
    buffer_load_dwordx4 v[124:127], v196, s[36:39], s82 offen offset:1280
    v_mfma_f32_16x16x32_bf16 v[104:107], a[24:27], a[12:15], v[104:107]
    buffer_load_dwordx4 v[128:131], v196, s[36:39], s82 offen offset:2560
    v_mfma_f32_16x16x32_bf16 v[108:111], a[28:31], a[12:15], v[108:111]
    buffer_load_dwordx4 v[132:135], v196, s[36:39], s82 offen offset:3840
    v_mfma_f32_16x16x32_bf16 v[112:115], a[32:35], a[12:15], v[112:115]
    v_add_u32 v20, s53, v20
    v_add_u32 v21, s53, v21
    buffer_load_dwordx4 v[136:139], v196, s[36:39], s83 offen offset:0
    v_mfma_f32_16x16x32_bf16 v[116:119], a[36:39], a[12:15], v[116:119]
    v_add_u32 v22, s53, v22
    v_add_u32 v23, s53, v23
    buffer_load_dwordx4 v[140:143], v196, s[36:39], s83 offen offset:1280
    s_waitcnt vmcnt(21) lgkmcnt(0)
    s_barrier
    v_mfma_f32_16x16x32_bf16 v[24:27], a[56:59], a[40:43], v[24:27]
    ds_read_b128 a[0:3], v18 offset:0
    buffer_load_dwordx4 v[144:147], v196, s[36:39], s83 offen offset:2560
    v_mfma_f32_16x16x32_bf16 v[28:31], a[60:63], a[40:43], v[28:31]
    ds_read_b128 a[4:7], v18 offset:2048
    buffer_load_dwordx4 v[148:151], v196, s[36:39], s83 offen offset:3840
    v_mfma_f32_16x16x32_bf16 v[32:35], a[64:67], a[40:43], v[32:35]
    ds_read_b128 a[8:11], v18 offset:4096
    v_mfma_f32_16x16x32_bf16 v[36:39], a[68:71], a[40:43], v[36:39]
    ds_read_b128 a[12:15], v18 offset:6144
    v_mfma_f32_16x16x32_bf16 v[40:43], a[72:75], a[40:43], v[40:43]
    ds_read_b64_tr_b16 a[16:17], v20 offset:16384
    v_mfma_f32_16x16x32_bf16 v[44:47], a[76:79], a[40:43], v[44:47]
    ds_read_b64_tr_b16 a[18:19], v20 offset:17920
    v_mfma_f32_16x16x32_bf16 v[48:51], a[56:59], a[44:47], v[48:51]
    ds_read_b64_tr_b16 a[20:21], v21 offset:16384
    v_mfma_f32_16x16x32_bf16 v[52:55], a[60:63], a[44:47], v[52:55]
    ds_read_b64_tr_b16 a[22:23], v21 offset:17920
    v_mfma_f32_16x16x32_bf16 v[56:59], a[64:67], a[44:47], v[56:59]
    ds_read_b64_tr_b16 a[24:25], v22 offset:16384
    v_mfma_f32_16x16x32_bf16 v[60:63], a[68:71], a[44:47], v[60:63]
    ds_read_b64_tr_b16 a[26:27], v22 offset:17920
    v_mfma_f32_16x16x32_bf16 v[64:67], a[72:75], a[44:47], v[64:67]
    ds_read_b64_tr_b16 a[28:29], v23 offset:16384
    v_mfma_f32_16x16x32_bf16 v[68:71], a[76:79], a[44:47], v[68:71]
    ds_read_b64_tr_b16 a[30:31], v23 offset:17920
    v_mfma_f32_16x16x32_bf16 v[72:75], a[56:59], a[48:51], v[72:75]
    ds_read_b64_tr_b16 a[32:33], v20 offset:16512
    s_lshl_b32 s56, s44, 6
    s_lshl_b32 s57, s45, 3
    v_mfma_f32_16x16x32_bf16 v[76:79], a[60:63], a[48:51], v[76:79]
    ds_read_b64_tr_b16 a[34:35], v20 offset:18048
    s_add_u32 s56, s56, s57
    s_add_u32 s59, s56, s46
    v_mfma_f32_16x16x32_bf16 v[80:83], a[64:67], a[48:51], v[80:83]
    ds_read_b64_tr_b16 a[36:37], v21 offset:16512
    s_lshl_b32 s59, s59, 2
    s_add_u32 s59, s59, s47
    v_mfma_f32_16x16x32_bf16 v[84:87], a[68:71], a[48:51], v[84:87]
    ds_read_b64_tr_b16 a[38:39], v21 offset:18048
    s_lshl_b32 s59, s59, 4
    s_add_u32 s59, s59, 0xc00000
    v_mfma_f32_16x16x32_bf16 v[88:91], a[72:75], a[48:51], v[88:91]
    s_lshl_b32 s57, s61, 2
    s_add_u32 s56, s56, s57
    v_mfma_f32_16x16x32_bf16 v[92:95], a[76:79], a[48:51], v[92:95]
    s_mul_i32 s56, s56, 68
    s_mul_i32 s57, s46, 6
    v_mfma_f32_16x16x32_bf16 v[96:99], a[56:59], a[52:55], v[96:99]
    s_add_u32 s56, s56, s57
    s_and_b32 s57, s47, 1
    v_mfma_f32_16x16x32_bf16 v[100:103], a[60:63], a[52:55], v[100:103]
    s_mul_i32 s57, s57, 3
    s_add_u32 s56, s56, s57
    v_mfma_f32_16x16x32_bf16 v[104:107], a[64:67], a[52:55], v[104:107]
    s_add_u32 s56, s56, 20
    s_lshl_b32 s56, s56, 10
    v_mfma_f32_16x16x32_bf16 v[108:111], a[68:71], a[52:55], v[108:111]
    v_lshlrev_b32 v1, 4, v0
    v_mfma_f32_16x16x32_bf16 v[112:115], a[72:75], a[52:55], v[112:115]
    v_mfma_f32_16x16x32_bf16 v[116:119], a[76:79], a[52:55], v[116:119]
    s_waitcnt lgkmcnt(0)
    v_mfma_f32_16x16x32_bf16 v[24:27], a[16:19], a[0:3], v[24:27]
    ds_read_b128 a[40:43], v19 offset:0
    v_mfma_f32_16x16x32_bf16 v[28:31], a[20:23], a[0:3], v[28:31]
    ds_read_b128 a[44:47], v19 offset:2048
    s_waitcnt vmcnt(11)
    v_mfma_f32_16x16x32_bf16 v[32:35], a[24:27], a[0:3], v[32:35]
    ds_read_b128 a[48:51], v19 offset:4096
    v_dot2_f32_bf16 v192, v152, v172, 0
    v_mfma_f32_16x16x32_bf16 v[36:39], a[28:31], a[0:3], v[36:39]
    ds_read_b128 a[52:55], v19 offset:6144
    v_dot2_f32_bf16 v237, v153, v173, 0
    v_mfma_f32_16x16x32_bf16 v[40:43], a[32:35], a[0:3], v[40:43]
    ds_read_b64_tr_b16 a[56:57], v20 offset:28672
    v_dot2_f32_bf16 v192, v154, v174, v192
    v_mfma_f32_16x16x32_bf16 v[44:47], a[36:39], a[0:3], v[44:47]
    ds_read_b64_tr_b16 a[58:59], v20 offset:30208
    v_dot2_f32_bf16 v237, v155, v175, v237
    v_mfma_f32_16x16x32_bf16 v[48:51], a[16:19], a[4:7], v[48:51]
    ds_read_b64_tr_b16 a[60:61], v21 offset:28672
    v_dot2_f32_bf16 v192, v156, v176, v192
    v_mfma_f32_16x16x32_bf16 v[52:55], a[20:23], a[4:7], v[52:55]
    ds_read_b64_tr_b16 a[62:63], v21 offset:30208
    v_dot2_f32_bf16 v237, v157, v177, v237
    v_mfma_f32_16x16x32_bf16 v[56:59], a[24:27], a[4:7], v[56:59]
    ds_read_b64_tr_b16 a[64:65], v22 offset:28672
    v_dot2_f32_bf16 v192, v158, v178, v192
    v_mfma_f32_16x16x32_bf16 v[60:63], a[28:31], a[4:7], v[60:63]
    ds_read_b64_tr_b16 a[66:67], v22 offset:30208
    v_dot2_f32_bf16 v237, v159, v179, v237
    v_mfma_f32_16x16x32_bf16 v[64:67], a[32:35], a[4:7], v[64:67]
    ds_read_b64_tr_b16 a[68:69], v23 offset:28672
    v_dot2_f32_bf16 v192, v160, v180, v192
    v_mfma_f32_16x16x32_bf16 v[68:71], a[36:39], a[4:7], v[68:71]
    ds_read_b64_tr_b16 a[70:71], v23 offset:30208
    v_dot2_f32_bf16 v237, v161, v181, v237
    v_mfma_f32_16x16x32_bf16 v[72:75], a[16:19], a[8:11], v[72:75]
    ds_read_b64_tr_b16 a[72:73], v20 offset:28800
    v_dot2_f32_bf16 v192, v162, v182, v192
    v_mfma_f32_16x16x32_bf16 v[76:79], a[20:23], a[8:11], v[76:79]
    ds_read_b64_tr_b16 a[74:75], v20 offset:30336
    v_dot2_f32_bf16 v237, v163, v183, v237
    v_mfma_f32_16x16x32_bf16 v[80:83], a[24:27], a[8:11], v[80:83]
    ds_read_b64_tr_b16 a[76:77], v21 offset:28800
    v_dot2_f32_bf16 v192, v164, v184, v192
    v_mfma_f32_16x16x32_bf16 v[84:87], a[28:31], a[8:11], v[84:87]
    ds_read_b64_tr_b16 a[78:79], v21 offset:30336
    v_dot2_f32_bf16 v237, v165, v185, v237
    v_mfma_f32_16x16x32_bf16 v[88:91], a[32:35], a[8:11], v[88:91]
    s_add_u32 s70, s52, 0xa000
    s_cmp_eq_u32 s70, 0x1e000
    s_cselect_b32 s70, 0, s70
    s_sub_u32 s53, s70, s52
    s_mov_b32 s52, s70
    v_dot2_f32_bf16 v192, v166, v186, v192
    v_mfma_f32_16x16x32_bf16 v[92:95], a[36:39], a[8:11], v[92:95]
    v_add_u32 v18, s53, v18
    v_add_u32 v19, s53, v19
    v_dot2_f32_bf16 v237, v167, v187, v237
    v_mfma_f32_16x16x32_bf16 v[96:99], a[16:19], a[12:15], v[96:99]
    v_dot2_f32_bf16 v192, v168, v188, v192
    v_mfma_f32_16x16x32_bf16 v[100:103], a[20:23], a[12:15], v[100:103]
    v_dot2_f32_bf16 v237, v169, v189, v237
    v_mfma_f32_16x16x32_bf16 v[104:107], a[24:27], a[12:15], v[104:107]
    v_dot2_f32_bf16 v192, v170, v190, v192
    v_mfma_f32_16x16x32_bf16 v[108:111], a[28:31], a[12:15], v[108:111]
    v_dot2_f32_bf16 v237, v171, v191, v237
    v_mfma_f32_16x16x32_bf16 v[112:115], a[32:35], a[12:15], v[112:115]
    v_add_u32 v20, s53, v20
    v_add_u32 v21, s53, v21
    v_mfma_f32_16x16x32_bf16 v[116:119], a[36:39], a[12:15], v[116:119]
    v_add_u32 v22, s53, v22
    v_add_u32 v23, s53, v23
    s_waitcnt vmcnt(8) lgkmcnt(0)
    s_barrier
    v_mfma_f32_16x16x32_bf16 v[24:27], a[56:59], a[40:43], v[24:27]
    ds_read_b128 a[0:3], v18 offset:0
    v_mfma_f32_16x16x32_bf16 v[28:31], a[60:63], a[40:43], v[28:31]
    ds_read_b128 a[4:7], v18 offset:2048
    v_add_f32 v192, v192, v237
    v_mfma_f32_16x16x32_bf16 v[32:35], a[64:67], a[40:43], v[32:35]
    ds_read_b128 a[8:11], v18 offset:4096
    v_add_f32_dpp v4, v192, v192 row_ror:8 row_mask:0xf bank_mask:0xf
    v_mfma_f32_16x16x32_bf16 v[36:39], a[68:71], a[40:43], v[36:39]
    ds_read_b128 a[12:15], v18 offset:6144
    v_mov_b32 v192, v4
    v_mfma_f32_16x16x32_bf16 v[40:43], a[72:75], a[40:43], v[40:43]
    ds_read_b64_tr_b16 a[16:17], v20 offset:16384
    v_add_f32_dpp v4, v192, v192 row_ror:4 row_mask:0xf bank_mask:0xf
    v_mfma_f32_16x16x32_bf16 v[44:47], a[76:79], a[40:43], v[44:47]
    ds_read_b64_tr_b16 a[18:19], v20 offset:17920
    v_mov_b32 v192, v4
    v_mfma_f32_16x16x32_bf16 v[48:51], a[56:59], a[44:47], v[48:51]
    ds_read_b64_tr_b16 a[20:21], v21 offset:16384
    v_add_f32_dpp v4, v192, v192 row_ror:2 row_mask:0xf bank_mask:0xf
    v_mfma_f32_16x16x32_bf16 v[52:55], a[60:63], a[44:47], v[52:55]
    ds_read_b64_tr_b16 a[22:23], v21 offset:17920
    v_mov_b32 v192, v4
    v_mfma_f32_16x16x32_bf16 v[56:59], a[64:67], a[44:47], v[56:59]
    ds_read_b64_tr_b16 a[24:25], v22 offset:16384
    v_add_f32_dpp v4, v192, v192 row_ror:1 row_mask:0xf bank_mask:0xf
    v_mfma_f32_16x16x32_bf16 v[60:63], a[68:71], a[44:47], v[60:63]
    ds_read_b64_tr_b16 a[26:27], v22 offset:17920
    v_mov_b32 v192, v4
    v_mfma_f32_16x16x32_bf16 v[64:67], a[72:75], a[44:47], v[64:67]
    ds_read_b64_tr_b16 a[28:29], v23 offset:16384
    v_cvt_pk_bf16_f32 v192, v192, v192
    v_mfma_f32_16x16x32_bf16 v[68:71], a[76:79], a[44:47], v[68:71]
    ds_read_b64_tr_b16 a[30:31], v23 offset:17920
    v_lshlrev_b32 v192, 16, v192
    v_mfma_f32_16x16x32_bf16 v[72:75], a[56:59], a[48:51], v[72:75]
    ds_read_b64_tr_b16 a[32:33], v20 offset:16512
    v_mul_f32 v192, 0xbfb8aa3b, v192
    v_mfma_f32_16x16x32_bf16 v[76:79], a[60:63], a[48:51], v[76:79]
    ds_read_b64_tr_b16 a[34:35], v20 offset:18048
    v_exp_f32 v192, v192
    v_mfma_f32_16x16x32_bf16 v[80:83], a[64:67], a[48:51], v[80:83]
    ds_read_b64_tr_b16 a[36:37], v21 offset:16512
    v_lshrrev_b32 v4, 4, v0
    v_mfma_f32_16x16x32_bf16 v[84:87], a[68:71], a[48:51], v[84:87]
    ds_read_b64_tr_b16 a[38:39], v21 offset:18048
    v_add_f32 v192, 1.0, v192
    v_mfma_f32_16x16x32_bf16 v[88:91], a[72:75], a[48:51], v[88:91]
    v_rcp_f32 v192, v192
    v_mfma_f32_16x16x32_bf16 v[92:95], a[76:79], a[48:51], v[92:95]
    v_lshlrev_b32 v4, 2, v4
    v_mfma_f32_16x16x32_bf16 v[96:99], a[56:59], a[52:55], v[96:99]
    v_cvt_pk_bf16_f32 v192, v192, v192
    v_mfma_f32_16x16x32_bf16 v[100:103], a[60:63], a[52:55], v[100:103]
    v_lshlrev_b32 v192, 16, v192
    v_mfma_f32_16x16x32_bf16 v[104:107], a[64:67], a[52:55], v[104:107]
    buffer_store_dword v192, v4, s[32:35], s59 offen
    v_mfma_f32_16x16x32_bf16 v[108:111], a[68:71], a[52:55], v[108:111]
    v_mfma_f32_16x16x32_bf16 v[112:115], a[72:75], a[52:55], v[112:115]
    v_mfma_f32_16x16x32_bf16 v[116:119], a[76:79], a[52:55], v[116:119]
    s_waitcnt lgkmcnt(0)
    v_mfma_f32_16x16x32_bf16 v[24:27], a[16:19], a[0:3], v[24:27]
    ds_read_b128 a[40:43], v19 offset:0
    v_mfma_f32_16x16x32_bf16 v[28:31], a[20:23], a[0:3], v[28:31]
    ds_read_b128 a[44:47], v19 offset:2048
    s_waitcnt vmcnt(1)
    v_mfma_f32_16x16x32_bf16 v[32:35], a[24:27], a[0:3], v[32:35]
    ds_read_b128 a[48:51], v19 offset:4096
    s_mov_b32 s82, 0x05040100
    s_mov_b32 s83, 0x07060302
    v_perm_b32 v152, v124, v120, s82
    v_mfma_f32_16x16x32_bf16 v[36:39], a[28:31], a[0:3], v[36:39]
    ds_read_b128 a[52:55], v19 offset:6144
    v_perm_b32 v153, v132, v128, s82
    v_perm_b32 v154, v140, v136, s82
    v_mfma_f32_16x16x32_bf16 v[40:43], a[32:35], a[0:3], v[40:43]
    ds_read_b64_tr_b16 a[56:57], v20 offset:28672
    v_perm_b32 v155, v148, v144, s82
    ds_write_b128 v232, v[152:155]
    v_mfma_f32_16x16x32_bf16 v[44:47], a[36:39], a[0:3], v[44:47]
    ds_read_b64_tr_b16 a[58:59], v20 offset:30208
    v_perm_b32 v156, v124, v120, s83
    v_perm_b32 v157, v132, v128, s83
    v_mfma_f32_16x16x32_bf16 v[48:51], a[16:19], a[4:7], v[48:51]
    ds_read_b64_tr_b16 a[60:61], v21 offset:28672
    v_perm_b32 v158, v140, v136, s83
    v_perm_b32 v159, v148, v144, s83
    v_xor_b32 v238, 0x10, v232
    v_mfma_f32_16x16x32_bf16 v[52:55], a[20:23], a[4:7], v[52:55]
    ds_read_b64_tr_b16 a[62:63], v21 offset:30208
    ds_write_b128 v238, v[156:159]
    v_perm_b32 v160, v125, v121, s82
    v_mfma_f32_16x16x32_bf16 v[56:59], a[24:27], a[4:7], v[56:59]
    ds_read_b64_tr_b16 a[64:65], v22 offset:28672
    v_perm_b32 v161, v133, v129, s82
    v_perm_b32 v162, v141, v137, s82
    v_mfma_f32_16x16x32_bf16 v[60:63], a[28:31], a[4:7], v[60:63]
    ds_read_b64_tr_b16 a[66:67], v22 offset:30208
    v_perm_b32 v163, v149, v145, s82
    v_xor_b32 v237, 0x20, v232
    v_mfma_f32_16x16x32_bf16 v[64:67], a[32:35], a[4:7], v[64:67]
    ds_read_b64_tr_b16 a[68:69], v23 offset:28672
    ds_write_b128 v237, v[160:163]
    v_perm_b32 v164, v125, v121, s83
    v_perm_b32 v165, v133, v129, s83
    v_mfma_f32_16x16x32_bf16 v[68:71], a[36:39], a[4:7], v[68:71]
    ds_read_b64_tr_b16 a[70:71], v23 offset:30208
    v_perm_b32 v166, v141, v137, s83
    v_perm_b32 v167, v149, v145, s83
    v_mfma_f32_16x16x32_bf16 v[72:75], a[16:19], a[8:11], v[72:75]
    ds_read_b64_tr_b16 a[72:73], v20 offset:28800
    v_xor_b32 v238, 0x30, v232
    ds_write_b128 v238, v[164:167]
    v_mfma_f32_16x16x32_bf16 v[76:79], a[20:23], a[8:11], v[76:79]
    ds_read_b64_tr_b16 a[74:75], v20 offset:30336
    v_perm_b32 v168, v126, v122, s82
    v_perm_b32 v169, v134, v130, s82
    v_mfma_f32_16x16x32_bf16 v[80:83], a[24:27], a[8:11], v[80:83]
    ds_read_b64_tr_b16 a[76:77], v21 offset:28800
    v_perm_b32 v170, v142, v138, s82
    v_perm_b32 v171, v150, v146, s82
    v_mfma_f32_16x16x32_bf16 v[84:87], a[28:31], a[8:11], v[84:87]
    ds_read_b64_tr_b16 a[78:79], v21 offset:30336
    v_xor_b32 v237, 0x40, v232
    ds_write_b128 v237, v[168:171]
    v_perm_b32 v172, v126, v122, s83
    v_mfma_f32_16x16x32_bf16 v[88:91], a[32:35], a[8:11], v[88:91]
    v_perm_b32 v173, v134, v130, s83
    v_perm_b32 v174, v142, v138, s83
    v_mfma_f32_16x16x32_bf16 v[92:95], a[36:39], a[8:11], v[92:95]
    v_perm_b32 v175, v150, v146, s83
    v_xor_b32 v238, 0x50, v232
    v_mfma_f32_16x16x32_bf16 v[96:99], a[16:19], a[12:15], v[96:99]
    ds_write_b128 v238, v[172:175]
    v_perm_b32 v176, v127, v123, s82
    v_mfma_f32_16x16x32_bf16 v[100:103], a[20:23], a[12:15], v[100:103]
    v_perm_b32 v177, v135, v131, s82
    v_perm_b32 v178, v143, v139, s82
    v_perm_b32 v179, v151, v147, s82
    v_mfma_f32_16x16x32_bf16 v[104:107], a[24:27], a[12:15], v[104:107]
    v_xor_b32 v237, 0x60, v232
    ds_write_b128 v237, v[176:179]
    v_mfma_f32_16x16x32_bf16 v[108:111], a[28:31], a[12:15], v[108:111]
    v_perm_b32 v180, v127, v123, s83
    v_perm_b32 v181, v135, v131, s83
    v_mfma_f32_16x16x32_bf16 v[112:115], a[32:35], a[12:15], v[112:115]
    v_perm_b32 v182, v143, v139, s83
    v_perm_b32 v183, v151, v147, s83
    v_mfma_f32_16x16x32_bf16 v[116:119], a[36:39], a[12:15], v[116:119]
    v_xor_b32 v238, 0x70, v232
    ds_write_b128 v238, v[180:183]
    s_waitcnt lgkmcnt(0)
    v_mfma_f32_16x16x32_bf16 v[24:27], a[56:59], a[40:43], v[24:27]
    ds_read_b128 v[120:123], v233 offset:0
    v_mfma_f32_16x16x32_bf16 v[28:31], a[60:63], a[40:43], v[28:31]
    ds_read_b128 v[124:127], v234 offset:1024
    v_mfma_f32_16x16x32_bf16 v[32:35], a[64:67], a[40:43], v[32:35]
    ds_read_b128 v[128:131], v235 offset:2048
    v_mfma_f32_16x16x32_bf16 v[36:39], a[68:71], a[40:43], v[36:39]
    ds_read_b128 v[132:135], v236 offset:3072
    v_mfma_f32_16x16x32_bf16 v[40:43], a[72:75], a[40:43], v[40:43]
    ds_read_b128 v[136:139], v233 offset:4096
    v_mfma_f32_16x16x32_bf16 v[44:47], a[76:79], a[40:43], v[44:47]
    ds_read_b128 v[140:143], v234 offset:5120
    v_mfma_f32_16x16x32_bf16 v[48:51], a[56:59], a[44:47], v[48:51]
    ds_read_b128 v[144:147], v235 offset:6144
    v_mfma_f32_16x16x32_bf16 v[52:55], a[60:63], a[44:47], v[52:55]
    ds_read_b128 v[148:151], v236 offset:7168
    v_mfma_f32_16x16x32_bf16 v[56:59], a[64:67], a[44:47], v[56:59]
    s_movk_i32 s60, 0x1000
    v_mfma_f32_16x16x32_bf16 v[60:63], a[68:71], a[44:47], v[60:63]
    v_mfma_f32_16x16x32_bf16 v[64:67], a[72:75], a[44:47], v[64:67]
    s_waitcnt lgkmcnt(7)
    buffer_store_dwordx4 v[120:123], v193, s[32:35], 0 offen offset:0 sc1
    v_mfma_f32_16x16x32_bf16 v[68:71], a[76:79], a[44:47], v[68:71]
    s_waitcnt lgkmcnt(6)
    buffer_store_dwordx4 v[124:127], v193, s[32:35], 0 offen offset:1024 sc1
    v_mfma_f32_16x16x32_bf16 v[72:75], a[56:59], a[48:51], v[72:75]
    s_waitcnt lgkmcnt(5)
    buffer_store_dwordx4 v[128:131], v193, s[32:35], 0 offen offset:2048 sc1
    v_mfma_f32_16x16x32_bf16 v[76:79], a[60:63], a[48:51], v[76:79]
    s_waitcnt lgkmcnt(4)
    buffer_store_dwordx4 v[132:135], v193, s[32:35], 0 offen offset:3072 sc1
    v_mfma_f32_16x16x32_bf16 v[80:83], a[64:67], a[48:51], v[80:83]
    s_waitcnt lgkmcnt(3)
    buffer_store_dwordx4 v[136:139], v193, s[32:35], s60 offen offset:0 sc1
    v_mfma_f32_16x16x32_bf16 v[84:87], a[68:71], a[48:51], v[84:87]
    s_waitcnt lgkmcnt(2)
    buffer_store_dwordx4 v[140:143], v193, s[32:35], s60 offen offset:1024 sc1
    v_mfma_f32_16x16x32_bf16 v[88:91], a[72:75], a[48:51], v[88:91]
    s_waitcnt lgkmcnt(1)
    buffer_store_dwordx4 v[144:147], v193, s[32:35], s60 offen offset:2048 sc1
    v_mfma_f32_16x16x32_bf16 v[92:95], a[76:79], a[48:51], v[92:95]
    s_waitcnt lgkmcnt(0)
    buffer_store_dwordx4 v[148:151], v193, s[32:35], s60 offen offset:3072 sc1
    v_mfma_f32_16x16x32_bf16 v[96:99], a[56:59], a[52:55], v[96:99]
    v_mfma_f32_16x16x32_bf16 v[100:103], a[60:63], a[52:55], v[100:103]
    v_mfma_f32_16x16x32_bf16 v[104:107], a[64:67], a[52:55], v[104:107]
    v_mfma_f32_16x16x32_bf16 v[108:111], a[68:71], a[52:55], v[108:111]
    v_mfma_f32_16x16x32_bf16 v[112:115], a[72:75], a[52:55], v[112:115]
    v_mfma_f32_16x16x32_bf16 v[116:119], a[76:79], a[52:55], v[116:119]
    s_mov_b32 s62, 0xc0135761
    s_mov_b32 s63, 0xc0135761
    v_mov_b32 v2, 0xbdd2d3e8
    v_mov_b32 v3, 0xbdd2d3e8
    s_mul_i32 s92, s94, 128
    s_min_u32 s92, s92, L_k2_end-k2_kernel-128
    s_getpc_b64 s[90:91]
L_pf7:
    s_add_u32 s92, s92, k2_kernel-L_pf7
    s_add_u32 s90, s90, s92
    s_addc_u32 s91, s91, 0
    s_load_dword s93, s[90:91], 0
    s_load_dword s93, s[90:91], 64
    v_pk_mul_f32 v[200:201], v[24:25], v[24:25]
    v_pk_mul_f32 v[202:203], v[26:27], v[26:27]
    v_pk_mul_f32 v[204:205], v[28:29], v[28:29]
    v_pk_mul_f32 v[206:207], v[30:31], v[30:31]
    v_pk_fma_f32 v[200:201], v[200:201], v[2:3], s[62:63]
    v_pk_fma_f32 v[202:203], v[202:203], v[2:3], s[62:63]
    v_pk_fma_f32 v[204:205], v[204:205], v[2:3], s[62:63]
    v_pk_fma_f32 v[206:207], v[206:207], v[2:3], s[62:63]
    v_pk_mul_f32 v[200:201], v[200:201], v[24:25]
    v_pk_mul_f32 v[202:203], v[202:203], v[26:27]
    v_pk_mul_f32 v[204:205], v[204:205], v[28:29]
    v_pk_mul_f32 v[206:207], v[206:207], v[30:31]
    v_exp_f32 v200, v200
    v_exp_f32 v202, v202
    v_exp_f32 v204, v204
    v_exp_f32 v206, v206
    v_exp_f32 v201, v201
    v_exp_f32 v203, v203
    v_exp_f32 v205, v205
    v_exp_f32 v207, v207
    v_pk_add_f32 v[200:201], v[200:201], 1.0 op_sel_hi:[1,0]
    v_pk_add_f32 v[202:203], v[202:203], 1.0 op_sel_hi:[1,0]
    v_pk_add_f32 v[204:205], v[204:205], 1.0 op_sel_hi:[1,0]
    v_pk_add_f32 v[206:207], v[206:207], 1.0 op_sel_hi:[1,0]
    v_rcp_f32 v200, v200
    v_rcp_f32 v202, v202
    v_rcp_f32 v204, v204
    v_rcp_f32 v206, v206
    v_rcp_f32 v201, v201
    v_rcp_f32 v203, v203
    v_rcp_f32 v205, v205
    v_rcp_f32 v207, v207
    v_pk_mul_f32 v[200:201], v[200:201], v[24:25]
    v_pk_mul_f32 v[202:203], v[202:203], v[26:27]
    v_pk_mul_f32 v[204:205], v[204:205], v[28:29]
    v_pk_mul_f32 v[206:207], v[206:207], v[30:31]
    v_cvt_pk_bf16_f32 v208, v200, v201
    v_cvt_pk_bf16_f32 v209, v202, v203
    v_cvt_pk_bf16_f32 v210, v204, v205
    v_cvt_pk_bf16_f32 v211, v206, v207
    s_add_u32 s57, s56, 0x0
    buffer_store_dwordx4 v[208:211], v1, s[32:35], s57 offen sc1
    v_pk_mul_f32 v[224:225], v[32:33], v[32:33]
    v_pk_mul_f32 v[226:227], v[34:35], v[34:35]
    v_pk_mul_f32 v[228:229], v[36:37], v[36:37]
    v_pk_mul_f32 v[230:231], v[38:39], v[38:39]
    v_pk_fma_f32 v[224:225], v[224:225], v[2:3], s[62:63]
    v_pk_fma_f32 v[226:227], v[226:227], v[2:3], s[62:63]
    v_pk_fma_f32 v[228:229], v[228:229], v[2:3], s[62:63]
    v_pk_fma_f32 v[230:231], v[230:231], v[2:3], s[62:63]
    v_pk_mul_f32 v[224:225], v[224:225], v[32:33]
    v_pk_mul_f32 v[226:227], v[226:227], v[34:35]
    v_pk_mul_f32 v[228:229], v[228:229], v[36:37]
    v_pk_mul_f32 v[230:231], v[230:231], v[38:39]
    v_exp_f32 v224, v224
    v_exp_f32 v226, v226
    v_exp_f32 v228, v228
    v_exp_f32 v230, v230
    v_exp_f32 v225, v225
    v_exp_f32 v227, v227
    v_exp_f32 v229, v229
    v_exp_f32 v231, v231
    v_pk_add_f32 v[224:225], v[224:225], 1.0 op_sel_hi:[1,0]
    v_pk_add_f32 v[226:227], v[226:227], 1.0 op_sel_hi:[1,0]
    v_pk_add_f32 v[228:229], v[228:229], 1.0 op_sel_hi:[1,0]
    v_pk_add_f32 v[230:231], v[230:231], 1.0 op_sel_hi:[1,0]
    v_rcp_f32 v224, v224
    v_rcp_f32 v226, v226
    v_rcp_f32 v228, v228
    v_rcp_f32 v230, v230
    v_rcp_f32 v225, v225
    v_rcp_f32 v227, v227
    v_rcp_f32 v229, v229
    v_rcp_f32 v231, v231
    v_pk_mul_f32 v[224:225], v[224:225], v[32:33]
    v_pk_mul_f32 v[226:227], v[226:227], v[34:35]
    v_pk_mul_f32 v[228:229], v[228:229], v[36:37]
    v_pk_mul_f32 v[230:231], v[230:231], v[38:39]
    v_cvt_pk_bf16_f32 v212, v224, v225
    v_cvt_pk_bf16_f32 v213, v226, v227
    v_cvt_pk_bf16_f32 v214, v228, v229
    v_cvt_pk_bf16_f32 v215, v230, v231
    s_add_u32 s58, s56, 0x400
    buffer_store_dwordx4 v[212:215], v1, s[32:35], s58 offen sc1
    v_pk_mul_f32 v[200:201], v[40:41], v[40:41]
    v_pk_mul_f32 v[202:203], v[42:43], v[42:43]
    v_pk_mul_f32 v[204:205], v[44:45], v[44:45]
    v_pk_mul_f32 v[206:207], v[46:47], v[46:47]
    v_pk_fma_f32 v[200:201], v[200:201], v[2:3], s[62:63]
    v_pk_fma_f32 v[202:203], v[202:203], v[2:3], s[62:63]
    v_pk_fma_f32 v[204:205], v[204:205], v[2:3], s[62:63]
    v_pk_fma_f32 v[206:207], v[206:207], v[2:3], s[62:63]
    v_pk_mul_f32 v[200:201], v[200:201], v[40:41]
    v_pk_mul_f32 v[202:203], v[202:203], v[42:43]
    v_pk_mul_f32 v[204:205], v[204:205], v[44:45]
    v_pk_mul_f32 v[206:207], v[206:207], v[46:47]
    v_exp_f32 v200, v200
    v_exp_f32 v202, v202
    v_exp_f32 v204, v204
    v_exp_f32 v206, v206
    v_exp_f32 v201, v201
    v_exp_f32 v203, v203
    v_exp_f32 v205, v205
    v_exp_f32 v207, v207
    v_pk_add_f32 v[200:201], v[200:201], 1.0 op_sel_hi:[1,0]
    v_pk_add_f32 v[202:203], v[202:203], 1.0 op_sel_hi:[1,0]
    v_pk_add_f32 v[204:205], v[204:205], 1.0 op_sel_hi:[1,0]
    v_pk_add_f32 v[206:207], v[206:207], 1.0 op_sel_hi:[1,0]
    v_rcp_f32 v200, v200
    v_rcp_f32 v202, v202
    v_rcp_f32 v204, v204
    v_rcp_f32 v206, v206
    v_rcp_f32 v201, v201
    v_rcp_f32 v203, v203
    v_rcp_f32 v205, v205
    v_rcp_f32 v207, v207
    v_pk_mul_f32 v[200:201], v[200:201], v[40:41]
    v_pk_mul_f32 v[202:203], v[202:203], v[42:43]
    v_pk_mul_f32 v[204:205], v[204:205], v[44:45]
    v_pk_mul_f32 v[206:207], v[206:207], v[46:47]
    v_cvt_pk_bf16_f32 v216, v200, v201
    v_cvt_pk_bf16_f32 v217, v202, v203
    v_cvt_pk_bf16_f32 v218, v204, v205
    v_cvt_pk_bf16_f32 v219, v206, v207
    s_add_u32 s57, s56, 0x800
    buffer_store_dwordx4 v[216:219], v1, s[32:35], s57 offen sc1
    v_pk_mul_f32 v[224:225], v[48:49], v[48:49]
    v_pk_mul_f32 v[226:227], v[50:51], v[50:51]
    v_pk_mul_f32 v[228:229], v[52:53], v[52:53]
    v_pk_mul_f32 v[230:231], v[54:55], v[54:55]
    v_pk_fma_f32 v[224:225], v[224:225], v[2:3], s[62:63]
    v_pk_fma_f32 v[226:227], v[226:227], v[2:3], s[62:63]
    v_pk_fma_f32 v[228:229], v[228:229], v[2:3], s[62:63]
    v_pk_fma_f32 v[230:231], v[230:231], v[2:3], s[62:63]
    v_pk_mul_f32 v[224:225], v[224:225], v[48:49]
    v_pk_mul_f32 v[226:227], v[226:227], v[50:51]
    v_pk_mul_f32 v[228:229], v[228:229], v[52:53]
    v_pk_mul_f32 v[230:231], v[230:231], v[54:55]
    v_exp_f32 v224, v224
    v_exp_f32 v226, v226
    v_exp_f32 v228, v228
    v_exp_f32 v230, v230
    v_exp_f32 v225, v225
    v_exp_f32 v227, v227
    v_exp_f32 v229, v229
    v_exp_f32 v231, v231
    v_pk_add_f32 v[224:225], v[224:225], 1.0 op_sel_hi:[1,0]
    v_pk_add_f32 v[226:227], v[226:227], 1.0 op_sel_hi:[1,0]
    v_pk_add_f32 v[228:229], v[228:229], 1.0 op_sel_hi:[1,0]
    v_pk_add_f32 v[230:231], v[230:231], 1.0 op_sel_hi:[1,0]
    v_rcp_f32 v224, v224
    v_rcp_f32 v226, v226
    v_rcp_f32 v228, v228
    v_rcp_f32 v230, v230
    v_rcp_f32 v225, v225
    v_rcp_f32 v227, v227
    v_rcp_f32 v229, v229
    v_rcp_f32 v231, v231
    v_pk_mul_f32 v[224:225], v[224:225], v[48:49]
    v_pk_mul_f32 v[226:227], v[226:227], v[50:51]
    v_pk_mul_f32 v[228:229], v[228:229], v[52:53]
    v_pk_mul_f32 v[230:231], v[230:231], v[54:55]
    v_cvt_pk_bf16_f32 v220, v224, v225
    v_cvt_pk_bf16_f32 v221, v226, v227
    v_cvt_pk_bf16_f32 v222, v228, v229
    v_cvt_pk_bf16_f32 v223, v230, v231
    s_add_u32 s58, s56, 0x11000
    buffer_store_dwordx4 v[220:223], v1, s[32:35], s58 offen sc1
    v_pk_mul_f32 v[200:201], v[56:57], v[56:57]
    v_pk_mul_f32 v[202:203], v[58:59], v[58:59]
    v_pk_mul_f32 v[204:205], v[60:61], v[60:61]
    v_pk_mul_f32 v[206:207], v[62:63], v[62:63]
    v_pk_fma_f32 v[200:201], v[200:201], v[2:3], s[62:63]
    v_pk_fma_f32 v[202:203], v[202:203], v[2:3], s[62:63]
    v_pk_fma_f32 v[204:205], v[204:205], v[2:3], s[62:63]
    v_pk_fma_f32 v[206:207], v[206:207], v[2:3], s[62:63]
    v_pk_mul_f32 v[200:201], v[200:201], v[56:57]
    v_pk_mul_f32 v[202:203], v[202:203], v[58:59]
    v_pk_mul_f32 v[204:205], v[204:205], v[60:61]
    v_pk_mul_f32 v[206:207], v[206:207], v[62:63]
    v_exp_f32 v200, v200
    v_exp_f32 v202, v202
    v_exp_f32 v204, v204
    v_exp_f32 v206, v206
    v_exp_f32 v201, v201
    v_exp_f32 v203, v203
    v_exp_f32 v205, v205
    v_exp_f32 v207, v207
    v_pk_add_f32 v[200:201], v[200:201], 1.0 op_sel_hi:[1,0]
    v_pk_add_f32 v[202:203], v[202:203], 1.0 op_sel_hi:[1,0]
    v_pk_add_f32 v[204:205], v[204:205], 1.0 op_sel_hi:[1,0]
    v_pk_add_f32 v[206:207], v[206:207], 1.0 op_sel_hi:[1,0]
    v_rcp_f32 v200, v200
    v_rcp_f32 v202, v202
    v_rcp_f32 v204, v204
    v_rcp_f32 v206, v206
    v_rcp_f32 v201, v201
    v_rcp_f32 v203, v203
    v_rcp_f32 v205, v205
    v_rcp_f32 v207, v207
    v_pk_mul_f32 v[200:201], v[200:201], v[56:57]
    v_pk_mul_f32 v[202:203], v[202:203], v[58:59]
    v_pk_mul_f32 v[204:205], v[204:205], v[60:61]
    v_pk_mul_f32 v[206:207], v[206:207], v[62:63]
    v_cvt_pk_bf16_f32 v208, v200, v201
    v_cvt_pk_bf16_f32 v209, v202, v203
    v_cvt_pk_bf16_f32 v210, v204, v205
    v_cvt_pk_bf16_f32 v211, v206, v207
    s_add_u32 s57, s56, 0x11400
    buffer_store_dwordx4 v[208:211], v1, s[32:35], s57 offen sc1
    v_pk_mul_f32 v[224:225], v[64:65], v[64:65]
    v_pk_mul_f32 v[226:227], v[66:67], v[66:67]
    v_pk_mul_f32 v[228:229], v[68:69], v[68:69]
    v_pk_mul_f32 v[230:231], v[70:71], v[70:71]
    v_pk_fma_f32 v[224:225], v[224:225], v[2:3], s[62:63]
    v_pk_fma_f32 v[226:227], v[226:227], v[2:3], s[62:63]
    v_pk_fma_f32 v[228:229], v[228:229], v[2:3], s[62:63]
    v_pk_fma_f32 v[230:231], v[230:231], v[2:3], s[62:63]
    v_pk_mul_f32 v[224:225], v[224:225], v[64:65]
    v_pk_mul_f32 v[226:227], v[226:227], v[66:67]
    v_pk_mul_f32 v[228:229], v[228:229], v[68:69]
    v_pk_mul_f32 v[230:231], v[230:231], v[70:71]
    v_exp_f32 v224, v224
    v_exp_f32 v226, v226
    v_exp_f32 v228, v228
    v_exp_f32 v230, v230
    v_exp_f32 v225, v225
    v_exp_f32 v227, v227
    v_exp_f32 v229, v229
    v_exp_f32 v231, v231
    v_pk_add_f32 v[224:225], v[224:225], 1.0 op_sel_hi:[1,0]
    v_pk_add_f32 v[226:227], v[226:227], 1.0 op_sel_hi:[1,0]
    v_pk_add_f32 v[228:229], v[228:229], 1.0 op_sel_hi:[1,0]
    v_pk_add_f32 v[230:231], v[230:231], 1.0 op_sel_hi:[1,0]
    v_rcp_f32 v224, v224
    v_rcp_f32 v226, v226
    v_rcp_f32 v228, v228
    v_rcp_f32 v230, v230
    v_rcp_f32 v225, v225
    v_rcp_f32 v227, v227
    v_rcp_f32 v229, v229
    v_rcp_f32 v231, v231
    v_pk_mul_f32 v[224:225], v[224:225], v[64:65]
    v_pk_mul_f32 v[226:227], v[226:227], v[66:67]
    v_pk_mul_f32 v[228:229], v[228:229], v[68:69]
    v_pk_mul_f32 v[230:231], v[230:231], v[70:71]
    v_cvt_pk_bf16_f32 v212, v224, v225
    v_cvt_pk_bf16_f32 v213, v226, v227
    v_cvt_pk_bf16_f32 v214, v228, v229
    v_cvt_pk_bf16_f32 v215, v230, v231
    s_add_u32 s58, s56, 0x11800
    buffer_store_dwordx4 v[212:215], v1, s[32:35], s58 offen sc1
    v_pk_mul_f32 v[200:201], v[72:73], v[72:73]
    v_pk_mul_f32 v[202:203], v[74:75], v[74:75]
    v_pk_mul_f32 v[204:205], v[76:77], v[76:77]
    v_pk_mul_f32 v[206:207], v[78:79], v[78:79]
    v_pk_fma_f32 v[200:201], v[200:201], v[2:3], s[62:63]
    v_pk_fma_f32 v[202:203], v[202:203], v[2:3], s[62:63]
    v_pk_fma_f32 v[204:205], v[204:205], v[2:3], s[62:63]
    v_pk_fma_f32 v[206:207], v[206:207], v[2:3], s[62:63]
    v_pk_mul_f32 v[200:201], v[200:201], v[72:73]
    v_pk_mul_f32 v[202:203], v[202:203], v[74:75]
    v_pk_mul_f32 v[204:205], v[204:205], v[76:77]
    v_pk_mul_f32 v[206:207], v[206:207], v[78:79]
    v_exp_f32 v200, v200
    v_exp_f32 v202, v202
    v_exp_f32 v204, v204
    v_exp_f32 v206, v206
    v_exp_f32 v201, v201
    v_exp_f32 v203, v203
    v_exp_f32 v205, v205
    v_exp_f32 v207, v207
    v_pk_add_f32 v[200:201], v[200:201], 1.0 op_sel_hi:[1,0]
    v_pk_add_f32 v[202:203], v[202:203], 1.0 op_sel_hi:[1,0]
    v_pk_add_f32 v[204:205], v[204:205], 1.0 op_sel_hi:[1,0]
    v_pk_add_f32 v[206:207], v[206:207], 1.0 op_sel_hi:[1,0]
    v_rcp_f32 v200, v200
    v_rcp_f32 v202, v202
    v_rcp_f32 v204, v204
    v_rcp_f32 v206, v206
    v_rcp_f32 v201, v201
    v_rcp_f32 v203, v203
    v_rcp_f32 v205, v205
    v_rcp_f32 v207, v207
    v_pk_mul_f32 v[200:201], v[200:201], v[72:73]
    v_pk_mul_f32 v[202:203], v[202:203], v[74:75]
    v_pk_mul_f32 v[204:205], v[204:205], v[76:77]
    v_pk_mul_f32 v[206:207], v[206:207], v[78:79]
    v_cvt_pk_bf16_f32 v216, v200, v201
    v_cvt_pk_bf16_f32 v217, v202, v203
    v_cvt_pk_bf16_f32 v218, v204, v205
    v_cvt_pk_bf16_f32 v219, v206, v207
    s_add_u32 s57, s56, 0x22000
    buffer_store_dwordx4 v[216:219], v1, s[32:35], s57 offen sc1
    v_pk_mul_f32 v[224:225], v[80:81], v[80:81]
    v_pk_mul_f32 v[226:227], v[82:83], v[82:83]
    v_pk_mul_f32 v[228:229], v[84:85], v[84:85]
    v_pk_mul_f32 v[230:231], v[86:87], v[86:87]
    v_pk_fma_f32 v[224:225], v[224:225], v[2:3], s[62:63]
    v_pk_fma_f32 v[226:227], v[226:227], v[2:3], s[62:63]
    v_pk_fma_f32 v[228:229], v[228:229], v[2:3], s[62:63]
    v_pk_fma_f32 v[230:231], v[230:231], v[2:3], s[62:63]
    v_pk_mul_f32 v[224:225], v[224:225], v[80:81]
    v_pk_mul_f32 v[226:227], v[226:227], v[82:83]
    v_pk_mul_f32 v[228:229], v[228:229], v[84:85]
    v_pk_mul_f32 v[230:231], v[230:231], v[86:87]
    v_exp_f32 v224, v224
    v_exp_f32 v226, v226
    v_exp_f32 v228, v228
    v_exp_f32 v230, v230
    v_exp_f32 v225, v225
    v_exp_f32 v227, v227
    v_exp_f32 v229, v229
    v_exp_f32 v231, v231
    v_pk_add_f32 v[224:225], v[224:225], 1.0 op_sel_hi:[1,0]
    v_pk_add_f32 v[226:227], v[226:227], 1.0 op_sel_hi:[1,0]
    v_pk_add_f32 v[228:229], v[228:229], 1.0 op_sel_hi:[1,0]
    v_pk_add_f32 v[230:231], v[230:231], 1.0 op_sel_hi:[1,0]
    v_rcp_f32 v224, v224
    v_rcp_f32 v226, v226
    v_rcp_f32 v228, v228
    v_rcp_f32 v230, v230
    v_rcp_f32 v225, v225
    v_rcp_f32 v227, v227
    v_rcp_f32 v229, v229
    v_rcp_f32 v231, v231
    v_pk_mul_f32 v[224:225], v[224:225], v[80:81]
    v_pk_mul_f32 v[226:227], v[226:227], v[82:83]
    v_pk_mul_f32 v[228:229], v[228:229], v[84:85]
    v_pk_mul_f32 v[230:231], v[230:231], v[86:87]
    v_cvt_pk_bf16_f32 v220, v224, v225
    v_cvt_pk_bf16_f32 v221, v226, v227
    v_cvt_pk_bf16_f32 v222, v228, v229
    v_cvt_pk_bf16_f32 v223, v230, v231
    s_add_u32 s58, s56, 0x22400
    buffer_store_dwordx4 v[220:223], v1, s[32:35], s58 offen sc1
    v_pk_mul_f32 v[200:201], v[88:89], v[88:89]
    v_pk_mul_f32 v[202:203], v[90:91], v[90:91]
    v_pk_mul_f32 v[204:205], v[92:93], v[92:93]
    v_pk_mul_f32 v[206:207], v[94:95], v[94:95]
    v_pk_fma_f32 v[200:201], v[200:201], v[2:3], s[62:63]
    v_pk_fma_f32 v[202:203], v[202:203], v[2:3], s[62:63]
    v_pk_fma_f32 v[204:205], v[204:205], v[2:3], s[62:63]
    v_pk_fma_f32 v[206:207], v[206:207], v[2:3], s[62:63]
    v_pk_mul_f32 v[200:201], v[200:201], v[88:89]
    v_pk_mul_f32 v[202:203], v[202:203], v[90:91]
    v_pk_mul_f32 v[204:205], v[204:205], v[92:93]
    v_pk_mul_f32 v[206:207], v[206:207], v[94:95]
    v_exp_f32 v200, v200
    v_exp_f32 v202, v202
    v_exp_f32 v204, v204
    v_exp_f32 v206, v206
    v_exp_f32 v201, v201
    v_exp_f32 v203, v203
    v_exp_f32 v205, v205
    v_exp_f32 v207, v207
    v_pk_add_f32 v[200:201], v[200:201], 1.0 op_sel_hi:[1,0]
    v_pk_add_f32 v[202:203], v[202:203], 1.0 op_sel_hi:[1,0]
    v_pk_add_f32 v[204:205], v[204:205], 1.0 op_sel_hi:[1,0]
    v_pk_add_f32 v[206:207], v[206:207], 1.0 op_sel_hi:[1,0]
    v_rcp_f32 v200, v200
    v_rcp_f32 v202, v202
    v_rcp_f32 v204, v204
    v_rcp_f32 v206, v206
    v_rcp_f32 v201, v201
    v_rcp_f32 v203, v203
    v_rcp_f32 v205, v205
    v_rcp_f32 v207, v207
    v_pk_mul_f32 v[200:201], v[200:201], v[88:89]
    v_pk_mul_f32 v[202:203], v[202:203], v[90:91]
    v_pk_mul_f32 v[204:205], v[204:205], v[92:93]
    v_pk_mul_f32 v[206:207], v[206:207], v[94:95]
    v_cvt_pk_bf16_f32 v208, v200, v201
    v_cvt_pk_bf16_f32 v209, v202, v203
    v_cvt_pk_bf16_f32 v210, v204, v205
    v_cvt_pk_bf16_f32 v211, v206, v207
    s_add_u32 s57, s56, 0x22800
    buffer_store_dwordx4 v[208:211], v1, s[32:35], s57 offen sc1
    v_pk_mul_f32 v[224:225], v[96:97], v[96:97]
    v_pk_mul_f32 v[226:227], v[98:99], v[98:99]
    v_pk_mul_f32 v[228:229], v[100:101], v[100:101]
    v_pk_mul_f32 v[230:231], v[102:103], v[102:103]
    v_pk_fma_f32 v[224:225], v[224:225], v[2:3], s[62:63]
    v_pk_fma_f32 v[226:227], v[226:227], v[2:3], s[62:63]
    v_pk_fma_f32 v[228:229], v[228:229], v[2:3], s[62:63]
    v_pk_fma_f32 v[230:231], v[230:231], v[2:3], s[62:63]
    v_pk_mul_f32 v[224:225], v[224:225], v[96:97]
    v_pk_mul_f32 v[226:227], v[226:227], v[98:99]
    v_pk_mul_f32 v[228:229], v[228:229], v[100:101]
    v_pk_mul_f32 v[230:231], v[230:231], v[102:103]
    v_exp_f32 v224, v224
    v_exp_f32 v226, v226
    v_exp_f32 v228, v228
    v_exp_f32 v230, v230
    v_exp_f32 v225, v225
    v_exp_f32 v227, v227
    v_exp_f32 v229, v229
    v_exp_f32 v231, v231
    v_pk_add_f32 v[224:225], v[224:225], 1.0 op_sel_hi:[1,0]
    v_pk_add_f32 v[226:227], v[226:227], 1.0 op_sel_hi:[1,0]
    v_pk_add_f32 v[228:229], v[228:229], 1.0 op_sel_hi:[1,0]
    v_pk_add_f32 v[230:231], v[230:231], 1.0 op_sel_hi:[1,0]
    v_rcp_f32 v224, v224
    v_rcp_f32 v226, v226
    v_rcp_f32 v228, v228
    v_rcp_f32 v230, v230
    v_rcp_f32 v225, v225
    v_rcp_f32 v227, v227
    v_rcp_f32 v229, v229
    v_rcp_f32 v231, v231
    v_pk_mul_f32 v[224:225], v[224:225], v[96:97]
    v_pk_mul_f32 v[226:227], v[226:227], v[98:99]
    v_pk_mul_f32 v[228:229], v[228:229], v[100:101]
    v_pk_mul_f32 v[230:231], v[230:231], v[102:103]
    v_cvt_pk_bf16_f32 v212, v224, v225
    v_cvt_pk_bf16_f32 v213, v226, v227
    v_cvt_pk_bf16_f32 v214, v228, v229
    v_cvt_pk_bf16_f32 v215, v230, v231
    s_add_u32 s58, s56, 0x33000
    buffer_store_dwordx4 v[212:215], v1, s[32:35], s58 offen sc1
    v_pk_mul_f32 v[200:201], v[104:105], v[104:105]
    v_pk_mul_f32 v[202:203], v[106:107], v[106:107]
    v_pk_mul_f32 v[204:205], v[108:109], v[108:109]
    v_pk_mul_f32 v[206:207], v[110:111], v[110:111]
    v_pk_fma_f32 v[200:201], v[200:201], v[2:3], s[62:63]
    v_pk_fma_f32 v[202:203], v[202:203], v[2:3], s[62:63]
    v_pk_fma_f32 v[204:205], v[204:205], v[2:3], s[62:63]
    v_pk_fma_f32 v[206:207], v[206:207], v[2:3], s[62:63]
    v_pk_mul_f32 v[200:201], v[200:201], v[104:105]
    v_pk_mul_f32 v[202:203], v[202:203], v[106:107]
    v_pk_mul_f32 v[204:205], v[204:205], v[108:109]
    v_pk_mul_f32 v[206:207], v[206:207], v[110:111]
    v_exp_f32 v200, v200
    v_exp_f32 v202, v202
    v_exp_f32 v204, v204
    v_exp_f32 v206, v206
    v_exp_f32 v201, v201
    v_exp_f32 v203, v203
    v_exp_f32 v205, v205
    v_exp_f32 v207, v207
    v_pk_add_f32 v[200:201], v[200:201], 1.0 op_sel_hi:[1,0]
    v_pk_add_f32 v[202:203], v[202:203], 1.0 op_sel_hi:[1,0]
    v_pk_add_f32 v[204:205], v[204:205], 1.0 op_sel_hi:[1,0]
    v_pk_add_f32 v[206:207], v[206:207], 1.0 op_sel_hi:[1,0]
    v_rcp_f32 v200, v200
    v_rcp_f32 v202, v202
    v_rcp_f32 v204, v204
    v_rcp_f32 v206, v206
    v_rcp_f32 v201, v201
    v_rcp_f32 v203, v203
    v_rcp_f32 v205, v205
    v_rcp_f32 v207, v207
    v_pk_mul_f32 v[200:201], v[200:201], v[104:105]
    v_pk_mul_f32 v[202:203], v[202:203], v[106:107]
    v_pk_mul_f32 v[204:205], v[204:205], v[108:109]
    v_pk_mul_f32 v[206:207], v[206:207], v[110:111]
    v_cvt_pk_bf16_f32 v216, v200, v201
    v_cvt_pk_bf16_f32 v217, v202, v203
    v_cvt_pk_bf16_f32 v218, v204, v205
    v_cvt_pk_bf16_f32 v219, v206, v207
    s_add_u32 s57, s56, 0x33400
    buffer_store_dwordx4 v[216:219], v1, s[32:35], s57 offen sc1
    v_pk_mul_f32 v[224:225], v[112:113], v[112:113]
    v_pk_mul_f32 v[226:227], v[114:115], v[114:115]
    v_pk_mul_f32 v[228:229], v[116:117], v[116:117]
    v_pk_mul_f32 v[230:231], v[118:119], v[118:119]
    v_pk_fma_f32 v[224:225], v[224:225], v[2:3], s[62:63]
    v_pk_fma_f32 v[226:227], v[226:227], v[2:3], s[62:63]
    v_pk_fma_f32 v[228:229], v[228:229], v[2:3], s[62:63]
    v_pk_fma_f32 v[230:231], v[230:231], v[2:3], s[62:63]
    v_pk_mul_f32 v[224:225], v[224:225], v[112:113]
    v_pk_mul_f32 v[226:227], v[226:227], v[114:115]
    v_pk_mul_f32 v[228:229], v[228:229], v[116:117]
    v_pk_mul_f32 v[230:231], v[230:231], v[118:119]
    v_exp_f32 v224, v224
    v_exp_f32 v226, v226
    v_exp_f32 v228, v228
    v_exp_f32 v230, v230
    v_exp_f32 v225, v225
    v_exp_f32 v227, v227
    v_exp_f32 v229, v229
    v_exp_f32 v231, v231
    v_pk_add_f32 v[224:225], v[224:225], 1.0 op_sel_hi:[1,0]
    v_pk_add_f32 v[226:227], v[226:227], 1.0 op_sel_hi:[1,0]
    v_pk_add_f32 v[228:229], v[228:229], 1.0 op_sel_hi:[1,0]
    v_pk_add_f32 v[230:231], v[230:231], 1.0 op_sel_hi:[1,0]
    v_rcp_f32 v224, v224
    v_rcp_f32 v226, v226
    v_rcp_f32 v228, v228
    v_rcp_f32 v230, v230
    v_rcp_f32 v225, v225
    v_rcp_f32 v227, v227
    v_rcp_f32 v229, v229
    v_rcp_f32 v231, v231
    v_pk_mul_f32 v[224:225], v[224:225], v[112:113]
    v_pk_mul_f32 v[226:227], v[226:227], v[114:115]
    v_pk_mul_f32 v[228:229], v[228:229], v[116:117]
    v_pk_mul_f32 v[230:231], v[230:231], v[118:119]
    v_cvt_pk_bf16_f32 v220, v224, v225
    v_cvt_pk_bf16_f32 v221, v226, v227
    v_cvt_pk_bf16_f32 v222, v228, v229
    v_cvt_pk_bf16_f32 v223, v230, v231
    s_add_u32 s58, s56, 0x33800
    buffer_store_dwordx4 v[220:223], v1, s[32:35], s58 offen sc1
    s_endpgm
L_k1_end:
    s_endpgm
.globl k2_kernel
.p2align 8
.type k2_kernel,@function
k2_kernel:
    s_cmp_ge_u32 s2, 256
    s_cbranch_scc1 L_k2_end
    s_load_dwordx2 s[4:5], s[0:1], 88
    s_load_dwordx2 s[6:7], s[0:1], 72
    s_load_dwordx2 s[36:37], s[0:1], 56
    v_lshrrev_b32 v1, 6, v0
    v_and_b32 v0, 63, v0
    v_readfirstlane_b32 s20, v1
    s_and_b32 s21, s2, 1
    s_lshl_b32 s21, s21, 4
    s_bfe_u32 s32, s2, 0x10001
    s_lshl_b32 s32, s32, 3
    s_add_u32 s21, s21, s32
    s_lshr_b32 s32, s2, 5
    s_add_u32 s21, s21, s32
    s_bfe_u32 s22, s2, 0x10002
    s_lshl_b32 s22, s22, 2
    s_bfe_u32 s32, s2, 0x20003
    s_add_u32 s22, s22, s32
    v_lshlrev_b32 v1, 4, v0
    s_mul_i32 s32, s21, 0x44000
    s_add_u32 s33, s20, 0
    s_and_b32 s33, s33, 3
    s_mul_i32 s34, s33, 0x11000
    s_add_u32 s34, s34, s32
    v_add_u32 v8, s34, v1
    s_add_u32 s33, s20, 1
    s_and_b32 s33, s33, 3
    s_mul_i32 s34, s33, 0x11000
    s_add_u32 s34, s34, s32
    v_add_u32 v9, s34, v1
    s_add_u32 s33, s20, 2
    s_and_b32 s33, s33, 3
    s_mul_i32 s34, s33, 0x11000
    s_add_u32 s34, s34, s32
    v_add_u32 v10, s34, v1
    s_add_u32 s33, s20, 3
    s_and_b32 s33, s33, 3
    s_mul_i32 s34, s33, 0x11000
    s_add_u32 s34, s34, s32
    v_add_u32 v11, s34, v1
    s_mul_i32 s32, s22, 5120
    s_add_u32 s32, s32, 0x900000
    v_add_u32 v12, s32, v1
    v_add_u32 v13, 0x1000, v12
    s_mul_i32 s24, s20, 5120
    s_mul_i32 s25, s20, 12288
    s_add_u32 s25, s25, 20480
    s_mul_i32 s26, s24, 40
    s_mul_i32 s27, s25, 40
    v_and_b32 v2, 15, v0
    v_lshlrev_b32 v213, 2, v2
    v_lshrrev_b32 v4, 4, v0
    v_lshlrev_b32 v215, 3, v4
    v_mul_u32_u24 v214, 0xa00, v2
    v_add_u32 v214, v214, v215
    s_waitcnt lgkmcnt(0)
    s_mov_b32 s8, s4
    s_mov_b32 s9, s5
    s_mov_b32 s10, 0xc02000
    s_mov_b32 s11, 0x20000
    s_add_u32 s28, s24, 0x0
    s_add_u32 s30, s26, 0x0
    buffer_load_dwordx4 a[0:3], v8, s[8:11], s28 offen
    buffer_load_dwordx4 a[16:19], v12, s[8:11], s30 offen offset:0
    buffer_load_dwordx4 a[4:7], v9, s[8:11], s28 offen
    buffer_load_dwordx4 a[8:11], v10, s[8:11], s28 offen
    buffer_load_dwordx4 a[12:15], v11, s[8:11], s28 offen
    buffer_load_dwordx4 a[20:23], v12, s[8:11], s30 offen offset:1024
    buffer_load_dwordx4 a[24:27], v12, s[8:11], s30 offen offset:2048
    buffer_load_dwordx4 a[28:31], v12, s[8:11], s30 offen offset:3072
    buffer_load_dwordx4 a[32:35], v13, s[8:11], s30 offen
    s_add_u32 s29, s24, 0x400
    s_add_u32 s31, s26, 0xa000
    buffer_load_dwordx4 a[36:39], v8, s[8:11], s29 offen
    buffer_load_dwordx4 a[52:55], v12, s[8:11], s31 offen offset:0
    buffer_load_dwordx4 a[40:43], v9, s[8:11], s29 offen
    buffer_load_dwordx4 a[44:47], v10, s[8:11], s29 offen
    buffer_load_dwordx4 a[48:51], v11, s[8:11], s29 offen
    buffer_load_dwordx4 a[56:59], v12, s[8:11], s31 offen offset:1024
    buffer_load_dwordx4 a[60:63], v12, s[8:11], s31 offen offset:2048
    buffer_load_dwordx4 a[64:67], v12, s[8:11], s31 offen offset:3072
    buffer_load_dwordx4 a[68:71], v13, s[8:11], s31 offen
    s_mov_b32 s12, s6
    s_mov_b32 s13, s7
    s_mov_b32 s14, 0x280000
    s_mov_b32 s15, 0x20000
    s_mov_b32 s16, s36
    s_mov_b32 s17, s37
    s_mov_b32 s18, 0x500
    s_mov_b32 s19, 0x20000
    s_mul_i32 s44, s22, 160
    s_add_u32 s44, s36, s44
    s_addc_u32 s45, s37, 0
    s_load_dword s46, s[44:45], 0
    s_load_dword s46, s[44:45], 64
    s_load_dword s46, s[44:45], 128
    s_load_dword s46, s[44:45], 156
    s_waitcnt vmcnt(9)
    v_mfma_f32_16x16x32_bf16 v[44:47], a[16:19], a[0:3], 0
    s_add_u32 s28, s24, 0x800
    v_mfma_f32_16x16x32_bf16 v[64:67], a[16:19], a[4:7], 0
    s_add_u32 s30, s26, 0x14000
    v_mfma_f32_16x16x32_bf16 v[84:87], a[16:19], a[8:11], 0
    buffer_load_dwordx4 a[72:75], v8, s[8:11], s28 offen
    v_mfma_f32_16x16x32_bf16 v[104:107], a[16:19], a[12:15], 0
    buffer_load_dwordx4 a[88:91], v12, s[8:11], s30 offen offset:0
    v_mfma_f32_16x16x32_bf16 v[48:51], a[20:23], a[0:3], 0
    buffer_load_dwordx4 a[76:79], v9, s[8:11], s28 offen
    v_mfma_f32_16x16x32_bf16 v[68:71], a[20:23], a[4:7], 0
    buffer_load_dwordx4 a[80:83], v10, s[8:11], s28 offen
    v_mfma_f32_16x16x32_bf16 v[88:91], a[20:23], a[8:11], 0
    buffer_load_dwordx4 a[84:87], v11, s[8:11], s28 offen
    v_mfma_f32_16x16x32_bf16 v[108:111], a[20:23], a[12:15], 0
    buffer_load_dwordx4 a[92:95], v12, s[8:11], s30 offen offset:1024
    v_mfma_f32_16x16x32_bf16 v[52:55], a[24:27], a[0:3], 0
    buffer_load_dwordx4 a[96:99], v12, s[8:11], s30 offen offset:2048
    v_mfma_f32_16x16x32_bf16 v[72:75], a[24:27], a[4:7], 0
    buffer_load_dwordx4 a[100:103], v12, s[8:11], s30 offen offset:3072
    v_mfma_f32_16x16x32_bf16 v[92:95], a[24:27], a[8:11], 0
    buffer_load_dwordx4 a[104:107], v13, s[8:11], s30 offen
    v_mfma_f32_16x16x32_bf16 v[112:115], a[24:27], a[12:15], 0
    v_mfma_f32_16x16x32_bf16 v[56:59], a[28:31], a[0:3], 0
    v_mfma_f32_16x16x32_bf16 v[76:79], a[28:31], a[4:7], 0
    v_mfma_f32_16x16x32_bf16 v[96:99], a[28:31], a[8:11], 0
    v_mfma_f32_16x16x32_bf16 v[116:119], a[28:31], a[12:15], 0
    v_mfma_f32_16x16x32_bf16 v[60:63], a[32:35], a[0:3], 0
    v_mfma_f32_16x16x32_bf16 v[80:83], a[32:35], a[4:7], 0
    v_mfma_f32_16x16x32_bf16 v[100:103], a[32:35], a[8:11], 0
    v_mfma_f32_16x16x32_bf16 v[120:123], a[32:35], a[12:15], 0
    s_waitcnt vmcnt(9)
    v_mfma_f32_16x16x32_bf16 v[44:47], a[52:55], a[36:39], v[44:47]
    s_add_u32 s29, s24, 0xc00
    v_mfma_f32_16x16x32_bf16 v[64:67], a[52:55], a[40:43], v[64:67]
    s_add_u32 s31, s26, 0x1e000
    v_mfma_f32_16x16x32_bf16 v[84:87], a[52:55], a[44:47], v[84:87]
    buffer_load_dwordx4 a[0:3], v8, s[8:11], s29 offen
    v_mfma_f32_16x16x32_bf16 v[104:107], a[52:55], a[48:51], v[104:107]
    buffer_load_dwordx4 a[16:19], v12, s[8:11], s31 offen offset:0
    v_mfma_f32_16x16x32_bf16 v[48:51], a[56:59], a[36:39], v[48:51]
    buffer_load_dwordx4 a[4:7], v9, s[8:11], s29 offen
    v_mfma_f32_16x16x32_bf16 v[68:71], a[56:59], a[40:43], v[68:71]
    buffer_load_dwordx4 a[8:11], v10, s[8:11], s29 offen
    v_mfma_f32_16x16x32_bf16 v[88:91], a[56:59], a[44:47], v[88:91]
    buffer_load_dwordx4 a[12:15], v11, s[8:11], s29 offen
    v_mfma_f32_16x16x32_bf16 v[108:111], a[56:59], a[48:51], v[108:111]
    buffer_load_dwordx4 a[20:23], v12, s[8:11], s31 offen offset:1024
    v_mfma_f32_16x16x32_bf16 v[52:55], a[60:63], a[36:39], v[52:55]
    buffer_load_dwordx4 a[24:27], v12, s[8:11], s31 offen offset:2048
    v_mfma_f32_16x16x32_bf16 v[72:75], a[60:63], a[40:43], v[72:75]
    buffer_load_dwordx4 a[28:31], v12, s[8:11], s31 offen offset:3072
    v_mfma_f32_16x16x32_bf16 v[92:95], a[60:63], a[44:47], v[92:95]
    buffer_load_dwordx4 a[32:35], v13, s[8:11], s31 offen
    v_mfma_f32_16x16x32_bf16 v[112:115], a[60:63], a[48:51], v[112:115]
    s_add_u32 s33, s20, 0
    s_and_b32 s33, s33, 3
    s_mul_i32 s34, s33, 15360
    v_add_u32 v212, s34, v1
    v_mfma_f32_16x16x32_bf16 v[56:59], a[64:67], a[36:39], v[56:59]
    s_lshl_b32 s34, s21, 2
    s_add_u32 s33, s33, s34
    s_lshl_b32 s33, s33, 6
    s_add_u32 s33, s33, 0xc00000
    v_mfma_f32_16x16x32_bf16 v[76:79], a[64:67], a[40:43], v[76:79]
    buffer_load_dword v16, v213, s[8:11], s33 offen
    s_add_u32 s33, s20, 1
    s_and_b32 s33, s33, 3
    s_mul_i32 s34, s33, 15360
    v_mfma_f32_16x16x32_bf16 v[96:99], a[64:67], a[44:47], v[96:99]
    v_add_u32 v209, s34, v1
    s_lshl_b32 s34, s21, 2
    s_add_u32 s33, s33, s34
    s_lshl_b32 s33, s33, 6
    v_mfma_f32_16x16x32_bf16 v[116:119], a[64:67], a[48:51], v[116:119]
    s_add_u32 s33, s33, 0xc00000
    buffer_load_dword v18, v213, s[8:11], s33 offen
    s_add_u32 s33, s20, 2
    s_and_b32 s33, s33, 3
    v_mfma_f32_16x16x32_bf16 v[60:63], a[68:71], a[36:39], v[60:63]
    s_mul_i32 s34, s33, 15360
    v_add_u32 v210, s34, v1
    s_lshl_b32 s34, s21, 2
    s_add_u32 s33, s33, s34
    v_mfma_f32_16x16x32_bf16 v[80:83], a[68:71], a[40:43], v[80:83]
    s_lshl_b32 s33, s33, 6
    s_add_u32 s33, s33, 0xc00000
    buffer_load_dword v20, v213, s[8:11], s33 offen
    s_add_u32 s33, s20, 3
    v_mfma_f32_16x16x32_bf16 v[100:103], a[68:71], a[44:47], v[100:103]
    s_and_b32 s33, s33, 3
    s_mul_i32 s34, s33, 15360
    v_add_u32 v211, s34, v1
    s_lshl_b32 s34, s21, 2
    v_mfma_f32_16x16x32_bf16 v[120:123], a[68:71], a[48:51], v[120:123]
    s_add_u32 s33, s33, s34
    s_lshl_b32 s33, s33, 6
    s_add_u32 s33, s33, 0xc00000
    buffer_load_dword v22, v213, s[8:11], s33 offen
    s_waitcnt vmcnt(13)
    v_mfma_f32_16x16x32_bf16 v[44:47], a[88:91], a[72:75], v[44:47]
    s_add_u32 s28, s24, 0x1000
    v_mfma_f32_16x16x32_bf16 v[64:67], a[88:91], a[76:79], v[64:67]
    s_add_u32 s30, s26, 0x28000
    v_mfma_f32_16x16x32_bf16 v[84:87], a[88:91], a[80:83], v[84:87]
    buffer_load_dwordx4 a[36:39], v8, s[8:11], s28 offen
    v_mfma_f32_16x16x32_bf16 v[104:107], a[88:91], a[84:87], v[104:107]
    buffer_load_dwordx4 a[52:55], v12, s[8:11], s30 offen offset:0
    v_mfma_f32_16x16x32_bf16 v[48:51], a[92:95], a[72:75], v[48:51]
    buffer_load_dwordx4 a[40:43], v9, s[8:11], s28 offen
    v_mfma_f32_16x16x32_bf16 v[68:71], a[92:95], a[76:79], v[68:71]
    buffer_load_dwordx4 a[44:47], v10, s[8:11], s28 offen
    v_mfma_f32_16x16x32_bf16 v[88:91], a[92:95], a[80:83], v[88:91]
    buffer_load_dwordx4 a[48:51], v11, s[8:11], s28 offen
    v_mfma_f32_16x16x32_bf16 v[108:111], a[92:95], a[84:87], v[108:111]
    buffer_load_dwordx4 a[56:59], v12, s[8:11], s30 offen offset:1024
    v_mfma_f32_16x16x32_bf16 v[52:55], a[96:99], a[72:75], v[52:55]
    buffer_load_dwordx4 a[60:63], v12, s[8:11], s30 offen offset:2048
    v_mfma_f32_16x16x32_bf16 v[72:75], a[96:99], a[76:79], v[72:75]
    buffer_load_dwordx4 a[64:67], v12, s[8:11], s30 offen offset:3072
    v_mfma_f32_16x16x32_bf16 v[92:95], a[96:99], a[80:83], v[92:95]
    buffer_load_dwordx4 a[68:71], v13, s[8:11], s30 offen
    v_mfma_f32_16x16x32_bf16 v[112:115], a[96:99], a[84:87], v[112:115]
    v_mfma_f32_16x16x32_bf16 v[56:59], a[100:103], a[72:75], v[56:59]
    v_mfma_f32_16x16x32_bf16 v[76:79], a[100:103], a[76:79], v[76:79]
    v_mfma_f32_16x16x32_bf16 v[96:99], a[100:103], a[80:83], v[96:99]
    v_mfma_f32_16x16x32_bf16 v[116:119], a[100:103], a[84:87], v[116:119]
    v_mfma_f32_16x16x32_bf16 v[60:63], a[104:107], a[72:75], v[60:63]
    v_mfma_f32_16x16x32_bf16 v[80:83], a[104:107], a[76:79], v[80:83]
    v_mfma_f32_16x16x32_bf16 v[100:103], a[104:107], a[80:83], v[100:103]
    v_mfma_f32_16x16x32_bf16 v[120:123], a[104:107], a[84:87], v[120:123]
    s_waitcnt vmcnt(13)
    v_mfma_f32_16x16x32_bf16 v[44:47], a[16:19], a[0:3], v[44:47]
    s_add_u32 s29, s25, 0x0
    v_mfma_f32_16x16x32_bf16 v[64:67], a[16:19], a[4:7], v[64:67]
    s_add_u32 s31, s27, 0x0
    v_mfma_f32_16x16x32_bf16 v[84:87], a[16:19], a[8:11], v[84:87]
    buffer_load_dwordx4 a[72:75], v8, s[8:11], s29 offen
    v_mfma_f32_16x16x32_bf16 v[104:107], a[16:19], a[12:15], v[104:107]
    buffer_load_dwordx4 a[88:91], v12, s[8:11], s31 offen offset:0
    v_mfma_f32_16x16x32_bf16 v[48:51], a[20:23], a[0:3], v[48:51]
    buffer_load_dwordx4 a[76:79], v9, s[8:11], s29 offen
    v_mfma_f32_16x16x32_bf16 v[68:71], a[20:23], a[4:7], v[68:71]
    buffer_load_dwordx4 a[80:83], v10, s[8:11], s29 offen
    v_mfma_f32_16x16x32_bf16 v[88:91], a[20:23], a[8:11], v[88:91]
    buffer_load_dwordx4 a[84:87], v11, s[8:11], s29 offen
    v_mfma_f32_16x16x32_bf16 v[108:111], a[20:23], a[12:15], v[108:111]
    buffer_load_dwordx4 a[92:95], v12, s[8:11], s31 offen offset:1024
    v_mfma_f32_16x16x32_bf16 v[52:55], a[24:27], a[0:3], v[52:55]
    buffer_load_dwordx4 a[96:99], v12, s[8:11], s31 offen offset:2048
    v_mfma_f32_16x16x32_bf16 v[72:75], a[24:27], a[4:7], v[72:75]
    buffer_load_dwordx4 a[100:103], v12, s[8:11], s31 offen offset:3072
    v_mfma_f32_16x16x32_bf16 v[92:95], a[24:27], a[8:11], v[92:95]
    buffer_load_dwordx4 a[104:107], v13, s[8:11], s31 offen
    v_mfma_f32_16x16x32_bf16 v[112:115], a[24:27], a[12:15], v[112:115]
    v_mfma_f32_16x16x32_bf16 v[56:59], a[28:31], a[0:3], v[56:59]
    v_mfma_f32_16x16x32_bf16 v[76:79], a[28:31], a[4:7], v[76:79]
    v_mfma_f32_16x16x32_bf16 v[96:99], a[28:31], a[8:11], v[96:99]
    v_mfma_f32_16x16x32_bf16 v[116:119], a[28:31], a[12:15], v[116:119]
    v_mfma_f32_16x16x32_bf16 v[60:63], a[32:35], a[0:3], v[60:63]
    v_mfma_f32_16x16x32_bf16 v[80:83], a[32:35], a[4:7], v[80:83]
    v_mfma_f32_16x16x32_bf16 v[100:103], a[32:35], a[8:11], v[100:103]
    v_mfma_f32_16x16x32_bf16 v[120:123], a[32:35], a[12:15], v[120:123]
    s_waitcnt vmcnt(9)
    v_mfma_f32_16x16x32_bf16 v[44:47], a[52:55], a[36:39], v[44:47]
    s_add_u32 s28, s25, 0x400
    v_mfma_f32_16x16x32_bf16 v[64:67], a[52:55], a[40:43], v[64:67]
    s_add_u32 s30, s27, 0xa000
    v_mfma_f32_16x16x32_bf16 v[84:87], a[52:55], a[44:47], v[84:87]
    buffer_load_dwordx4 a[0:3], v8, s[8:11], s28 offen
    v_mfma_f32_16x16x32_bf16 v[104:107], a[52:55], a[48:51], v[104:107]
    buffer_load_dwordx4 a[16:19], v12, s[8:11], s30 offen offset:0
    v_mfma_f32_16x16x32_bf16 v[48:51], a[56:59], a[36:39], v[48:51]
    buffer_load_dwordx4 a[4:7], v9, s[8:11], s28 offen
    v_mfma_f32_16x16x32_bf16 v[68:71], a[56:59], a[40:43], v[68:71]
    buffer_load_dwordx4 a[8:11], v10, s[8:11], s28 offen
    v_mfma_f32_16x16x32_bf16 v[88:91], a[56:59], a[44:47], v[88:91]
    buffer_load_dwordx4 a[12:15], v11, s[8:11], s28 offen
    v_mfma_f32_16x16x32_bf16 v[108:111], a[56:59], a[48:51], v[108:111]
    buffer_load_dwordx4 a[20:23], v12, s[8:11], s30 offen offset:1024
    v_mfma_f32_16x16x32_bf16 v[52:55], a[60:63], a[36:39], v[52:55]
    buffer_load_dwordx4 a[24:27], v12, s[8:11], s30 offen offset:2048
    v_mfma_f32_16x16x32_bf16 v[72:75], a[60:63], a[40:43], v[72:75]
    buffer_load_dwordx4 a[28:31], v12, s[8:11], s30 offen offset:3072
    v_mfma_f32_16x16x32_bf16 v[92:95], a[60:63], a[44:47], v[92:95]
    buffer_load_dwordx4 a[32:35], v13, s[8:11], s30 offen
    v_mfma_f32_16x16x32_bf16 v[112:115], a[60:63], a[48:51], v[112:115]
    v_sub_f32 v24, 1.0, v16
    v_cvt_pk_bf16_f32 v24, v24, v24
    v_mfma_f32_16x16x32_bf16 v[56:59], a[64:67], a[36:39], v[56:59]
    v_lshlrev_b32 v24, 16, v24
    v_sub_f32 v26, 1.0, v18
    v_mfma_f32_16x16x32_bf16 v[76:79], a[64:67], a[40:43], v[76:79]
    v_cvt_pk_bf16_f32 v26, v26, v26
    v_lshlrev_b32 v26, 16, v26
    v_mfma_f32_16x16x32_bf16 v[96:99], a[64:67], a[44:47], v[96:99]
    v_sub_f32 v28, 1.0, v20
    v_cvt_pk_bf16_f32 v28, v28, v28
    v_mfma_f32_16x16x32_bf16 v[116:119], a[64:67], a[48:51], v[116:119]
    v_lshlrev_b32 v28, 16, v28
    v_sub_f32 v30, 1.0, v22
    v_mfma_f32_16x16x32_bf16 v[60:63], a[68:71], a[36:39], v[60:63]
    v_cvt_pk_bf16_f32 v30, v30, v30
    v_lshlrev_b32 v30, 16, v30
    v_mfma_f32_16x16x32_bf16 v[80:83], a[68:71], a[40:43], v[80:83]
    v_mfma_f32_16x16x32_bf16 v[100:103], a[68:71], a[44:47], v[100:103]
    v_mfma_f32_16x16x32_bf16 v[120:123], a[68:71], a[48:51], v[120:123]
    s_waitcnt vmcnt(9)
    v_mfma_f32_16x16x32_bf16 v[124:127], a[88:91], a[72:75], 0
    s_add_u32 s29, s25, 0x800
    v_mfma_f32_16x16x32_bf16 v[144:147], a[88:91], a[76:79], 0
    s_add_u32 s31, s27, 0x14000
    v_mfma_f32_16x16x32_bf16 v[164:167], a[88:91], a[80:83], 0
    buffer_load_dwordx4 a[36:39], v8, s[8:11], s29 offen
    v_mfma_f32_16x16x32_bf16 v[184:187], a[88:91], a[84:87], 0
    buffer_load_dwordx4 a[52:55], v12, s[8:11], s31 offen offset:0
    v_mfma_f32_16x16x32_bf16 v[128:131], a[92:95], a[72:75], 0
    buffer_load_dwordx4 a[40:43], v9, s[8:11], s29 offen
    v_mfma_f32_16x16x32_bf16 v[148:151], a[92:95], a[76:79], 0
    buffer_load_dwordx4 a[44:47], v10, s[8:11], s29 offen
    v_mfma_f32_16x16x32_bf16 v[168:171], a[92:95], a[80:83], 0
    buffer_load_dwordx4 a[48:51], v11, s[8:11], s29 offen
    v_mfma_f32_16x16x32_bf16 v[188:191], a[92:95], a[84:87], 0
    buffer_load_dwordx4 a[56:59], v12, s[8:11], s31 offen offset:1024
    v_mfma_f32_16x16x32_bf16 v[132:135], a[96:99], a[72:75], 0
    buffer_load_dwordx4 a[60:63], v12, s[8:11], s31 offen offset:2048
    v_mfma_f32_16x16x32_bf16 v[152:155], a[96:99], a[76:79], 0
    buffer_load_dwordx4 a[64:67], v12, s[8:11], s31 offen offset:3072
    v_mfma_f32_16x16x32_bf16 v[172:175], a[96:99], a[80:83], 0
    buffer_load_dwordx4 a[68:71], v13, s[8:11], s31 offen
    v_mfma_f32_16x16x32_bf16 v[192:195], a[96:99], a[84:87], 0
    v_mfma_f32_16x16x32_bf16 v[136:139], a[100:103], a[72:75], 0
    v_mfma_f32_16x16x32_bf16 v[156:159], a[100:103], a[76:79], 0
    v_mfma_f32_16x16x32_bf16 v[176:179], a[100:103], a[80:83], 0
    v_mfma_f32_16x16x32_bf16 v[196:199], a[100:103], a[84:87], 0
    v_mfma_f32_16x16x32_bf16 v[140:143], a[104:107], a[72:75], 0
    v_mfma_f32_16x16x32_bf16 v[160:163], a[104:107], a[76:79], 0
    v_mfma_f32_16x16x32_bf16 v[180:183], a[104:107], a[80:83], 0
    v_mfma_f32_16x16x32_bf16 v[200:203], a[104:107], a[84:87], 0
    s_waitcnt vmcnt(9)
    v_mfma_f32_16x16x32_bf16 v[124:127], a[16:19], a[0:3], v[124:127]
    s_add_u32 s28, s25, 0xc00
    v_mfma_f32_16x16x32_bf16 v[144:147], a[16:19], a[4:7], v[144:147]
    s_add_u32 s30, s27, 0x1e000
    v_mfma_f32_16x16x32_bf16 v[164:167], a[16:19], a[8:11], v[164:167]
    buffer_load_dwordx4 a[72:75], v8, s[8:11], s28 offen
    v_mfma_f32_16x16x32_bf16 v[184:187], a[16:19], a[12:15], v[184:187]
    buffer_load_dwordx4 a[88:91], v12, s[8:11], s30 offen offset:0
    v_mfma_f32_16x16x32_bf16 v[128:131], a[20:23], a[0:3], v[128:131]
    buffer_load_dwordx4 a[76:79], v9, s[8:11], s28 offen
    v_mfma_f32_16x16x32_bf16 v[148:151], a[20:23], a[4:7], v[148:151]
    buffer_load_dwordx4 a[80:83], v10, s[8:11], s28 offen
    v_mfma_f32_16x16x32_bf16 v[168:171], a[20:23], a[8:11], v[168:171]
    buffer_load_dwordx4 a[84:87], v11, s[8:11], s28 offen
    v_mfma_f32_16x16x32_bf16 v[188:191], a[20:23], a[12:15], v[188:191]
    buffer_load_dwordx4 a[92:95], v12, s[8:11], s30 offen offset:1024
    v_mfma_f32_16x16x32_bf16 v[132:135], a[24:27], a[0:3], v[132:135]
    buffer_load_dwordx4 a[96:99], v12, s[8:11], s30 offen offset:2048
    v_mfma_f32_16x16x32_bf16 v[152:155], a[24:27], a[4:7], v[152:155]
    buffer_load_dwordx4 a[100:103], v12, s[8:11], s30 offen offset:3072
    v_mfma_f32_16x16x32_bf16 v[172:175], a[24:27], a[8:11], v[172:175]
    buffer_load_dwordx4 a[104:107], v13, s[8:11], s30 offen
    v_mfma_f32_16x16x32_bf16 v[192:195], a[24:27], a[12:15], v[192:195]
    v_mfma_f32_16x16x32_bf16 v[136:139], a[28:31], a[0:3], v[136:139]
    v_mfma_f32_16x16x32_bf16 v[156:159], a[28:31], a[4:7], v[156:159]
    v_mfma_f32_16x16x32_bf16 v[176:179], a[28:31], a[8:11], v[176:179]
    v_mfma_f32_16x16x32_bf16 v[196:199], a[28:31], a[12:15], v[196:199]
    v_mfma_f32_16x16x32_bf16 v[140:143], a[32:35], a[0:3], v[140:143]
    v_mfma_f32_16x16x32_bf16 v[160:163], a[32:35], a[4:7], v[160:163]
    v_mfma_f32_16x16x32_bf16 v[180:183], a[32:35], a[8:11], v[180:183]
    v_mfma_f32_16x16x32_bf16 v[200:203], a[32:35], a[12:15], v[200:203]
    s_waitcnt vmcnt(9)
    v_mfma_f32_16x16x32_bf16 v[124:127], a[52:55], a[36:39], v[124:127]
    s_add_u32 s29, s25, 0x1000
    v_mfma_f32_16x16x32_bf16 v[144:147], a[52:55], a[40:43], v[144:147]
    s_add_u32 s31, s27, 0x28000
    v_mfma_f32_16x16x32_bf16 v[164:167], a[52:55], a[44:47], v[164:167]
    buffer_load_dwordx4 a[0:3], v8, s[8:11], s29 offen
    v_mfma_f32_16x16x32_bf16 v[184:187], a[52:55], a[48:51], v[184:187]
    buffer_load_dwordx4 a[16:19], v12, s[8:11], s31 offen offset:0
    v_mfma_f32_16x16x32_bf16 v[128:131], a[56:59], a[36:39], v[128:131]
    buffer_load_dwordx4 a[4:7], v9, s[8:11], s29 offen
    v_mfma_f32_16x16x32_bf16 v[148:151], a[56:59], a[40:43], v[148:151]
    buffer_load_dwordx4 a[8:11], v10, s[8:11], s29 offen
    v_mfma_f32_16x16x32_bf16 v[168:171], a[56:59], a[44:47], v[168:171]
    buffer_load_dwordx4 a[12:15], v11, s[8:11], s29 offen
    v_mfma_f32_16x16x32_bf16 v[188:191], a[56:59], a[48:51], v[188:191]
    buffer_load_dwordx4 a[20:23], v12, s[8:11], s31 offen offset:1024
    v_mfma_f32_16x16x32_bf16 v[132:135], a[60:63], a[36:39], v[132:135]
    buffer_load_dwordx4 a[24:27], v12, s[8:11], s31 offen offset:2048
    v_mfma_f32_16x16x32_bf16 v[152:155], a[60:63], a[40:43], v[152:155]
    buffer_load_dwordx4 a[28:31], v12, s[8:11], s31 offen offset:3072
    v_mfma_f32_16x16x32_bf16 v[172:175], a[60:63], a[44:47], v[172:175]
    buffer_load_dwordx4 a[32:35], v13, s[8:11], s31 offen
    v_mfma_f32_16x16x32_bf16 v[192:195], a[60:63], a[48:51], v[192:195]
    v_mfma_f32_16x16x32_bf16 v[136:139], a[64:67], a[36:39], v[136:139]
    v_mfma_f32_16x16x32_bf16 v[156:159], a[64:67], a[40:43], v[156:159]
    v_mfma_f32_16x16x32_bf16 v[176:179], a[64:67], a[44:47], v[176:179]
    v_mfma_f32_16x16x32_bf16 v[196:199], a[64:67], a[48:51], v[196:199]
    v_mfma_f32_16x16x32_bf16 v[140:143], a[68:71], a[36:39], v[140:143]
    v_mfma_f32_16x16x32_bf16 v[160:163], a[68:71], a[40:43], v[160:163]
    v_mfma_f32_16x16x32_bf16 v[180:183], a[68:71], a[44:47], v[180:183]
    v_mfma_f32_16x16x32_bf16 v[200:203], a[68:71], a[48:51], v[200:203]
    s_waitcnt vmcnt(9)
    v_mfma_f32_16x16x32_bf16 v[124:127], a[88:91], a[72:75], v[124:127]
    s_add_u32 s28, s25, 0x1400
    v_mfma_f32_16x16x32_bf16 v[144:147], a[88:91], a[76:79], v[144:147]
    s_add_u32 s30, s27, 0x32000
    v_mfma_f32_16x16x32_bf16 v[164:167], a[88:91], a[80:83], v[164:167]
    buffer_load_dwordx4 a[36:39], v8, s[8:11], s28 offen
    v_mfma_f32_16x16x32_bf16 v[184:187], a[88:91], a[84:87], v[184:187]
    buffer_load_dwordx4 a[52:55], v12, s[8:11], s30 offen offset:0
    v_mfma_f32_16x16x32_bf16 v[128:131], a[92:95], a[72:75], v[128:131]
    buffer_load_dwordx4 a[40:43], v9, s[8:11], s28 offen
    v_mfma_f32_16x16x32_bf16 v[148:151], a[92:95], a[76:79], v[148:151]
    buffer_load_dwordx4 a[44:47], v10, s[8:11], s28 offen
    v_mfma_f32_16x16x32_bf16 v[168:171], a[92:95], a[80:83], v[168:171]
    buffer_load_dwordx4 a[48:51], v11, s[8:11], s28 offen
    v_mfma_f32_16x16x32_bf16 v[188:191], a[92:95], a[84:87], v[188:191]
    buffer_load_dwordx4 a[56:59], v12, s[8:11], s30 offen offset:1024
    v_mfma_f32_16x16x32_bf16 v[132:135], a[96:99], a[72:75], v[132:135]
    buffer_load_dwordx4 a[60:63], v12, s[8:11], s30 offen offset:2048
    v_mfma_f32_16x16x32_bf16 v[152:155], a[96:99], a[76:79], v[152:155]
    buffer_load_dwordx4 a[64:67], v12, s[8:11], s30 offen offset:3072
    v_mfma_f32_16x16x32_bf16 v[172:175], a[96:99], a[80:83], v[172:175]
    buffer_load_dwordx4 a[68:71], v13, s[8:11], s30 offen
    v_mfma_f32_16x16x32_bf16 v[192:195], a[96:99], a[84:87], v[192:195]
    v_mfma_f32_16x16x32_bf16 v[136:139], a[100:103], a[72:75], v[136:139]
    v_mfma_f32_16x16x32_bf16 v[156:159], a[100:103], a[76:79], v[156:159]
    v_mfma_f32_16x16x32_bf16 v[176:179], a[100:103], a[80:83], v[176:179]
    v_mfma_f32_16x16x32_bf16 v[196:199], a[100:103], a[84:87], v[196:199]
    v_mfma_f32_16x16x32_bf16 v[140:143], a[104:107], a[72:75], v[140:143]
    v_mfma_f32_16x16x32_bf16 v[160:163], a[104:107], a[76:79], v[160:163]
    v_mfma_f32_16x16x32_bf16 v[180:183], a[104:107], a[80:83], v[180:183]
    v_mfma_f32_16x16x32_bf16 v[200:203], a[104:107], a[84:87], v[200:203]
    s_waitcnt vmcnt(9)
    v_mfma_f32_16x16x32_bf16 v[124:127], a[16:19], a[0:3], v[124:127]
    s_add_u32 s29, s25, 0x1800
    v_mfma_f32_16x16x32_bf16 v[144:147], a[16:19], a[4:7], v[144:147]
    s_add_u32 s31, s27, 0x3c000
    v_mfma_f32_16x16x32_bf16 v[164:167], a[16:19], a[8:11], v[164:167]
    buffer_load_dwordx4 a[72:75], v8, s[8:11], s29 offen
    v_mfma_f32_16x16x32_bf16 v[184:187], a[16:19], a[12:15], v[184:187]
    buffer_load_dwordx4 a[88:91], v12, s[8:11], s31 offen offset:0
    v_mfma_f32_16x16x32_bf16 v[128:131], a[20:23], a[0:3], v[128:131]
    buffer_load_dwordx4 a[76:79], v9, s[8:11], s29 offen
    v_mfma_f32_16x16x32_bf16 v[148:151], a[20:23], a[4:7], v[148:151]
    buffer_load_dwordx4 a[80:83], v10, s[8:11], s29 offen
    v_mfma_f32_16x16x32_bf16 v[168:171], a[20:23], a[8:11], v[168:171]
    buffer_load_dwordx4 a[84:87], v11, s[8:11], s29 offen
    v_mfma_f32_16x16x32_bf16 v[188:191], a[20:23], a[12:15], v[188:191]
    buffer_load_dwordx4 a[92:95], v12, s[8:11], s31 offen offset:1024
    v_mfma_f32_16x16x32_bf16 v[132:135], a[24:27], a[0:3], v[132:135]
    buffer_load_dwordx4 a[96:99], v12, s[8:11], s31 offen offset:2048
    v_mfma_f32_16x16x32_bf16 v[152:155], a[24:27], a[4:7], v[152:155]
    buffer_load_dwordx4 a[100:103], v12, s[8:11], s31 offen offset:3072
    v_mfma_f32_16x16x32_bf16 v[172:175], a[24:27], a[8:11], v[172:175]
    buffer_load_dwordx4 a[104:107], v13, s[8:11], s31 offen
    v_mfma_f32_16x16x32_bf16 v[192:195], a[24:27], a[12:15], v[192:195]
    s_mul_i32 s35, s22, 160
    buffer_load_dwordx2 v[32:33], v215, s[16:19], s35 offen offset:0
    v_mfma_f32_16x16x32_bf16 v[136:139], a[28:31], a[0:3], v[136:139]
    buffer_load_dwordx2 v[34:35], v215, s[16:19], s35 offen offset:32
    buffer_load_dwordx2 v[36:37], v215, s[16:19], s35 offen offset:64
    v_mfma_f32_16x16x32_bf16 v[156:159], a[28:31], a[4:7], v[156:159]
    buffer_load_dwordx2 v[38:39], v215, s[16:19], s35 offen offset:96
    buffer_load_dwordx2 v[40:41], v215, s[16:19], s35 offen offset:128
    v_mfma_f32_16x16x32_bf16 v[176:179], a[28:31], a[8:11], v[176:179]
    s_lshl_b32 s38, s21, 2
    s_add_u32 s38, s38, s20
    v_mfma_f32_16x16x32_bf16 v[196:199], a[28:31], a[12:15], v[196:199]
    s_lshr_b32 s34, s38, 6
    s_and_b32 s38, s38, 63
    v_mfma_f32_16x16x32_bf16 v[140:143], a[32:35], a[0:3], v[140:143]
    s_lshl_b32 s38, s38, 5
    s_add_u32 s38, s38, s34
    v_mfma_f32_16x16x32_bf16 v[160:163], a[32:35], a[4:7], v[160:163]
    s_mul_i32 s38, s38, 0x500
    s_add_u32 s38, s38, s35
    v_mfma_f32_16x16x32_bf16 v[180:183], a[32:35], a[8:11], v[180:183]
    v_mfma_f32_16x16x32_bf16 v[200:203], a[32:35], a[12:15], v[200:203]
    s_waitcnt vmcnt(14)
    v_mfma_f32_16x16x32_bf16 v[124:127], a[52:55], a[36:39], v[124:127]
    s_add_u32 s28, s25, 0x1c00
    v_mfma_f32_16x16x32_bf16 v[144:147], a[52:55], a[40:43], v[144:147]
    s_add_u32 s30, s27, 0x46000
    v_mfma_f32_16x16x32_bf16 v[164:167], a[52:55], a[44:47], v[164:167]
    buffer_load_dwordx4 a[0:3], v8, s[8:11], s28 offen
    v_mfma_f32_16x16x32_bf16 v[184:187], a[52:55], a[48:51], v[184:187]
    buffer_load_dwordx4 a[16:19], v12, s[8:11], s30 offen offset:0
    v_mfma_f32_16x16x32_bf16 v[128:131], a[56:59], a[36:39], v[128:131]
    buffer_load_dwordx4 a[4:7], v9, s[8:11], s28 offen
    v_mfma_f32_16x16x32_bf16 v[148:151], a[56:59], a[40:43], v[148:151]
    buffer_load_dwordx4 a[8:11], v10, s[8:11], s28 offen
    v_mfma_f32_16x16x32_bf16 v[168:171], a[56:59], a[44:47], v[168:171]
    buffer_load_dwordx4 a[12:15], v11, s[8:11], s28 offen
    v_mfma_f32_16x16x32_bf16 v[188:191], a[56:59], a[48:51], v[188:191]
    buffer_load_dwordx4 a[20:23], v12, s[8:11], s30 offen offset:1024
    v_mfma_f32_16x16x32_bf16 v[132:135], a[60:63], a[36:39], v[132:135]
    buffer_load_dwordx4 a[24:27], v12, s[8:11], s30 offen offset:2048
    v_mfma_f32_16x16x32_bf16 v[152:155], a[60:63], a[40:43], v[152:155]
    buffer_load_dwordx4 a[28:31], v12, s[8:11], s30 offen offset:3072
    v_mfma_f32_16x16x32_bf16 v[172:175], a[60:63], a[44:47], v[172:175]
    buffer_load_dwordx4 a[32:35], v13, s[8:11], s30 offen
    v_mfma_f32_16x16x32_bf16 v[192:195], a[60:63], a[48:51], v[192:195]
    v_pk_mul_f32 v[44:45], v[44:45], v[16:17] op_sel_hi:[1,0]
    v_pk_mul_f32 v[46:47], v[46:47], v[16:17] op_sel_hi:[1,0]
    v_mfma_f32_16x16x32_bf16 v[136:139], a[64:67], a[36:39], v[136:139]
    v_pk_mul_f32 v[48:49], v[48:49], v[16:17] op_sel_hi:[1,0]
    v_pk_mul_f32 v[50:51], v[50:51], v[16:17] op_sel_hi:[1,0]
    v_mfma_f32_16x16x32_bf16 v[156:159], a[64:67], a[40:43], v[156:159]
    v_pk_mul_f32 v[52:53], v[52:53], v[16:17] op_sel_hi:[1,0]
    v_pk_mul_f32 v[54:55], v[54:55], v[16:17] op_sel_hi:[1,0]
    v_mfma_f32_16x16x32_bf16 v[176:179], a[64:67], a[44:47], v[176:179]
    v_pk_mul_f32 v[56:57], v[56:57], v[16:17] op_sel_hi:[1,0]
    v_pk_mul_f32 v[58:59], v[58:59], v[16:17] op_sel_hi:[1,0]
    v_mfma_f32_16x16x32_bf16 v[196:199], a[64:67], a[48:51], v[196:199]
    v_pk_mul_f32 v[60:61], v[60:61], v[16:17] op_sel_hi:[1,0]
    v_pk_mul_f32 v[62:63], v[62:63], v[16:17] op_sel_hi:[1,0]
    v_mfma_f32_16x16x32_bf16 v[140:143], a[68:71], a[36:39], v[140:143]
    v_mfma_f32_16x16x32_bf16 v[160:163], a[68:71], a[40:43], v[160:163]
    v_mfma_f32_16x16x32_bf16 v[180:183], a[68:71], a[44:47], v[180:183]
    v_mfma_f32_16x16x32_bf16 v[200:203], a[68:71], a[48:51], v[200:203]
    s_waitcnt vmcnt(14)
    v_mfma_f32_16x16x32_bf16 v[124:127], a[88:91], a[72:75], v[124:127]
    s_add_u32 s29, s25, 0x2000
    v_mfma_f32_16x16x32_bf16 v[144:147], a[88:91], a[76:79], v[144:147]
    s_add_u32 s31, s27, 0x50000
    v_mfma_f32_16x16x32_bf16 v[164:167], a[88:91], a[80:83], v[164:167]
    buffer_load_dwordx4 a[36:39], v8, s[8:11], s29 offen
    v_mfma_f32_16x16x32_bf16 v[184:187], a[88:91], a[84:87], v[184:187]
    buffer_load_dwordx4 a[52:55], v12, s[8:11], s31 offen offset:0
    v_mfma_f32_16x16x32_bf16 v[128:131], a[92:95], a[72:75], v[128:131]
    buffer_load_dwordx4 a[40:43], v9, s[8:11], s29 offen
    v_mfma_f32_16x16x32_bf16 v[148:151], a[92:95], a[76:79], v[148:151]
    buffer_load_dwordx4 a[44:47], v10, s[8:11], s29 offen
    v_mfma_f32_16x16x32_bf16 v[168:171], a[92:95], a[80:83], v[168:171]
    buffer_load_dwordx4 a[48:51], v11, s[8:11], s29 offen
    v_mfma_f32_16x16x32_bf16 v[188:191], a[92:95], a[84:87], v[188:191]
    buffer_load_dwordx4 a[56:59], v12, s[8:11], s31 offen offset:1024
    v_mfma_f32_16x16x32_bf16 v[132:135], a[96:99], a[72:75], v[132:135]
    buffer_load_dwordx4 a[60:63], v12, s[8:11], s31 offen offset:2048
    v_mfma_f32_16x16x32_bf16 v[152:155], a[96:99], a[76:79], v[152:155]
    buffer_load_dwordx4 a[64:67], v12, s[8:11], s31 offen offset:3072
    v_mfma_f32_16x16x32_bf16 v[172:175], a[96:99], a[80:83], v[172:175]
    buffer_load_dwordx4 a[68:71], v13, s[8:11], s31 offen
    v_mfma_f32_16x16x32_bf16 v[192:195], a[96:99], a[84:87], v[192:195]
    v_pk_mul_f32 v[64:65], v[64:65], v[18:19] op_sel_hi:[1,0]
    v_pk_mul_f32 v[66:67], v[66:67], v[18:19] op_sel_hi:[1,0]
    v_mfma_f32_16x16x32_bf16 v[136:139], a[100:103], a[72:75], v[136:139]
    v_pk_mul_f32 v[68:69], v[68:69], v[18:19] op_sel_hi:[1,0]
    v_pk_mul_f32 v[70:71], v[70:71], v[18:19] op_sel_hi:[1,0]
    v_mfma_f32_16x16x32_bf16 v[156:159], a[100:103], a[76:79], v[156:159]
    v_pk_mul_f32 v[72:73], v[72:73], v[18:19] op_sel_hi:[1,0]
    v_pk_mul_f32 v[74:75], v[74:75], v[18:19] op_sel_hi:[1,0]
    v_mfma_f32_16x16x32_bf16 v[176:179], a[100:103], a[80:83], v[176:179]
    v_pk_mul_f32 v[76:77], v[76:77], v[18:19] op_sel_hi:[1,0]
    v_pk_mul_f32 v[78:79], v[78:79], v[18:19] op_sel_hi:[1,0]
    v_mfma_f32_16x16x32_bf16 v[196:199], a[100:103], a[84:87], v[196:199]
    v_pk_mul_f32 v[80:81], v[80:81], v[18:19] op_sel_hi:[1,0]
    v_pk_mul_f32 v[82:83], v[82:83], v[18:19] op_sel_hi:[1,0]
    v_mfma_f32_16x16x32_bf16 v[140:143], a[104:107], a[72:75], v[140:143]
    v_mfma_f32_16x16x32_bf16 v[160:163], a[104:107], a[76:79], v[160:163]
    v_mfma_f32_16x16x32_bf16 v[180:183], a[104:107], a[80:83], v[180:183]
    v_mfma_f32_16x16x32_bf16 v[200:203], a[104:107], a[84:87], v[200:203]
    s_waitcnt vmcnt(9)
    v_mfma_f32_16x16x32_bf16 v[124:127], a[16:19], a[0:3], v[124:127]
    s_add_u32 s28, s25, 0x2400
    v_mfma_f32_16x16x32_bf16 v[144:147], a[16:19], a[4:7], v[144:147]
    s_add_u32 s30, s27, 0x5a000
    v_mfma_f32_16x16x32_bf16 v[164:167], a[16:19], a[8:11], v[164:167]
    buffer_load_dwordx4 a[72:75], v8, s[8:11], s28 offen
    v_mfma_f32_16x16x32_bf16 v[184:187], a[16:19], a[12:15], v[184:187]
    buffer_load_dwordx4 a[88:91], v12, s[8:11], s30 offen offset:0
    v_mfma_f32_16x16x32_bf16 v[128:131], a[20:23], a[0:3], v[128:131]
    buffer_load_dwordx4 a[76:79], v9, s[8:11], s28 offen
    v_mfma_f32_16x16x32_bf16 v[148:151], a[20:23], a[4:7], v[148:151]
    buffer_load_dwordx4 a[80:83], v10, s[8:11], s28 offen
    v_mfma_f32_16x16x32_bf16 v[168:171], a[20:23], a[8:11], v[168:171]
    buffer_load_dwordx4 a[84:87], v11, s[8:11], s28 offen
    v_mfma_f32_16x16x32_bf16 v[188:191], a[20:23], a[12:15], v[188:191]
    buffer_load_dwordx4 a[92:95], v12, s[8:11], s30 offen offset:1024
    v_mfma_f32_16x16x32_bf16 v[132:135], a[24:27], a[0:3], v[132:135]
    buffer_load_dwordx4 a[96:99], v12, s[8:11], s30 offen offset:2048
    v_mfma_f32_16x16x32_bf16 v[152:155], a[24:27], a[4:7], v[152:155]
    buffer_load_dwordx4 a[100:103], v12, s[8:11], s30 offen offset:3072
    v_mfma_f32_16x16x32_bf16 v[172:175], a[24:27], a[8:11], v[172:175]
    buffer_load_dwordx4 a[104:107], v13, s[8:11], s30 offen
    v_mfma_f32_16x16x32_bf16 v[192:195], a[24:27], a[12:15], v[192:195]
    v_pk_mul_f32 v[84:85], v[84:85], v[20:21] op_sel_hi:[1,0]
    v_pk_mul_f32 v[86:87], v[86:87], v[20:21] op_sel_hi:[1,0]
    v_mfma_f32_16x16x32_bf16 v[136:139], a[28:31], a[0:3], v[136:139]
    v_pk_mul_f32 v[88:89], v[88:89], v[20:21] op_sel_hi:[1,0]
    v_pk_mul_f32 v[90:91], v[90:91], v[20:21] op_sel_hi:[1,0]
    v_mfma_f32_16x16x32_bf16 v[156:159], a[28:31], a[4:7], v[156:159]
    v_pk_mul_f32 v[92:93], v[92:93], v[20:21] op_sel_hi:[1,0]
    v_pk_mul_f32 v[94:95], v[94:95], v[20:21] op_sel_hi:[1,0]
    v_mfma_f32_16x16x32_bf16 v[176:179], a[28:31], a[8:11], v[176:179]
    v_pk_mul_f32 v[96:97], v[96:97], v[20:21] op_sel_hi:[1,0]
    v_pk_mul_f32 v[98:99], v[98:99], v[20:21] op_sel_hi:[1,0]
    v_mfma_f32_16x16x32_bf16 v[196:199], a[28:31], a[12:15], v[196:199]
    v_pk_mul_f32 v[100:101], v[100:101], v[20:21] op_sel_hi:[1,0]
    v_pk_mul_f32 v[102:103], v[102:103], v[20:21] op_sel_hi:[1,0]
    v_mfma_f32_16x16x32_bf16 v[140:143], a[32:35], a[0:3], v[140:143]
    v_mfma_f32_16x16x32_bf16 v[160:163], a[32:35], a[4:7], v[160:163]
    v_mfma_f32_16x16x32_bf16 v[180:183], a[32:35], a[8:11], v[180:183]
    v_mfma_f32_16x16x32_bf16 v[200:203], a[32:35], a[12:15], v[200:203]
    s_waitcnt vmcnt(9)
    v_mfma_f32_16x16x32_bf16 v[124:127], a[52:55], a[36:39], v[124:127]
    s_add_u32 s29, s25, 0x2800
    v_mfma_f32_16x16x32_bf16 v[144:147], a[52:55], a[40:43], v[144:147]
    s_add_u32 s31, s27, 0x64000
    v_mfma_f32_16x16x32_bf16 v[164:167], a[52:55], a[44:47], v[164:167]
    buffer_load_dwordx4 a[0:3], v8, s[8:11], s29 offen
    v_mfma_f32_16x16x32_bf16 v[184:187], a[52:55], a[48:51], v[184:187]
    buffer_load_dwordx4 a[16:19], v12, s[8:11], s31 offen offset:0
    v_mfma_f32_16x16x32_bf16 v[128:131], a[56:59], a[36:39], v[128:131]
    buffer_load_dwordx4 a[4:7], v9, s[8:11], s29 offen
    v_mfma_f32_16x16x32_bf16 v[148:151], a[56:59], a[40:43], v[148:151]
    buffer_load_dwordx4 a[8:11], v10, s[8:11], s29 offen
    v_mfma_f32_16x16x32_bf16 v[168:171], a[56:59], a[44:47], v[168:171]
    buffer_load_dwordx4 a[12:15], v11, s[8:11], s29 offen
    v_mfma_f32_16x16x32_bf16 v[188:191], a[56:59], a[48:51], v[188:191]
    buffer_load_dwordx4 a[20:23], v12, s[8:11], s31 offen offset:1024
    v_mfma_f32_16x16x32_bf16 v[132:135], a[60:63], a[36:39], v[132:135]
    buffer_load_dwordx4 a[24:27], v12, s[8:11], s31 offen offset:2048
    v_mfma_f32_16x16x32_bf16 v[152:155], a[60:63], a[40:43], v[152:155]
    buffer_load_dwordx4 a[28:31], v12, s[8:11], s31 offen offset:3072
    v_mfma_f32_16x16x32_bf16 v[172:175], a[60:63], a[44:47], v[172:175]
    buffer_load_dwordx4 a[32:35], v13, s[8:11], s31 offen
    v_mfma_f32_16x16x32_bf16 v[192:195], a[60:63], a[48:51], v[192:195]
    v_pk_mul_f32 v[104:105], v[104:105], v[22:23] op_sel_hi:[1,0]
    v_pk_mul_f32 v[106:107], v[106:107], v[22:23] op_sel_hi:[1,0]
    v_mfma_f32_16x16x32_bf16 v[136:139], a[64:67], a[36:39], v[136:139]
    v_pk_mul_f32 v[108:109], v[108:109], v[22:23] op_sel_hi:[1,0]
    v_pk_mul_f32 v[110:111], v[110:111], v[22:23] op_sel_hi:[1,0]
    v_mfma_f32_16x16x32_bf16 v[156:159], a[64:67], a[40:43], v[156:159]
    v_pk_mul_f32 v[112:113], v[112:113], v[22:23] op_sel_hi:[1,0]
    v_pk_mul_f32 v[114:115], v[114:115], v[22:23] op_sel_hi:[1,0]
    v_mfma_f32_16x16x32_bf16 v[176:179], a[64:67], a[44:47], v[176:179]
    v_pk_mul_f32 v[116:117], v[116:117], v[22:23] op_sel_hi:[1,0]
    v_pk_mul_f32 v[118:119], v[118:119], v[22:23] op_sel_hi:[1,0]
    v_mfma_f32_16x16x32_bf16 v[196:199], a[64:67], a[48:51], v[196:199]
    v_pk_mul_f32 v[120:121], v[120:121], v[22:23] op_sel_hi:[1,0]
    v_pk_mul_f32 v[122:123], v[122:123], v[22:23] op_sel_hi:[1,0]
    v_mfma_f32_16x16x32_bf16 v[140:143], a[68:71], a[36:39], v[140:143]
    v_mfma_f32_16x16x32_bf16 v[160:163], a[68:71], a[40:43], v[160:163]
    v_mfma_f32_16x16x32_bf16 v[180:183], a[68:71], a[44:47], v[180:183]
    v_mfma_f32_16x16x32_bf16 v[200:203], a[68:71], a[48:51], v[200:203]
    s_waitcnt vmcnt(9)
    v_mfma_f32_16x16x32_bf16 v[124:127], a[88:91], a[72:75], v[124:127]
    s_add_u32 s28, s25, 0x2c00
    v_mfma_f32_16x16x32_bf16 v[144:147], a[88:91], a[76:79], v[144:147]
    s_add_u32 s30, s27, 0x6e000
    v_mfma_f32_16x16x32_bf16 v[164:167], a[88:91], a[80:83], v[164:167]
    buffer_load_dwordx4 a[52:55], v12, s[8:11], s30 offen offset:0
    v_mfma_f32_16x16x32_bf16 v[184:187], a[88:91], a[84:87], v[184:187]
    buffer_load_dwordx4 a[56:59], v12, s[8:11], s30 offen offset:1024
    v_mfma_f32_16x16x32_bf16 v[128:131], a[92:95], a[72:75], v[128:131]
    buffer_load_dwordx4 a[60:63], v12, s[8:11], s30 offen offset:2048
    v_mfma_f32_16x16x32_bf16 v[148:151], a[92:95], a[76:79], v[148:151]
    buffer_load_dwordx4 a[64:67], v12, s[8:11], s30 offen offset:3072
    v_mfma_f32_16x16x32_bf16 v[168:171], a[92:95], a[80:83], v[168:171]
    buffer_load_dwordx4 a[68:71], v13, s[8:11], s30 offen
    v_mfma_f32_16x16x32_bf16 v[188:191], a[92:95], a[84:87], v[188:191]
    buffer_load_dwordx4 a[40:43], v9, s[8:11], s28 offen
    v_mfma_f32_16x16x32_bf16 v[132:135], a[96:99], a[72:75], v[132:135]
    buffer_load_dwordx4 a[44:47], v10, s[8:11], s28 offen
    v_mfma_f32_16x16x32_bf16 v[152:155], a[96:99], a[76:79], v[152:155]
    buffer_load_dwordx4 a[48:51], v11, s[8:11], s28 offen
    v_mfma_f32_16x16x32_bf16 v[172:175], a[96:99], a[80:83], v[172:175]
    buffer_load_dwordx4 a[36:39], v8, s[8:11], s28 offen
    v_mfma_f32_16x16x32_bf16 v[192:195], a[96:99], a[84:87], v[192:195]
    v_lshlrev_b32 v204, 16, v32
    v_and_b32 v205, 0xffff0000, v32
    v_lshlrev_b32 v206, 16, v33
    v_and_b32 v207, 0xffff0000, v33
    v_mfma_f32_16x16x32_bf16 v[136:139], a[100:103], a[72:75], v[136:139]
    v_pk_fma_f32 v[44:45], v[204:205], v[24:25], v[44:45] op_sel_hi:[1,0,1]
    v_pk_fma_f32 v[46:47], v[206:207], v[24:25], v[46:47] op_sel_hi:[1,0,1]
    v_lshlrev_b32 v204, 16, v34
    v_and_b32 v205, 0xffff0000, v34
    v_mfma_f32_16x16x32_bf16 v[156:159], a[100:103], a[76:79], v[156:159]
    v_lshlrev_b32 v206, 16, v35
    v_and_b32 v207, 0xffff0000, v35
    v_pk_fma_f32 v[48:49], v[204:205], v[24:25], v[48:49] op_sel_hi:[1,0,1]
    v_pk_fma_f32 v[50:51], v[206:207], v[24:25], v[50:51] op_sel_hi:[1,0,1]
    v_mfma_f32_16x16x32_bf16 v[176:179], a[100:103], a[80:83], v[176:179]
    v_lshlrev_b32 v204, 16, v36
    v_and_b32 v205, 0xffff0000, v36
    v_lshlrev_b32 v206, 16, v37
    v_and_b32 v207, 0xffff0000, v37
    v_mfma_f32_16x16x32_bf16 v[196:199], a[100:103], a[84:87], v[196:199]
    v_pk_fma_f32 v[52:53], v[204:205], v[24:25], v[52:53] op_sel_hi:[1,0,1]
    v_pk_fma_f32 v[54:55], v[206:207], v[24:25], v[54:55] op_sel_hi:[1,0,1]
    v_lshlrev_b32 v204, 16, v38
    v_and_b32 v205, 0xffff0000, v38
    v_mfma_f32_16x16x32_bf16 v[140:143], a[104:107], a[72:75], v[140:143]
    v_lshlrev_b32 v206, 16, v39
    v_and_b32 v207, 0xffff0000, v39
    v_pk_fma_f32 v[56:57], v[204:205], v[24:25], v[56:57] op_sel_hi:[1,0,1]
    v_pk_fma_f32 v[58:59], v[206:207], v[24:25], v[58:59] op_sel_hi:[1,0,1]
    v_mfma_f32_16x16x32_bf16 v[160:163], a[104:107], a[76:79], v[160:163]
    v_lshlrev_b32 v204, 16, v40
    v_and_b32 v205, 0xffff0000, v40
    v_lshlrev_b32 v206, 16, v41
    v_and_b32 v207, 0xffff0000, v41
    v_mfma_f32_16x16x32_bf16 v[180:183], a[104:107], a[80:83], v[180:183]
    v_pk_fma_f32 v[60:61], v[204:205], v[24:25], v[60:61] op_sel_hi:[1,0,1]
    v_pk_fma_f32 v[62:63], v[206:207], v[24:25], v[62:63] op_sel_hi:[1,0,1]
    v_mfma_f32_16x16x32_bf16 v[200:203], a[104:107], a[84:87], v[200:203]
    s_waitcnt vmcnt(9)
    v_mfma_f32_16x16x32_bf16 v[124:127], a[16:19], a[0:3], v[124:127]
    v_mfma_f32_16x16x32_bf16 v[144:147], a[16:19], a[4:7], v[144:147]
    v_mfma_f32_16x16x32_bf16 v[164:167], a[16:19], a[8:11], v[164:167]
    v_mfma_f32_16x16x32_bf16 v[184:187], a[16:19], a[12:15], v[184:187]
    v_mfma_f32_16x16x32_bf16 v[128:131], a[20:23], a[0:3], v[128:131]
    v_mfma_f32_16x16x32_bf16 v[148:151], a[20:23], a[4:7], v[148:151]
    v_mfma_f32_16x16x32_bf16 v[168:171], a[20:23], a[8:11], v[168:171]
    v_mfma_f32_16x16x32_bf16 v[188:191], a[20:23], a[12:15], v[188:191]
    v_mfma_f32_16x16x32_bf16 v[132:135], a[24:27], a[0:3], v[132:135]
    v_mfma_f32_16x16x32_bf16 v[152:155], a[24:27], a[4:7], v[152:155]
    v_mfma_f32_16x16x32_bf16 v[172:175], a[24:27], a[8:11], v[172:175]
    v_mfma_f32_16x16x32_bf16 v[192:195], a[24:27], a[12:15], v[192:195]
    v_mfma_f32_16x16x32_bf16 v[136:139], a[28:31], a[0:3], v[136:139]
    v_mfma_f32_16x16x32_bf16 v[156:159], a[28:31], a[4:7], v[156:159]
    v_mfma_f32_16x16x32_bf16 v[176:179], a[28:31], a[8:11], v[176:179]
    v_mfma_f32_16x16x32_bf16 v[196:199], a[28:31], a[12:15], v[196:199]
    v_mfma_f32_16x16x32_bf16 v[140:143], a[32:35], a[0:3], v[140:143]
    v_mfma_f32_16x16x32_bf16 v[160:163], a[32:35], a[4:7], v[160:163]
    v_mfma_f32_16x16x32_bf16 v[180:183], a[32:35], a[8:11], v[180:183]
    v_mfma_f32_16x16x32_bf16 v[200:203], a[32:35], a[12:15], v[200:203]
    s_waitcnt vmcnt(3)
    v_mfma_f32_16x16x32_bf16 v[144:147], a[52:55], a[40:43], v[144:147]
    v_mfma_f32_16x16x32_bf16 v[148:151], a[56:59], a[40:43], v[148:151]
    v_mfma_f32_16x16x32_bf16 v[152:155], a[60:63], a[40:43], v[152:155]
    v_mfma_f32_16x16x32_bf16 v[156:159], a[64:67], a[40:43], v[156:159]
    v_mfma_f32_16x16x32_bf16 v[160:163], a[68:71], a[40:43], v[160:163]
    s_nop 3
    v_pk_fma_f32 v[64:65], v[144:145], v[26:27], v[64:65] op_sel_hi:[1,0,1]
    v_pk_fma_f32 v[66:67], v[146:147], v[26:27], v[66:67] op_sel_hi:[1,0,1]
    ds_write_b128 v209, v[64:67] offset:0
    v_pk_fma_f32 v[68:69], v[148:149], v[26:27], v[68:69] op_sel_hi:[1,0,1]
    v_pk_fma_f32 v[70:71], v[150:151], v[26:27], v[70:71] op_sel_hi:[1,0,1]
    ds_write_b128 v209, v[68:71] offset:1024
    v_pk_fma_f32 v[72:73], v[152:153], v[26:27], v[72:73] op_sel_hi:[1,0,1]
    v_pk_fma_f32 v[74:75], v[154:155], v[26:27], v[74:75] op_sel_hi:[1,0,1]
    ds_write_b128 v209, v[72:75] offset:2048
    v_pk_fma_f32 v[76:77], v[156:157], v[26:27], v[76:77] op_sel_hi:[1,0,1]
    v_pk_fma_f32 v[78:79], v[158:159], v[26:27], v[78:79] op_sel_hi:[1,0,1]
    ds_write_b128 v209, v[76:79] offset:3072
    v_pk_fma_f32 v[80:81], v[160:161], v[26:27], v[80:81] op_sel_hi:[1,0,1]
    v_pk_fma_f32 v[82:83], v[162:163], v[26:27], v[82:83] op_sel_hi:[1,0,1]
    ds_write_b128 v209, v[80:83] offset:4096
    s_waitcnt vmcnt(2)
    v_mfma_f32_16x16x32_bf16 v[164:167], a[52:55], a[44:47], v[164:167]
    v_mfma_f32_16x16x32_bf16 v[168:171], a[56:59], a[44:47], v[168:171]
    v_mfma_f32_16x16x32_bf16 v[172:175], a[60:63], a[44:47], v[172:175]
    v_mfma_f32_16x16x32_bf16 v[176:179], a[64:67], a[44:47], v[176:179]
    v_mfma_f32_16x16x32_bf16 v[180:183], a[68:71], a[44:47], v[180:183]
    s_nop 3
    v_pk_fma_f32 v[84:85], v[164:165], v[28:29], v[84:85] op_sel_hi:[1,0,1]
    v_pk_fma_f32 v[86:87], v[166:167], v[28:29], v[86:87] op_sel_hi:[1,0,1]
    ds_write_b128 v210, v[84:87] offset:5120
    v_pk_fma_f32 v[88:89], v[168:169], v[28:29], v[88:89] op_sel_hi:[1,0,1]
    v_pk_fma_f32 v[90:91], v[170:171], v[28:29], v[90:91] op_sel_hi:[1,0,1]
    ds_write_b128 v210, v[88:91] offset:6144
    v_pk_fma_f32 v[92:93], v[172:173], v[28:29], v[92:93] op_sel_hi:[1,0,1]
    v_pk_fma_f32 v[94:95], v[174:175], v[28:29], v[94:95] op_sel_hi:[1,0,1]
    ds_write_b128 v210, v[92:95] offset:7168
    v_pk_fma_f32 v[96:97], v[176:177], v[28:29], v[96:97] op_sel_hi:[1,0,1]
    v_pk_fma_f32 v[98:99], v[178:179], v[28:29], v[98:99] op_sel_hi:[1,0,1]
    ds_write_b128 v210, v[96:99] offset:8192
    v_pk_fma_f32 v[100:101], v[180:181], v[28:29], v[100:101] op_sel_hi:[1,0,1]
    v_pk_fma_f32 v[102:103], v[182:183], v[28:29], v[102:103] op_sel_hi:[1,0,1]
    ds_write_b128 v210, v[100:103] offset:9216
    s_waitcnt vmcnt(1)
    v_mfma_f32_16x16x32_bf16 v[184:187], a[52:55], a[48:51], v[184:187]
    v_mfma_f32_16x16x32_bf16 v[188:191], a[56:59], a[48:51], v[188:191]
    v_mfma_f32_16x16x32_bf16 v[192:195], a[60:63], a[48:51], v[192:195]
    v_mfma_f32_16x16x32_bf16 v[196:199], a[64:67], a[48:51], v[196:199]
    v_mfma_f32_16x16x32_bf16 v[200:203], a[68:71], a[48:51], v[200:203]
    s_nop 3
    v_pk_fma_f32 v[104:105], v[184:185], v[30:31], v[104:105] op_sel_hi:[1,0,1]
    v_pk_fma_f32 v[106:107], v[186:187], v[30:31], v[106:107] op_sel_hi:[1,0,1]
    ds_write_b128 v211, v[104:107] offset:10240
    v_pk_fma_f32 v[108:109], v[188:189], v[30:31], v[108:109] op_sel_hi:[1,0,1]
    v_pk_fma_f32 v[110:111], v[190:191], v[30:31], v[110:111] op_sel_hi:[1,0,1]
    ds_write_b128 v211, v[108:111] offset:11264
    v_pk_fma_f32 v[112:113], v[192:193], v[30:31], v[112:113] op_sel_hi:[1,0,1]
    v_pk_fma_f32 v[114:115], v[194:195], v[30:31], v[114:115] op_sel_hi:[1,0,1]
    ds_write_b128 v211, v[112:115] offset:12288
    v_pk_fma_f32 v[116:117], v[196:197], v[30:31], v[116:117] op_sel_hi:[1,0,1]
    v_pk_fma_f32 v[118:119], v[198:199], v[30:31], v[118:119] op_sel_hi:[1,0,1]
    ds_write_b128 v211, v[116:119] offset:13312
    v_pk_fma_f32 v[120:121], v[200:201], v[30:31], v[120:121] op_sel_hi:[1,0,1]
    v_pk_fma_f32 v[122:123], v[202:203], v[30:31], v[122:123] op_sel_hi:[1,0,1]
    ds_write_b128 v211, v[120:123] offset:14336
    s_waitcnt vmcnt(0)
    v_mfma_f32_16x16x32_bf16 v[124:127], a[52:55], a[36:39], v[124:127]
    v_mfma_f32_16x16x32_bf16 v[128:131], a[56:59], a[36:39], v[128:131]
    v_mfma_f32_16x16x32_bf16 v[132:135], a[60:63], a[36:39], v[132:135]
    v_mfma_f32_16x16x32_bf16 v[136:139], a[64:67], a[36:39], v[136:139]
    v_mfma_f32_16x16x32_bf16 v[140:143], a[68:71], a[36:39], v[140:143]
    s_waitcnt lgkmcnt(0)
    s_barrier
    ds_read_b128 v[144:147], v212 offset:0
    ds_read_b128 v[164:167], v212 offset:5120
    ds_read_b128 v[184:187], v212 offset:10240
    ds_read_b128 v[148:151], v212 offset:1024
    ds_read_b128 v[168:171], v212 offset:6144
    ds_read_b128 v[188:191], v212 offset:11264
    ds_read_b128 v[152:155], v212 offset:2048
    ds_read_b128 v[172:175], v212 offset:7168
    ds_read_b128 v[192:195], v212 offset:12288
    ds_read_b128 v[156:159], v212 offset:3072
    ds_read_b128 v[176:179], v212 offset:8192
    ds_read_b128 v[196:199], v212 offset:13312
    ds_read_b128 v[160:163], v212 offset:4096
    ds_read_b128 v[180:183], v212 offset:9216
    ds_read_b128 v[200:203], v212 offset:14336
    v_pk_fma_f32 v[44:45], v[124:125], v[24:25], v[44:45] op_sel_hi:[1,0,1]
    v_pk_fma_f32 v[46:47], v[126:127], v[24:25], v[46:47] op_sel_hi:[1,0,1]
    v_pk_fma_f32 v[48:49], v[128:129], v[24:25], v[48:49] op_sel_hi:[1,0,1]
    v_pk_fma_f32 v[50:51], v[130:131], v[24:25], v[50:51] op_sel_hi:[1,0,1]
    v_pk_fma_f32 v[52:53], v[132:133], v[24:25], v[52:53] op_sel_hi:[1,0,1]
    v_pk_fma_f32 v[54:55], v[134:135], v[24:25], v[54:55] op_sel_hi:[1,0,1]
    v_pk_fma_f32 v[56:57], v[136:137], v[24:25], v[56:57] op_sel_hi:[1,0,1]
    v_pk_fma_f32 v[58:59], v[138:139], v[24:25], v[58:59] op_sel_hi:[1,0,1]
    v_pk_fma_f32 v[60:61], v[140:141], v[24:25], v[60:61] op_sel_hi:[1,0,1]
    v_pk_fma_f32 v[62:63], v[142:143], v[24:25], v[62:63] op_sel_hi:[1,0,1]
    s_waitcnt lgkmcnt(12)
    v_pk_add_f32 v[44:45], v[44:45], v[144:145]
    v_pk_add_f32 v[164:165], v[164:165], v[184:185]
    v_pk_add_f32 v[46:47], v[46:47], v[146:147]
    v_pk_add_f32 v[166:167], v[166:167], v[186:187]
    v_pk_add_f32 v[44:45], v[44:45], v[164:165]
    v_pk_add_f32 v[46:47], v[46:47], v[166:167]
    v_cvt_pk_bf16_f32 v44, v44, v45
    v_cvt_pk_bf16_f32 v45, v46, v47
    buffer_store_dwordx2 v[44:45], v214, s[12:15], s38 offen offset:0
    s_waitcnt lgkmcnt(9)
    v_pk_add_f32 v[48:49], v[48:49], v[148:149]
    v_pk_add_f32 v[168:169], v[168:169], v[188:189]
    v_pk_add_f32 v[50:51], v[50:51], v[150:151]
    v_pk_add_f32 v[170:171], v[170:171], v[190:191]
    v_pk_add_f32 v[48:49], v[48:49], v[168:169]
    v_pk_add_f32 v[50:51], v[50:51], v[170:171]
    v_cvt_pk_bf16_f32 v48, v48, v49
    v_cvt_pk_bf16_f32 v49, v50, v51
    buffer_store_dwordx2 v[48:49], v214, s[12:15], s38 offen offset:32
    s_waitcnt lgkmcnt(6)
    v_pk_add_f32 v[52:53], v[52:53], v[152:153]
    v_pk_add_f32 v[172:173], v[172:173], v[192:193]
    v_pk_add_f32 v[54:55], v[54:55], v[154:155]
    v_pk_add_f32 v[174:175], v[174:175], v[194:195]
    v_pk_add_f32 v[52:53], v[52:53], v[172:173]
    v_pk_add_f32 v[54:55], v[54:55], v[174:175]
    v_cvt_pk_bf16_f32 v52, v52, v53
    v_cvt_pk_bf16_f32 v53, v54, v55
    buffer_store_dwordx2 v[52:53], v214, s[12:15], s38 offen offset:64
    s_waitcnt lgkmcnt(3)
    v_pk_add_f32 v[56:57], v[56:57], v[156:157]
    v_pk_add_f32 v[176:177], v[176:177], v[196:197]
    v_pk_add_f32 v[58:59], v[58:59], v[158:159]
    v_pk_add_f32 v[178:179], v[178:179], v[198:199]
    v_pk_add_f32 v[56:57], v[56:57], v[176:177]
    v_pk_add_f32 v[58:59], v[58:59], v[178:179]
    v_cvt_pk_bf16_f32 v56, v56, v57
    v_cvt_pk_bf16_f32 v57, v58, v59
    buffer_store_dwordx2 v[56:57], v214, s[12:15], s38 offen offset:96
    s_waitcnt lgkmcnt(0)
    v_pk_add_f32 v[60:61], v[60:61], v[160:161]
    v_pk_add_f32 v[180:181], v[180:181], v[200:201]
    v_pk_add_f32 v[62:63], v[62:63], v[162:163]
    v_pk_add_f32 v[182:183], v[182:183], v[202:203]
    v_pk_add_f32 v[60:61], v[60:61], v[180:181]
    v_pk_add_f32 v[62:63], v[62:63], v[182:183]
    v_cvt_pk_bf16_f32 v60, v60, v61
    v_cvt_pk_bf16_f32 v61, v62, v63
    buffer_store_dwordx2 v[60:61], v214, s[12:15], s38 offen offset:128
L_k2_end:
    s_endpgm
.section .rodata,"a"
.p2align 6
.amdhsa_kernel k1_kernel
  .amdhsa_next_free_vgpr 360
  .amdhsa_next_free_sgpr 96
  .amdhsa_accum_offset 256
  .amdhsa_group_segment_fixed_size 0
  .amdhsa_kernarg_size 96
  .amdhsa_user_sgpr_count 2
  .amdhsa_user_sgpr_kernarg_segment_ptr 1
  .amdhsa_system_sgpr_workgroup_id_x 1
.end_amdhsa_kernel

.p2align 6
.amdhsa_kernel k2_kernel
  .amdhsa_next_free_vgpr 324
  .amdhsa_next_free_sgpr 96
  .amdhsa_accum_offset 216
  .amdhsa_group_segment_fixed_size 0
  .amdhsa_kernarg_size 96
  .amdhsa_user_sgpr_count 2
  .amdhsa_user_sgpr_kernarg_segment_ptr 1
  .amdhsa_system_sgpr_workgroup_id_x 1
.end_amdhsa_kernel
```
